```python
import torch

def _softmax(x, axis=-1):
    return torch.softmax(x, dim=axis)

def _gelu(x):
    return torch.nn.functional.gelu(x, approximate='tanh')

def _silu(x):
    return torch.nn.functional.silu(x)

def _sigmoid(x):
    return torch.sigmoid(x)

def _layernorm(x, axis=-1, eps=1e-05):
    m = x.mean(dim=axis, keepdim=True)
    v = x.var(dim=axis, keepdim=True, unbiased=False)
    return (x - m) / torch.sqrt(v + eps)

def _scatter_add(tgt, idx, src, axis=0):
    return tgt.clone().index_add_(axis, idx, src)

def _segment_sum(src, seg, n):
    out = torch.zeros((n,) + src.shape[1:], dtype=src.dtype)
    return out.index_add_(0, seg, src)

def _pad(x, pw):
    flat = tuple((v for pair in reversed(pw) for v in pair))
    return torch.nn.functional.pad(x, flat)
kernel_name = 'adaLN_cond__grouped_kv_mqa__glu_gated_swiglu__prompt'

def setup_inputs():

    _w = lambda a: (lambda t: t.to(torch.bfloat16) if t.is_floating_point() else t)(torch.as_tensor(a))

    def _A_setup():
        B, S, D, H = (1, 2048, 640, 32)
        Dh = D // H
        return {'x': _w((lambda *s: torch.randn(*s, dtype=torch.bfloat16) * 0.05)(B, S, D)), 'wq': _w((lambda *s: torch.randn(*s, dtype=torch.bfloat16) * 0.05)(D, H * Dh)), 'wk': _w((lambda *s: torch.randn(*s, dtype=torch.bfloat16) * 0.05)(D, Dh)), 'wv': _w((lambda *s: torch.randn(*s, dtype=torch.bfloat16) * 0.05)(D, Dh)), 'wo': _w((lambda *s: torch.randn(*s, dtype=torch.bfloat16) * 0.05)(H * Dh, D))}
    _A_in = _A_setup()

    def _B_setup():
        B, S, D, F = (1, 2048, 640, 1728)
        return {'x': _w((lambda *s: torch.randn(*s, dtype=torch.bfloat16) * 0.05)(B, S, D)), 'w1': _w((lambda *s: torch.randn(*s, dtype=torch.bfloat16) * 0.8)(D, F) * (2.0 / D) ** 0.5), 'w3': _w((lambda *s: torch.randn(*s, dtype=torch.bfloat16) * 0.8)(D, F) * (2.0 / D) ** 0.5), 'w2': _w((lambda *s: torch.randn(*s, dtype=torch.bfloat16) * 0.8)(F, D) * (2.0 / F) ** 0.5)}
    _B_in = _B_setup()
    return {'A_x': _A_in['x'], 'A_wq': _A_in['wq'], 'A_wk': _A_in['wk'], 'A_wv': _A_in['wv'], 'A_wo': _A_in['wo'], 'B_x': _B_in['x'], 'B_w1': _B_in['w1'], 'B_w3': _B_in['w3'], 'B_w2': _B_in['w2'], 'c': _w((lambda *s: torch.randn(*s, dtype=torch.bfloat16) * 0.2)(1, 640) * 8.0), 'w_mod': _w((lambda *s: torch.randn(*s, dtype=torch.bfloat16) * 0.2)(640, 6 * 640) * 640 ** (-0.5) * 8.0)}

def reference(A_x, A_wq, A_wk, A_wv, A_wo, B_x, B_w1, B_w3, B_w2, c, w_mod):

    def _A_ref(x, wq, wk, wv, wo):
        B, S, D = x.shape
        H = 32
        Dh = D // H
        q = (lambda x, *d: x.permute(*d))((x @ wq).reshape(B, S, H, Dh), 0, 2, 1, 3)
        k = x @ wk
        v = x @ wv
        scores = torch.einsum('bhqd,bkd->bhqk', q, k) * Dh ** (-0.5)
        p = _softmax(scores, axis=-1)
        o = torch.einsum('bhqk,bkd->bhqd', p, v)
        return (lambda x, *d: x.permute(*d))(o, 0, 2, 1, 3).reshape(B, S, H * Dh) @ wo

    def _B_ref(x, w1, w3, w2):
        gate = torch.einsum('bsd,df->bsf', x, w1)
        up = torch.einsum('bsd,df->bsf', x, w3)
        h = _silu(gate) * up
        out = torch.einsum('bsf,fd->bsd', h, w2)
        return out
    x = A_x
    mod = (_silu(c) @ w_mod).reshape(c.shape[0], 6, 1, -1)
    sa, ca, ga, sb, cb, gb = (mod[:, 0].clone(), mod[:, 1].clone(), mod[:, 2].clone(), mod[:, 3].clone(), mod[:, 4].clone(), mod[:, 5].clone())
    h = _layernorm(x, axis=-1) * (1 + ca) + sa
    x = x + ga * _A_ref(h, A_wq, A_wk, A_wv, A_wo)
    h = _layernorm(x, axis=-1) * (1 + cb) + sb
    x = x + gb * _B_ref(h, B_w1, B_w3, B_w2)
    return x
```

```asm
; @launch grid=(256,1,1) block=(512,1,1) lds=163840
.amdgcn_target "amdgcn-amd-amdhsa--gfx950"
.text
.globl adaLN_cond__grouped_kv_mqa__glu_gated_swiglu__prompt_kernel
.p2align 8
.type adaLN_cond__grouped_kv_mqa__glu_gated_swiglu__prompt_kernel,@function
adaLN_cond__grouped_kv_mqa__glu_gated_swiglu__prompt_kernel:
    s_cmp_ge_u32 s2, 256
    s_cbranch_scc1 L_END
    s_load_dwordx16 s[32:47], s[0:1], 0
    s_load_dwordx8 s[48:55], s[0:1], 64
    s_load_dwordx4 s[56:59], s[0:1], 96
    s_getpc_b64 s[72:73]
Lpc_2:
    s_lshr_b32 s74, s2, 3
    s_lshl_b32 s74, s74, 13
    s_cmp_ge_u32 s74, L_END - Lpc_2
    s_cbranch_scc1 Lcp_1
    v_lshlrev_b32 v208, 4, v0
    v_add_u32 v208, s74, v208
    v_min_u32 v208, L_END - Lpc_2 - 16, v208
    global_load_dwordx4 v[208:211], v208, s[72:73]
Lcp_1:
    v_and_b32 v1, 63, v0
    v_lshrrev_b32 v8, 6, v0
    s_and_b32 s67, s2, 7
    s_lshr_b32 s68, s2, 3
    v_readfirstlane_b32 s65, v8
    s_lshl_b32 s60, s67, 5
    s_add_u32 s60, s60, s68
    v_lshlrev_b32 v2, 4, v1
    s_lshr_b32 s61, s60, 4
    s_and_b32 s62, s60, 15
    s_lshr_b32 s63, s60, 3
    s_and_b32 s64, s60, 7
    s_and_b32 s69, s65, 3
    s_lshr_b32 s97, s65, 2
    s_lshl_b32 s29, s65, 10
    s_lshl_b32 s28, s63, 2
    s_add_u32 s28, s28, s69
    v_and_b32 v243, 31, v1
    s_lshl_b32 s70, s65, 5
    v_add_u32 v243, s70, v243
    v_lshlrev_b32 v244, 1, v243
    s_movk_i32 s70, 7680
    v_mul_u32_u24 v243, s70, v243
    v_lshrrev_b32 v245, 5, v1
    v_lshl_add_u32 v243, v245, 4, v243
    s_lshl_b32 s75, s60, 5
    s_cmp_lt_u32 s60, 240
    s_cselect_b32 s75, s75, 0x7000000
    v_mov_b32 v246, 0
    v_mov_b32 v247, 160512
    ds_write_b32 v247, v246
    s_waitcnt lgkmcnt(0)
    s_mov_b32 s16, s52
    s_mov_b32 s17, s53
    s_mov_b32 s18, 4915200
    s_mov_b32 s19, 0x20000
    s_cmp_ge_u32 s65, 4
    s_cbranch_scc1 Lp0l_3
    buffer_load_dwordx4 v[208:211], v243, s[16:19], s75 offen
    v_add_u32 v243, 983040, v243
    buffer_load_dwordx4 v[212:215], v243, s[16:19], s75 offen
    v_add_u32 v243, 983040, v243
    buffer_load_dwordx4 v[216:219], v243, s[16:19], s75 offen
    v_add_u32 v243, 983040, v243
    buffer_load_dwordx4 v[220:223], v243, s[16:19], s75 offen
    v_add_u32 v243, 983040, v243
    buffer_load_dwordx4 v[224:227], v243, s[16:19], s75 offen
    s_mov_b32 s20, s50
    s_mov_b32 s21, s51
    s_mov_b32 s22, 1280
    s_mov_b32 s23, 0x20000
    buffer_load_ushort v228, v244, s[20:23], 0 offen offset:0
    buffer_load_ushort v229, v244, s[20:23], 0 offen offset:256
    buffer_load_ushort v230, v244, s[20:23], 0 offen offset:512
    buffer_load_ushort v231, v244, s[20:23], 0 offen offset:768
    buffer_load_ushort v232, v244, s[20:23], 0 offen offset:1024
Lp0l_3:
    s_mov_b32 s12, s50
    s_mov_b32 s13, s51
    s_mov_b32 s14, 1280
    s_mov_b32 s15, 0x20000
    s_mov_b32 s8, s58
    s_mov_b32 s9, s59
    s_mov_b32 s10, 25165824
    s_mov_b32 s11, 0x20000
    buffer_load_dword v242, v246, s[8:11], 0 offen sc1
    s_barrier
    s_mov_b32 s4, s32
    s_mov_b32 s5, s33
    s_mov_b32 s6, 2621440
    s_mov_b32 s7, 0x20000
    v_lshrrev_b32 v245, 4, v1
    v_and_b32 v246, 15, v1
    s_lshl_b32 s78, s63, 3
    s_add_u32 s78, s78, s65
    s_mul_i32 s78, s78, 10240
    v_mul_u32_u24 v245, 1280, v245
    v_lshl_add_u32 v245, v246, 4, v245
    v_add_u32 v246, 5120, v245
    buffer_load_dwordx4 v[8:11], v245, s[4:7], s78 offen offset:0
    buffer_load_dwordx4 v[12:15], v245, s[4:7], s78 offen offset:256
    buffer_load_dwordx4 v[16:19], v245, s[4:7], s78 offen offset:512
    buffer_load_dwordx4 v[20:23], v245, s[4:7], s78 offen offset:768
    buffer_load_dwordx4 v[24:27], v245, s[4:7], s78 offen offset:1024
    buffer_load_dwordx4 v[28:31], v246, s[4:7], s78 offen offset:0
    buffer_load_dwordx4 v[32:35], v246, s[4:7], s78 offen offset:256
    buffer_load_dwordx4 v[36:39], v246, s[4:7], s78 offen offset:512
    buffer_load_dwordx4 v[40:43], v246, s[4:7], s78 offen offset:768
    buffer_load_dwordx4 v[44:47], v246, s[4:7], s78 offen offset:1024
    s_mov_b32 s24, s54
    s_mov_b32 s25, s55
    s_mov_b32 s26, 2621440
    s_mov_b32 s27, 0x20000
    s_cmp_ge_u32 s65, 4
    s_cbranch_scc1 Lp0b_4
    s_waitcnt vmcnt(10)
    v_readfirstlane_b32 s66, v242
    v_lshlrev_b32 v228, 16, v228
    v_mul_f32 v233, 0xbfb8aa3b, v228
    v_lshlrev_b32 v229, 16, v229
    v_mul_f32 v234, 0xbfb8aa3b, v229
    v_lshlrev_b32 v230, 16, v230
    v_mul_f32 v235, 0xbfb8aa3b, v230
    v_lshlrev_b32 v231, 16, v231
    v_mul_f32 v236, 0xbfb8aa3b, v231
    v_lshlrev_b32 v232, 16, v232
    v_mul_f32 v237, 0xbfb8aa3b, v232
    v_exp_f32 v233, v233
    v_exp_f32 v234, v234
    v_exp_f32 v235, v235
    v_exp_f32 v236, v236
    v_exp_f32 v237, v237
    s_add_u32 s66, s66, 1
    s_cmp_eq_u32 s66, 0
    s_cselect_b32 s66, 1, s66
    v_add_f32 v233, 1.0, v233
    v_add_f32 v234, 1.0, v234
    v_add_f32 v235, 1.0, v235
    v_add_f32 v236, 1.0, v236
    v_add_f32 v237, 1.0, v237
    v_rcp_f32 v233, v233
    v_rcp_f32 v234, v234
    v_rcp_f32 v235, v235
    v_rcp_f32 v236, v236
    v_rcp_f32 v237, v237
    v_mul_f32 v233, v228, v233
    v_mul_f32 v234, v229, v234
    v_mul_f32 v235, v230, v235
    v_mul_f32 v236, v231, v236
    v_mul_f32 v237, v232, v237
    v_cvt_pk_bf16_f32 v238, v233, 0
    v_cvt_pk_bf16_f32 v239, 0, v233
    v_dot2_f32_bf16 v244, v208, v238, 0
    v_dot2_f32_bf16 v245, v208, v239, 0
    v_dot2_f32_bf16 v246, v209, v238, 0
    v_dot2_f32_bf16 v247, v209, v239, 0
    v_dot2_f32_bf16 v248, v210, v238, 0
    v_dot2_f32_bf16 v249, v210, v239, 0
    v_dot2_f32_bf16 v250, v211, v238, 0
    v_dot2_f32_bf16 v251, v211, v239, 0
    v_cvt_pk_bf16_f32 v238, v234, 0
    v_cvt_pk_bf16_f32 v239, 0, v234
    v_dot2_f32_bf16 v244, v212, v238, v244
    v_dot2_f32_bf16 v245, v212, v239, v245
    v_dot2_f32_bf16 v246, v213, v238, v246
    v_dot2_f32_bf16 v247, v213, v239, v247
    v_dot2_f32_bf16 v248, v214, v238, v248
    v_dot2_f32_bf16 v249, v214, v239, v249
    v_dot2_f32_bf16 v250, v215, v238, v250
    v_dot2_f32_bf16 v251, v215, v239, v251
    v_cvt_pk_bf16_f32 v238, v235, 0
    v_cvt_pk_bf16_f32 v239, 0, v235
    v_dot2_f32_bf16 v244, v216, v238, v244
    v_dot2_f32_bf16 v245, v216, v239, v245
    v_dot2_f32_bf16 v246, v217, v238, v246
    v_dot2_f32_bf16 v247, v217, v239, v247
    v_dot2_f32_bf16 v248, v218, v238, v248
    v_dot2_f32_bf16 v249, v218, v239, v249
    v_dot2_f32_bf16 v250, v219, v238, v250
    v_dot2_f32_bf16 v251, v219, v239, v251
    v_cvt_pk_bf16_f32 v238, v236, 0
    v_cvt_pk_bf16_f32 v239, 0, v236
    v_dot2_f32_bf16 v244, v220, v238, v244
    v_dot2_f32_bf16 v245, v220, v239, v245
    v_dot2_f32_bf16 v246, v221, v238, v246
    v_dot2_f32_bf16 v247, v221, v239, v247
    v_dot2_f32_bf16 v248, v222, v238, v248
    v_dot2_f32_bf16 v249, v222, v239, v249
    v_dot2_f32_bf16 v250, v223, v238, v250
    v_dot2_f32_bf16 v251, v223, v239, v251
    v_cvt_pk_bf16_f32 v238, v237, 0
    v_cvt_pk_bf16_f32 v239, 0, v237
    v_dot2_f32_bf16 v244, v224, v238, v244
    v_dot2_f32_bf16 v245, v224, v239, v245
    v_dot2_f32_bf16 v246, v225, v238, v246
    v_dot2_f32_bf16 v247, v225, v239, v247
    v_dot2_f32_bf16 v248, v226, v238, v248
    v_dot2_f32_bf16 v249, v226, v239, v249
    v_dot2_f32_bf16 v250, v227, v238, v250
    v_dot2_f32_bf16 v251, v227, v239, v251
    v_add_f32_dpp v244, v244, v244 row_shr:1 row_mask:0xf bank_mask:0xf bound_ctrl:0
    v_add_f32_dpp v245, v245, v245 row_shr:1 row_mask:0xf bank_mask:0xf bound_ctrl:0
    v_add_f32_dpp v246, v246, v246 row_shr:1 row_mask:0xf bank_mask:0xf bound_ctrl:0
    v_add_f32_dpp v247, v247, v247 row_shr:1 row_mask:0xf bank_mask:0xf bound_ctrl:0
    v_add_f32_dpp v248, v248, v248 row_shr:1 row_mask:0xf bank_mask:0xf bound_ctrl:0
    v_add_f32_dpp v249, v249, v249 row_shr:1 row_mask:0xf bank_mask:0xf bound_ctrl:0
    v_add_f32_dpp v250, v250, v250 row_shr:1 row_mask:0xf bank_mask:0xf bound_ctrl:0
    v_add_f32_dpp v251, v251, v251 row_shr:1 row_mask:0xf bank_mask:0xf bound_ctrl:0
    v_add_f32_dpp v244, v244, v244 row_shr:2 row_mask:0xf bank_mask:0xf bound_ctrl:0
    v_add_f32_dpp v245, v245, v245 row_shr:2 row_mask:0xf bank_mask:0xf bound_ctrl:0
    v_add_f32_dpp v246, v246, v246 row_shr:2 row_mask:0xf bank_mask:0xf bound_ctrl:0
    v_add_f32_dpp v247, v247, v247 row_shr:2 row_mask:0xf bank_mask:0xf bound_ctrl:0
    v_add_f32_dpp v248, v248, v248 row_shr:2 row_mask:0xf bank_mask:0xf bound_ctrl:0
    v_add_f32_dpp v249, v249, v249 row_shr:2 row_mask:0xf bank_mask:0xf bound_ctrl:0
    v_add_f32_dpp v250, v250, v250 row_shr:2 row_mask:0xf bank_mask:0xf bound_ctrl:0
    v_add_f32_dpp v251, v251, v251 row_shr:2 row_mask:0xf bank_mask:0xf bound_ctrl:0
    v_add_f32_dpp v244, v244, v244 row_shr:4 row_mask:0xf bank_mask:0xf bound_ctrl:0
    v_add_f32_dpp v245, v245, v245 row_shr:4 row_mask:0xf bank_mask:0xf bound_ctrl:0
    v_add_f32_dpp v246, v246, v246 row_shr:4 row_mask:0xf bank_mask:0xf bound_ctrl:0
    v_add_f32_dpp v247, v247, v247 row_shr:4 row_mask:0xf bank_mask:0xf bound_ctrl:0
    v_add_f32_dpp v248, v248, v248 row_shr:4 row_mask:0xf bank_mask:0xf bound_ctrl:0
    v_add_f32_dpp v249, v249, v249 row_shr:4 row_mask:0xf bank_mask:0xf bound_ctrl:0
    v_add_f32_dpp v250, v250, v250 row_shr:4 row_mask:0xf bank_mask:0xf bound_ctrl:0
    v_add_f32_dpp v251, v251, v251 row_shr:4 row_mask:0xf bank_mask:0xf bound_ctrl:0
    v_add_f32_dpp v244, v244, v244 row_shr:8 row_mask:0xf bank_mask:0xf bound_ctrl:0
    v_add_f32_dpp v245, v245, v245 row_shr:8 row_mask:0xf bank_mask:0xf bound_ctrl:0
    v_add_f32_dpp v246, v246, v246 row_shr:8 row_mask:0xf bank_mask:0xf bound_ctrl:0
    v_add_f32_dpp v247, v247, v247 row_shr:8 row_mask:0xf bank_mask:0xf bound_ctrl:0
    v_add_f32_dpp v248, v248, v248 row_shr:8 row_mask:0xf bank_mask:0xf bound_ctrl:0
    v_add_f32_dpp v249, v249, v249 row_shr:8 row_mask:0xf bank_mask:0xf bound_ctrl:0
    v_add_f32_dpp v250, v250, v250 row_shr:8 row_mask:0xf bank_mask:0xf bound_ctrl:0
    v_add_f32_dpp v251, v251, v251 row_shr:8 row_mask:0xf bank_mask:0xf bound_ctrl:0
    v_add_f32_dpp v244, v244, v244 row_bcast:15 row_mask:0xa bank_mask:0xf
    v_add_f32_dpp v245, v245, v245 row_bcast:15 row_mask:0xa bank_mask:0xf
    v_add_f32_dpp v246, v246, v246 row_bcast:15 row_mask:0xa bank_mask:0xf
    v_add_f32_dpp v247, v247, v247 row_bcast:15 row_mask:0xa bank_mask:0xf
    v_add_f32_dpp v248, v248, v248 row_bcast:15 row_mask:0xa bank_mask:0xf
    v_add_f32_dpp v249, v249, v249 row_bcast:15 row_mask:0xa bank_mask:0xf
    v_add_f32_dpp v250, v250, v250 row_bcast:15 row_mask:0xa bank_mask:0xf
    v_add_f32_dpp v251, v251, v251 row_bcast:15 row_mask:0xa bank_mask:0xf
    v_lshrrev_b32 v252, 5, v1
    s_lshl_b32 s72, s65, 2
    s_add_u32 s72, s72, 160000
    v_lshl_add_u32 v252, v252, 7, s72
    s_mov_b32 exec_lo, 0x80000000
    s_mov_b32 exec_hi, 0x80000000
    ds_write_b32 v252, v244 offset:0
    ds_write_b32 v252, v245 offset:16
    ds_write_b32 v252, v246 offset:32
    ds_write_b32 v252, v247 offset:48
    ds_write_b32 v252, v248 offset:64
    ds_write_b32 v252, v249 offset:80
    ds_write_b32 v252, v250 offset:96
    ds_write_b32 v252, v251 offset:112
    s_mov_b64 exec, 1
    v_mov_b32 v252, 160512
    v_mov_b32 v253, 1
    s_waitcnt lgkmcnt(0)
    ds_add_u32 v252, v253
    s_mov_b64 exec, -1
    s_cmp_lg_u32 s65, 0
    s_cbranch_scc1 Lp0e_6
    s_cmp_ge_u32 s60, 240
    s_cbranch_scc1 Lp0e_6
    v_mov_b32 v252, 160512
Lp0s_7:
    ds_read_b32 v253, v252
    s_waitcnt lgkmcnt(0)
    v_readfirstlane_b32 s90, v253
    s_nop 3
    s_cmp_lt_u32 s90, 4
    s_cbranch_scc1 Lp0s_7
    v_and_b32 v246, 15, v1
    v_lshlrev_b32 v246, 4, v246
    v_add_u32 v246, 160000, v246
    ds_read_b128 v[244:247], v246
    s_mov_b32 s72, 0
    s_cmp_ge_u32 s60, 40
    s_cselect_b32 s72, 1.0, s72
    s_cmp_ge_u32 s60, 80
    s_cselect_b32 s72, 0, s72
    s_cmp_ge_u32 s60, 160
    s_cselect_b32 s72, 1.0, s72
    s_cmp_ge_u32 s60, 200
    s_cselect_b32 s72, 0, s72
    s_waitcnt lgkmcnt(0)
    v_add_f32 v244, v244, v245
    v_add_f32 v246, v246, v247
    v_add_f32 v244, v244, v246
    v_cvt_pk_bf16_f32 v244, v244, v244
    v_and_b32 v244, 0xffff0000, v244
    v_add_f32 v244, s72, v244
    v_cvt_pk_bf16_f32 v244, v244, v244
    v_and_b32 v244, 0xffff0000, v244
    s_nop 1
    v_mov_b32_dpp v245, v244 quad_perm:[1,0,3,2] row_mask:0xf bank_mask:0xf
    v_lshrrev_b32 v247, 16, v244
    v_or_b32 v248, v247, v245
    v_lshlrev_b32 v246, 2, v1
    v_mov_b32 v249, s66
    s_cmp_ge_u32 s60, 80
    s_cbranch_scc1 Lp0r_8
    s_lshl_b32 s71, s60, 6
    s_add_u32 s71, s71, 40960
    s_mov_b32 exec_lo, 0x5555
    s_mov_b32 exec_hi, 0
    buffer_store_dwordx2 v[248:249], v246, s[8:11], s71 offen sc1
    s_mov_b64 exec, -1
    s_branch Lp0e_6
Lp0r_8:
    s_sub_u32 s71, s60, 80
    s_lshl_b32 s72, s71, 6
    s_add_u32 s72, s72, 49152
    s_mov_b32 exec_lo, 0xffff
    s_mov_b32 exec_hi, 0
    buffer_store_dword v244, v246, s[8:11], s72 offen sc1
    s_cmp_lt_u32 s60, 120
    s_cbranch_scc1 Lmodb_9
    s_cmp_ge_u32 s60, 200
    s_cbranch_scc1 Lmodb_9
    s_sub_u32 s72, s60, 120
    s_lshl_b32 s72, s72, 5
    s_add_u32 s72, s72, 59392
    v_lshlrev_b32 v246, 1, v1
    s_mov_b32 exec_lo, 0x5555
    buffer_store_dword v248, v246, s[8:11], s72 offen sc1
Lmodb_9:
    s_lshl_b32 s72, s71, 2
    s_add_u32 s72, s72, 8192
    s_waitcnt vmcnt(0)
    s_mov_b64 exec, 1
    buffer_store_dword v249, v1, s[8:11], s72 offen sc1
    s_mov_b64 exec, -1
Lp0e_6:
    s_branch Lp0x_5
Lp0b_4:
    s_mov_b32 s70, 0x1999999a
    v_add_u32 v248, 0, v1
    v_mul_hi_u32 v249, v248, s70
    v_mul_u32_u24 v250, 1120, v249
    v_lshl_add_u32 v250, v248, 4, v250
    v_add_u32 v3, 4096, v250
    v_add_u32 v248, 64, v1
    v_mul_hi_u32 v249, v248, s70
    v_mul_u32_u24 v250, 1120, v249
    v_lshl_add_u32 v250, v248, 4, v250
    v_add_u32 v4, 3072, v250
    v_add_u32 v248, 128, v1
    v_mul_hi_u32 v249, v248, s70
    v_mul_u32_u24 v250, 1120, v249
    v_lshl_add_u32 v250, v248, 4, v250
    v_add_u32 v5, 2048, v250
    v_add_u32 v248, 192, v1
    v_mul_hi_u32 v249, v248, s70
    v_mul_u32_u24 v250, 1120, v249
    v_lshl_add_u32 v250, v248, 4, v250
    v_add_u32 v6, 1024, v250
    v_add_u32 v248, 256, v1
    v_mul_hi_u32 v249, v248, s70
    v_mul_u32_u24 v250, 1120, v249
    v_lshl_add_u32 v250, v248, 4, v250
    v_add_u32 v7, 4096, v250
    s_sub_u32 s12, s34, 4096
    s_subb_u32 s13, s35, 0
    s_mov_b32 s14, 823296
    s_mov_b32 s15, 0x20000
    s_mul_i32 s73, s69, 40960
    s_mul_i32 s74, s64, 160
    s_add_u32 s73, s73, s74
    s_mul_i32 s74, s69, 5120
    s_mov_b32 s76, s74
    s_add_u32 s74, s76, 0
    s_mov_b32 m0, s74
    s_nop 0
    buffer_load_dwordx4 v3, s[12:15], s73 offen offset:0 lds
    buffer_load_dwordx4 v4, s[12:15], s73 offen offset:1024 lds
    buffer_load_dwordx4 v5, s[12:15], s73 offen offset:2048 lds
    buffer_load_dwordx4 v6, s[12:15], s73 offen offset:3072 lds
    s_add_u32 m0, s74, 4096
    s_nop 0
    buffer_load_dwordx4 v7, s[12:15], s73 offen lds
    s_add_u32 s73, s73, 163840
    s_add_u32 s74, s76, 20480
    s_mov_b32 m0, s74
    s_nop 0
    buffer_load_dwordx4 v3, s[12:15], s73 offen offset:0 lds
    buffer_load_dwordx4 v4, s[12:15], s73 offen offset:1024 lds
    buffer_load_dwordx4 v5, s[12:15], s73 offen offset:2048 lds
    buffer_load_dwordx4 v6, s[12:15], s73 offen offset:3072 lds
    s_add_u32 m0, s74, 4096
    s_nop 0
    buffer_load_dwordx4 v7, s[12:15], s73 offen lds
    s_add_u32 s73, s73, 163840
    s_cmp_eq_u32 s69, 3
    s_cselect_b32 s75, 25600, 0
    s_add_u32 s74, s76, 40960
    s_add_u32 s74, s74, s75
    s_mov_b32 m0, s74
    s_nop 0
    buffer_load_dwordx4 v3, s[12:15], s73 offen offset:0 lds
    buffer_load_dwordx4 v4, s[12:15], s73 offen offset:1024 lds
    buffer_load_dwordx4 v5, s[12:15], s73 offen offset:2048 lds
    buffer_load_dwordx4 v6, s[12:15], s73 offen offset:3072 lds
    s_add_u32 m0, s74, 4096
    s_nop 0
    buffer_load_dwordx4 v7, s[12:15], s73 offen lds
    s_add_u32 s73, s73, 163840
    s_add_u32 s74, s76, 87040
    s_mov_b32 m0, s74
    s_nop 0
    buffer_load_dwordx4 v3, s[12:15], s73 offen offset:0 lds
    buffer_load_dwordx4 v4, s[12:15], s73 offen offset:1024 lds
    buffer_load_dwordx4 v5, s[12:15], s73 offen offset:2048 lds
    buffer_load_dwordx4 v6, s[12:15], s73 offen offset:3072 lds
    s_add_u32 m0, s74, 4096
    s_nop 0
    buffer_load_dwordx4 v7, s[12:15], s73 offen lds
    s_add_u32 s73, s73, 163840
    s_add_u32 s74, s76, 107520
    s_mov_b32 m0, s74
    s_nop 0
    buffer_load_dwordx4 v3, s[12:15], s73 offen offset:0 lds
    buffer_load_dwordx4 v4, s[12:15], s73 offen offset:1024 lds
    buffer_load_dwordx4 v5, s[12:15], s73 offen offset:2048 lds
    buffer_load_dwordx4 v6, s[12:15], s73 offen offset:3072 lds
    s_add_u32 m0, s74, 4096
    s_nop 0
    buffer_load_dwordx4 v7, s[12:15], s73 offen lds
    s_cmp_lt_u32 s64, 4
    s_cselect_b32 s20, s36, s38
    s_cselect_b32 s21, s37, s39
    s_mov_b32 s22, 25600
    s_mov_b32 s23, 0x20000
    s_lshl_b32 s73, s69, 12
    s_add_u32 s74, s73, 128000
    s_mov_b32 m0, s74
    s_nop 0
    buffer_load_dwordx4 v2, s[20:23], s73 offen offset:0 lds
    buffer_load_dwordx4 v2, s[20:23], s73 offen offset:1024 lds
    buffer_load_dwordx4 v2, s[20:23], s73 offen offset:2048 lds
    buffer_load_dwordx4 v2, s[20:23], s73 offen offset:3072 lds
    s_cmp_ge_u32 s69, 2
    s_cbranch_scc1 Lkv_10
    s_add_u32 s73, s73, 16384
    s_add_u32 s74, s74, 16384
    s_mov_b32 m0, s74
    s_nop 0
    buffer_load_dwordx4 v2, s[20:23], s73 offen offset:0 lds
    buffer_load_dwordx4 v2, s[20:23], s73 offen offset:1024 lds
    buffer_load_dwordx4 v2, s[20:23], s73 offen offset:2048 lds
    buffer_load_dwordx4 v2, s[20:23], s73 offen offset:3072 lds
    s_branch Lkv_11
Lkv_10:
    s_mov_b32 s73, 24576
    s_mov_b32 s74, 152576
    s_mov_b32 m0, s74
    s_nop 0
    buffer_load_dwordx4 v2, s[20:23], s73 offen offset:0 lds
Lkv_11:
    s_waitcnt vmcnt(40)
    v_readfirstlane_b32 s66, v242
    s_nop 3
    s_add_u32 s66, s66, 1
    s_cmp_eq_u32 s66, 0
    s_cselect_b32 s66, 1, s66
Lp0x_5:
    s_cmp_ge_u32 s65, 4
    s_cbranch_scc1 Lls_12
    s_waitcnt vmcnt(0)
    s_branch Lls_13
Lls_12:
    s_waitcnt vmcnt(30)
Lls_13:
    v_mov_b32 v240, 0x3f803f80
    v_dot2_f32_bf16 v232, v8, v240, 0
    v_dot2_f32_bf16 v236, v8, v8, 0
    v_dot2_f32_bf16 v234, v28, v240, 0
    v_dot2_f32_bf16 v238, v28, v28, 0
    v_dot2_f32_bf16 v233, v9, v240, 0
    v_dot2_f32_bf16 v237, v9, v9, 0
    v_dot2_f32_bf16 v235, v29, v240, 0
    v_dot2_f32_bf16 v239, v29, v29, 0
    v_dot2_f32_bf16 v232, v10, v240, v232
    v_dot2_f32_bf16 v236, v10, v10, v236
    v_dot2_f32_bf16 v234, v30, v240, v234
    v_dot2_f32_bf16 v238, v30, v30, v238
    v_dot2_f32_bf16 v233, v11, v240, v233
    v_dot2_f32_bf16 v237, v11, v11, v237
    v_dot2_f32_bf16 v235, v31, v240, v235
    v_dot2_f32_bf16 v239, v31, v31, v239
    v_dot2_f32_bf16 v232, v12, v240, v232
    v_dot2_f32_bf16 v236, v12, v12, v236
    v_dot2_f32_bf16 v234, v32, v240, v234
    v_dot2_f32_bf16 v238, v32, v32, v238
    v_dot2_f32_bf16 v233, v13, v240, v233
    v_dot2_f32_bf16 v237, v13, v13, v237
    v_dot2_f32_bf16 v235, v33, v240, v235
    v_dot2_f32_bf16 v239, v33, v33, v239
    v_dot2_f32_bf16 v232, v14, v240, v232
    v_dot2_f32_bf16 v236, v14, v14, v236
    v_dot2_f32_bf16 v234, v34, v240, v234
    v_dot2_f32_bf16 v238, v34, v34, v238
    v_dot2_f32_bf16 v233, v15, v240, v233
    v_dot2_f32_bf16 v237, v15, v15, v237
    v_dot2_f32_bf16 v235, v35, v240, v235
    v_dot2_f32_bf16 v239, v35, v35, v239
    v_dot2_f32_bf16 v232, v16, v240, v232
    v_dot2_f32_bf16 v236, v16, v16, v236
    v_dot2_f32_bf16 v234, v36, v240, v234
    v_dot2_f32_bf16 v238, v36, v36, v238
    v_dot2_f32_bf16 v233, v17, v240, v233
    v_dot2_f32_bf16 v237, v17, v17, v237
    v_dot2_f32_bf16 v235, v37, v240, v235
    v_dot2_f32_bf16 v239, v37, v37, v239
    v_dot2_f32_bf16 v232, v18, v240, v232
    v_dot2_f32_bf16 v236, v18, v18, v236
    v_dot2_f32_bf16 v234, v38, v240, v234
    v_dot2_f32_bf16 v238, v38, v38, v238
    v_dot2_f32_bf16 v233, v19, v240, v233
    v_dot2_f32_bf16 v237, v19, v19, v237
    v_dot2_f32_bf16 v235, v39, v240, v235
    v_dot2_f32_bf16 v239, v39, v39, v239
    v_dot2_f32_bf16 v232, v20, v240, v232
    v_dot2_f32_bf16 v236, v20, v20, v236
    v_dot2_f32_bf16 v234, v40, v240, v234
    v_dot2_f32_bf16 v238, v40, v40, v238
    v_dot2_f32_bf16 v233, v21, v240, v233
    v_dot2_f32_bf16 v237, v21, v21, v237
    v_dot2_f32_bf16 v235, v41, v240, v235
    v_dot2_f32_bf16 v239, v41, v41, v239
    v_dot2_f32_bf16 v232, v22, v240, v232
    v_dot2_f32_bf16 v236, v22, v22, v236
    v_dot2_f32_bf16 v234, v42, v240, v234
    v_dot2_f32_bf16 v238, v42, v42, v238
    v_dot2_f32_bf16 v233, v23, v240, v233
    v_dot2_f32_bf16 v237, v23, v23, v237
    v_dot2_f32_bf16 v235, v43, v240, v235
    v_dot2_f32_bf16 v239, v43, v43, v239
    v_dot2_f32_bf16 v232, v24, v240, v232
    v_dot2_f32_bf16 v236, v24, v24, v236
    v_dot2_f32_bf16 v234, v44, v240, v234
    v_dot2_f32_bf16 v238, v44, v44, v238
    v_dot2_f32_bf16 v233, v25, v240, v233
    v_dot2_f32_bf16 v237, v25, v25, v237
    v_dot2_f32_bf16 v235, v45, v240, v235
    v_dot2_f32_bf16 v239, v45, v45, v239
    v_dot2_f32_bf16 v232, v26, v240, v232
    v_dot2_f32_bf16 v236, v26, v26, v236
    v_dot2_f32_bf16 v234, v46, v240, v234
    v_dot2_f32_bf16 v238, v46, v46, v238
    v_dot2_f32_bf16 v233, v27, v240, v233
    v_dot2_f32_bf16 v237, v27, v27, v237
    v_dot2_f32_bf16 v235, v47, v240, v235
    v_dot2_f32_bf16 v239, v47, v47, v239
    v_add_f32 v232, v232, v233
    s_nop 0
    v_add_f32 v234, v234, v235
    v_add_f32 v236, v236, v237
    v_add_f32 v238, v238, v239
    v_add_f32_dpp v232, v232, v232 row_ror:8 row_mask:0xf bank_mask:0xf
    v_add_f32_dpp v234, v234, v234 row_ror:8 row_mask:0xf bank_mask:0xf
    v_add_f32_dpp v236, v236, v236 row_ror:8 row_mask:0xf bank_mask:0xf
    v_add_f32_dpp v238, v238, v238 row_ror:8 row_mask:0xf bank_mask:0xf
    v_add_f32_dpp v232, v232, v232 row_ror:4 row_mask:0xf bank_mask:0xf
    v_add_f32_dpp v234, v234, v234 row_ror:4 row_mask:0xf bank_mask:0xf
    v_add_f32_dpp v236, v236, v236 row_ror:4 row_mask:0xf bank_mask:0xf
    v_add_f32_dpp v238, v238, v238 row_ror:4 row_mask:0xf bank_mask:0xf
    v_add_f32_dpp v232, v232, v232 row_ror:2 row_mask:0xf bank_mask:0xf
    v_add_f32_dpp v234, v234, v234 row_ror:2 row_mask:0xf bank_mask:0xf
    v_add_f32_dpp v236, v236, v236 row_ror:2 row_mask:0xf bank_mask:0xf
    v_add_f32_dpp v238, v238, v238 row_ror:2 row_mask:0xf bank_mask:0xf
    v_add_f32_dpp v232, v232, v232 row_ror:1 row_mask:0xf bank_mask:0xf
    v_add_f32_dpp v234, v234, v234 row_ror:1 row_mask:0xf bank_mask:0xf
    v_add_f32_dpp v236, v236, v236 row_ror:1 row_mask:0xf bank_mask:0xf
    v_add_f32_dpp v238, v238, v238 row_ror:1 row_mask:0xf bank_mask:0xf
    s_mov_b32 s70, 0x3acccccd
    v_mul_f32 v232, s70, v232
    v_mul_f32 v236, s70, v236
    v_fma_f32 v236, -v232, v232, v236
    v_max_f32 v236, 0, v236
    v_add_f32 v236, 0x3727c5ac, v236
    v_rsq_f32 v242, v236
    v_mul_f32 v234, s70, v234
    v_mul_f32 v238, s70, v238
    v_fma_f32 v238, -v234, v234, v238
    v_max_f32 v238, 0, v238
    v_add_f32 v238, 0x3727c5ac, v238
    v_rsq_f32 v246, v238
    v_mov_b32 v243, v242
    v_mul_f32 v244, -v232, v242
    v_mul_f32 v245, -v232, v242
    v_mov_b32 v247, v246
    v_mul_f32 v248, -v234, v246
    v_mul_f32 v249, -v234, v246
    v_lshlrev_b32 v48, 16, v8
    v_and_b32 v49, 0xffff0000, v8
    v_lshlrev_b32 v50, 16, v9
    v_and_b32 v51, 0xffff0000, v9
    v_lshlrev_b32 v52, 16, v10
    v_and_b32 v53, 0xffff0000, v10
    v_lshlrev_b32 v54, 16, v11
    v_and_b32 v55, 0xffff0000, v11
    v_lshlrev_b32 v56, 16, v12
    v_and_b32 v57, 0xffff0000, v12
    v_lshlrev_b32 v58, 16, v13
    v_and_b32 v59, 0xffff0000, v13
    v_lshlrev_b32 v60, 16, v14
    v_and_b32 v61, 0xffff0000, v14
    v_lshlrev_b32 v62, 16, v15
    v_and_b32 v63, 0xffff0000, v15
    v_lshlrev_b32 v64, 16, v16
    v_and_b32 v65, 0xffff0000, v16
    v_lshlrev_b32 v66, 16, v17
    v_and_b32 v67, 0xffff0000, v17
    v_lshlrev_b32 v68, 16, v18
    v_and_b32 v69, 0xffff0000, v18
    v_lshlrev_b32 v70, 16, v19
    v_and_b32 v71, 0xffff0000, v19
    v_lshlrev_b32 v72, 16, v20
    v_and_b32 v73, 0xffff0000, v20
    v_lshlrev_b32 v74, 16, v21
    v_and_b32 v75, 0xffff0000, v21
    v_lshlrev_b32 v76, 16, v22
    v_and_b32 v77, 0xffff0000, v22
    v_lshlrev_b32 v78, 16, v23
    v_and_b32 v79, 0xffff0000, v23
    v_lshlrev_b32 v80, 16, v24
    v_and_b32 v81, 0xffff0000, v24
    v_lshlrev_b32 v82, 16, v25
    v_and_b32 v83, 0xffff0000, v25
    v_lshlrev_b32 v84, 16, v26
    v_and_b32 v85, 0xffff0000, v26
    v_lshlrev_b32 v86, 16, v27
    v_and_b32 v87, 0xffff0000, v27
    v_pk_fma_f32 v[48:49], v[48:49], v[242:243], v[244:245]
    v_pk_fma_f32 v[50:51], v[50:51], v[242:243], v[244:245]
    v_pk_fma_f32 v[52:53], v[52:53], v[242:243], v[244:245]
    v_pk_fma_f32 v[54:55], v[54:55], v[242:243], v[244:245]
    v_pk_fma_f32 v[56:57], v[56:57], v[242:243], v[244:245]
    v_pk_fma_f32 v[58:59], v[58:59], v[242:243], v[244:245]
    v_pk_fma_f32 v[60:61], v[60:61], v[242:243], v[244:245]
    v_pk_fma_f32 v[62:63], v[62:63], v[242:243], v[244:245]
    v_pk_fma_f32 v[64:65], v[64:65], v[242:243], v[244:245]
    v_pk_fma_f32 v[66:67], v[66:67], v[242:243], v[244:245]
    v_pk_fma_f32 v[68:69], v[68:69], v[242:243], v[244:245]
    v_pk_fma_f32 v[70:71], v[70:71], v[242:243], v[244:245]
    v_pk_fma_f32 v[72:73], v[72:73], v[242:243], v[244:245]
    v_pk_fma_f32 v[74:75], v[74:75], v[242:243], v[244:245]
    v_pk_fma_f32 v[76:77], v[76:77], v[242:243], v[244:245]
    v_pk_fma_f32 v[78:79], v[78:79], v[242:243], v[244:245]
    v_pk_fma_f32 v[80:81], v[80:81], v[242:243], v[244:245]
    v_pk_fma_f32 v[82:83], v[82:83], v[242:243], v[244:245]
    v_pk_fma_f32 v[84:85], v[84:85], v[242:243], v[244:245]
    v_pk_fma_f32 v[86:87], v[86:87], v[242:243], v[244:245]
    v_lshlrev_b32 v88, 16, v28
    v_and_b32 v89, 0xffff0000, v28
    v_lshlrev_b32 v90, 16, v29
    v_and_b32 v91, 0xffff0000, v29
    v_lshlrev_b32 v92, 16, v30
    v_and_b32 v93, 0xffff0000, v30
    v_lshlrev_b32 v94, 16, v31
    v_and_b32 v95, 0xffff0000, v31
    v_lshlrev_b32 v96, 16, v32
    v_and_b32 v97, 0xffff0000, v32
    v_lshlrev_b32 v98, 16, v33
    v_and_b32 v99, 0xffff0000, v33
    v_lshlrev_b32 v100, 16, v34
    v_and_b32 v101, 0xffff0000, v34
    v_lshlrev_b32 v102, 16, v35
    v_and_b32 v103, 0xffff0000, v35
    v_lshlrev_b32 v104, 16, v36
    v_and_b32 v105, 0xffff0000, v36
    v_lshlrev_b32 v106, 16, v37
    v_and_b32 v107, 0xffff0000, v37
    v_lshlrev_b32 v108, 16, v38
    v_and_b32 v109, 0xffff0000, v38
    v_lshlrev_b32 v110, 16, v39
    v_and_b32 v111, 0xffff0000, v39
    v_lshlrev_b32 v112, 16, v40
    v_and_b32 v113, 0xffff0000, v40
    v_lshlrev_b32 v114, 16, v41
    v_and_b32 v115, 0xffff0000, v41
    v_lshlrev_b32 v116, 16, v42
    v_and_b32 v117, 0xffff0000, v42
    v_lshlrev_b32 v118, 16, v43
    v_and_b32 v119, 0xffff0000, v43
    v_lshlrev_b32 v120, 16, v44
    v_and_b32 v121, 0xffff0000, v44
    v_lshlrev_b32 v122, 16, v45
    v_and_b32 v123, 0xffff0000, v45
    v_lshlrev_b32 v124, 16, v46
    v_and_b32 v125, 0xffff0000, v46
    v_lshlrev_b32 v126, 16, v47
    v_and_b32 v127, 0xffff0000, v47
    v_pk_fma_f32 v[88:89], v[88:89], v[246:247], v[248:249]
    v_pk_fma_f32 v[90:91], v[90:91], v[246:247], v[248:249]
    v_pk_fma_f32 v[92:93], v[92:93], v[246:247], v[248:249]
    v_pk_fma_f32 v[94:95], v[94:95], v[246:247], v[248:249]
    v_pk_fma_f32 v[96:97], v[96:97], v[246:247], v[248:249]
    v_pk_fma_f32 v[98:99], v[98:99], v[246:247], v[248:249]
    v_pk_fma_f32 v[100:101], v[100:101], v[246:247], v[248:249]
    v_pk_fma_f32 v[102:103], v[102:103], v[246:247], v[248:249]
    v_pk_fma_f32 v[104:105], v[104:105], v[246:247], v[248:249]
    v_pk_fma_f32 v[106:107], v[106:107], v[246:247], v[248:249]
    v_pk_fma_f32 v[108:109], v[108:109], v[246:247], v[248:249]
    v_pk_fma_f32 v[110:111], v[110:111], v[246:247], v[248:249]
    v_pk_fma_f32 v[112:113], v[112:113], v[246:247], v[248:249]
    v_pk_fma_f32 v[114:115], v[114:115], v[246:247], v[248:249]
    v_pk_fma_f32 v[116:117], v[116:117], v[246:247], v[248:249]
    v_pk_fma_f32 v[118:119], v[118:119], v[246:247], v[248:249]
    v_pk_fma_f32 v[120:121], v[120:121], v[246:247], v[248:249]
    v_pk_fma_f32 v[122:123], v[122:123], v[246:247], v[248:249]
    v_pk_fma_f32 v[124:125], v[124:125], v[246:247], v[248:249]
    v_pk_fma_f32 v[126:127], v[126:127], v[246:247], v[248:249]
    s_movk_i32 s89, 160
    v_lshrrev_b32 v8, 5, v1
    v_bfe_u32 v9, v1, 2, 2
    v_lshl_add_u32 v8, v8, 3, v9
    v_bfe_u32 v9, v1, 4, 1
    v_lshlrev_b32 v9, 5, v9
    v_mad_u32_u24 v8, v8, s89, v9
    v_and_b32 v9, 3, v1
    v_lshl_add_u32 v8, v9, 3, v8
    s_mul_i32 s70, s69, 40
    s_add_u32 s70, s70, 0
    v_add_u32 v8, s70, v8
    s_cmp_lt_u32 s65, 4
    s_cbranch_scc1 Lwr_14
    s_waitcnt vmcnt(0)
Lwr_14:
    s_barrier
    ds_read_b64_tr_b16 v[128:129], v8 offset:0
    ds_read_b64_tr_b16 v[130:131], v8 offset:640
    ds_read_b64_tr_b16 v[132:133], v8 offset:2560
    ds_read_b64_tr_b16 v[134:135], v8 offset:3200
    ds_read_b64_tr_b16 v[136:137], v8 offset:5120
    ds_read_b64_tr_b16 v[138:139], v8 offset:5760
    ds_read_b64_tr_b16 v[140:141], v8 offset:7680
    ds_read_b64_tr_b16 v[142:143], v8 offset:8320
    ds_read_b64_tr_b16 v[144:145], v8 offset:10240
    ds_read_b64_tr_b16 v[146:147], v8 offset:10880
    ds_read_b64_tr_b16 v[148:149], v8 offset:12800
    ds_read_b64_tr_b16 v[150:151], v8 offset:13440
    ds_read_b64_tr_b16 v[152:153], v8 offset:15360
    ds_read_b64_tr_b16 v[154:155], v8 offset:16000
    ds_read_b64_tr_b16 v[156:157], v8 offset:17920
    ds_read_b64_tr_b16 v[158:159], v8 offset:18560
    ds_read_b64_tr_b16 v[160:161], v8 offset:20480
    ds_read_b64_tr_b16 v[162:163], v8 offset:21120
    ds_read_b64_tr_b16 v[164:165], v8 offset:23040
    ds_read_b64_tr_b16 v[166:167], v8 offset:23680
    ds_read_b64_tr_b16 v[168:169], v8 offset:25600
    ds_read_b64_tr_b16 v[170:171], v8 offset:26240
    ds_read_b64_tr_b16 v[172:173], v8 offset:28160
    ds_read_b64_tr_b16 v[174:175], v8 offset:28800
    ds_read_b64_tr_b16 v[176:177], v8 offset:30720
    ds_read_b64_tr_b16 v[178:179], v8 offset:31360
    ds_read_b64_tr_b16 v[180:181], v8 offset:33280
    ds_read_b64_tr_b16 v[182:183], v8 offset:33920
    ds_read_b64_tr_b16 v[184:185], v8 offset:35840
    ds_read_b64_tr_b16 v[186:187], v8 offset:36480
    ds_read_b64_tr_b16 v[188:189], v8 offset:38400
    ds_read_b64_tr_b16 v[190:191], v8 offset:39040
    ds_read_b64_tr_b16 v[192:193], v8 offset:40960
    ds_read_b64_tr_b16 v[194:195], v8 offset:41600
    ds_read_b64_tr_b16 v[196:197], v8 offset:43520
    ds_read_b64_tr_b16 v[198:199], v8 offset:44160
    ds_read_b64_tr_b16 v[200:201], v8 offset:46080
    ds_read_b64_tr_b16 v[202:203], v8 offset:46720
    ds_read_b64_tr_b16 v[204:205], v8 offset:48640
    ds_read_b64_tr_b16 v[206:207], v8 offset:49280
    ds_read_b64_tr_b16 v[208:209], v8 offset:51200
    ds_read_b64_tr_b16 v[210:211], v8 offset:51840
    ds_read_b64_tr_b16 v[212:213], v8 offset:53760
    ds_read_b64_tr_b16 v[214:215], v8 offset:54400
    v_and_b32 v8, 15, v1
    v_lshlrev_b32 v9, 5, v8
    v_add_u32 v9, 153600, v9
    v_lshrrev_b32 v10, 4, v1
    s_lshl_b32 s70, s65, 3
    v_add_u32 v10, s70, v10
    v_and_b32 v11, 15, v10
    v_xor_b32 v11, v11, v8
    v_lshlrev_b32 v11, 4, v11
    v_mul_u32_u24 v12, 1280, v10
    v_add_u32 v12, v12, v11
    v_add_u32 v10, 4, v10
    v_and_b32 v11, 15, v10
    v_xor_b32 v11, v11, v8
    v_lshlrev_b32 v11, 4, v11
    v_mul_u32_u24 v13, 1280, v10
    v_add_u32 v13, v13, v11
    s_and_b32 s70, s64, 3
    s_lshl_b32 s70, s70, 4
    v_and_b32 v232, 15, v1
    v_lshrrev_b32 v233, 4, v1
    v_add_u32 v234, s70, v232
    v_mul_u32_u24 v234, 1280, v234
    s_lshr_b32 s71, s65, 1
    s_mul_i32 s72, s71, 5
    s_lshl_b32 s73, s72, 2
    v_add_u32 v235, s73, v233
    v_add_u32 v236, 0, v235
    v_xor_b32 v236, v236, v232
    v_lshl_add_u32 v240, v236, 4, v234
    v_add_u32 v236, 4, v235
    v_xor_b32 v236, v236, v232
    v_lshl_add_u32 v241, v236, 4, v234
    v_add_u32 v236, 8, v235
    v_xor_b32 v236, v236, v232
    v_lshl_add_u32 v242, v236, 4, v234
    v_add_u32 v236, 12, v235
    v_xor_b32 v236, v236, v232
    v_lshl_add_u32 v243, v236, 4, v234
    v_add_u32 v236, 16, v235
    v_xor_b32 v236, v236, v232
    v_lshl_add_u32 v244, v236, 4, v234
    v_bfe_u32 v236, v1, 2, 2
    v_lshl_add_u32 v236, v233, 3, v236
    v_mul_u32_u24 v236, 40, v236
    v_and_b32 v237, 3, v1
    v_lshl_add_u32 v236, v237, 3, v236
    s_and_b32 s73, s65, 1
    s_lshl_b32 s73, s73, 5
    s_mul_i32 s74, s72, 1280
    s_add_u32 s73, s73, s74
    s_add_u32 s73, s73, 128000
    v_add_u32 v236, s73, v236
    s_lshl_b32 s73, s72, 6
    s_add_u32 s73, s73, 158720
    v_lshl_add_u32 v237, v233, 4, s73
    s_lshl_b32 s70, s97, 5
    v_and_b32 v238, 31, v1
    v_add_u32 v238, s70, v238
    v_and_b32 v239, 15, v238
    v_mul_u32_u24 v238, 1280, v238
    v_lshrrev_b32 v226, 5, v1
    v_xor_b32 v239, v239, v226
    v_xor_b32 v227, 0, v239
    v_lshl_add_u32 v216, v227, 4, v238
    v_xor_b32 v227, 2, v239
    v_lshl_add_u32 v217, v227, 4, v238
    v_xor_b32 v227, 4, v239
    v_lshl_add_u32 v218, v227, 4, v238
    v_xor_b32 v227, 6, v239
    v_lshl_add_u32 v219, v227, 4, v238
    v_xor_b32 v227, 8, v239
    v_lshl_add_u32 v220, v227, 4, v238
    v_xor_b32 v227, 10, v239
    v_lshl_add_u32 v221, v227, 4, v238
    v_xor_b32 v227, 12, v239
    v_lshl_add_u32 v222, v227, 4, v238
    v_xor_b32 v227, 14, v239
    v_lshl_add_u32 v223, v227, 4, v238
    v_lshrrev_b32 v224, 5, v1
    v_bfe_u32 v225, v1, 2, 2
    v_lshl_add_u32 v224, v224, 3, v225
    v_bfe_u32 v225, v1, 4, 1
    v_lshlrev_b32 v225, 5, v225
    v_mad_u32_u24 v224, v224, s89, v225
    v_and_b32 v225, 3, v1
    v_lshl_add_u32 v224, v225, 3, v224
    s_mul_i32 s70, s69, 40
    s_add_u32 s70, s70, 81920
    v_add_u32 v224, s70, v224
    s_cmp_ge_u32 s65, 5
    s_cbranch_scc1 Lmp_15
    v_lshlrev_b32 v15, 4, v0
    s_mov_b32 s71, 40960
    s_mov_b32 s90, 0
Lpoll_16:
    buffer_load_dwordx4 v[16:19], v15, s[8:11], s71 offen sc1
    s_waitcnt vmcnt(0)
    v_cmp_ne_u32 vcc, s66, v17
    v_cmp_ne_u32 s[92:93], s66, v19
    s_nop 3
    s_or_b64 vcc, vcc, s[92:93]
    s_cbranch_vccz Lpdone_17
    s_add_u32 s90, s90, 1
    s_cmp_lt_u32 s90, 400000
    s_cbranch_scc1 Lpoll_16
    v_mov_b32 v254, 1
    v_mov_b32 v255, 0
    s_mov_b32 s20, s56
    s_mov_b32 s21, s57
    s_mov_b32 s22, 256
    s_mov_b32 s23, 0x20000
    buffer_store_dword v254, v255, s[20:23], 0 offen
Lpdone_17:
    v_lshlrev_b32 v20, 16, v16
    v_and_b32 v21, 0xffff0000, v16
    v_lshlrev_b32 v22, 16, v18
    v_and_b32 v23, 0xffff0000, v18
    v_add_u32 v24, 153600, v15
    ds_write_b128 v24, v[20:23]
    v_xor_b32 v16, 0x80008000, v16
    v_xor_b32 v17, 0x80008000, v18
    v_lshrrev_b32 v24, 1, v15
    v_add_u32 v24, 158720, v24
    v_cmp_gt_u32 vcc, 160, v0
    s_nop 3
    s_and_saveexec_b64 s[92:93], vcc
    ds_write_b64 v24, v[16:17]
    s_mov_b64 exec, -1
Lmp_15:
    s_waitcnt lgkmcnt(0)
    s_barrier
    ds_read_b128 v[16:19], v9 offset:0
    ds_read_b128 v[20:23], v9 offset:16
    ds_read_b128 v[24:27], v9 offset:2560
    ds_read_b128 v[28:31], v9 offset:2576
    ds_read_b128 v[32:35], v9 offset:512
    ds_read_b128 v[36:39], v9 offset:528
    ds_read_b128 v[40:43], v9 offset:3072
    ds_read_b128 v[44:47], v9 offset:3088
    s_waitcnt lgkmcnt(4)
    v_pk_fma_f32 v[48:49], v[48:49], v[24:25], v[16:17]
    v_pk_fma_f32 v[50:51], v[50:51], v[26:27], v[18:19]
    v_pk_fma_f32 v[52:53], v[52:53], v[28:29], v[20:21]
    v_pk_fma_f32 v[54:55], v[54:55], v[30:31], v[22:23]
    v_pk_fma_f32 v[88:89], v[88:89], v[24:25], v[16:17]
    v_pk_fma_f32 v[90:91], v[90:91], v[26:27], v[18:19]
    v_pk_fma_f32 v[92:93], v[92:93], v[28:29], v[20:21]
    v_pk_fma_f32 v[94:95], v[94:95], v[30:31], v[22:23]
    v_cvt_pk_bf16_f32 v48, v48, v49
    v_cvt_pk_bf16_f32 v49, v50, v51
    v_cvt_pk_bf16_f32 v50, v52, v53
    v_cvt_pk_bf16_f32 v51, v54, v55
    ds_write_b128 v12, v[48:51] offset:0
    v_cvt_pk_bf16_f32 v88, v88, v89
    v_cvt_pk_bf16_f32 v89, v90, v91
    v_cvt_pk_bf16_f32 v90, v92, v93
    v_cvt_pk_bf16_f32 v91, v94, v95
    ds_write_b128 v13, v[88:91] offset:0
    ds_read_b128 v[16:19], v9 offset:1024
    ds_read_b128 v[20:23], v9 offset:1040
    ds_read_b128 v[24:27], v9 offset:3584
    ds_read_b128 v[28:31], v9 offset:3600
    s_waitcnt lgkmcnt(6)
    v_pk_fma_f32 v[56:57], v[56:57], v[40:41], v[32:33]
    v_pk_fma_f32 v[58:59], v[58:59], v[42:43], v[34:35]
    v_pk_fma_f32 v[60:61], v[60:61], v[44:45], v[36:37]
    v_pk_fma_f32 v[62:63], v[62:63], v[46:47], v[38:39]
    v_pk_fma_f32 v[96:97], v[96:97], v[40:41], v[32:33]
    v_pk_fma_f32 v[98:99], v[98:99], v[42:43], v[34:35]
    v_pk_fma_f32 v[100:101], v[100:101], v[44:45], v[36:37]
    v_pk_fma_f32 v[102:103], v[102:103], v[46:47], v[38:39]
    v_cvt_pk_bf16_f32 v56, v56, v57
    v_cvt_pk_bf16_f32 v57, v58, v59
    v_cvt_pk_bf16_f32 v58, v60, v61
    v_cvt_pk_bf16_f32 v59, v62, v63
    ds_write_b128 v12, v[56:59] offset:256
    v_cvt_pk_bf16_f32 v96, v96, v97
    v_cvt_pk_bf16_f32 v97, v98, v99
    v_cvt_pk_bf16_f32 v98, v100, v101
    v_cvt_pk_bf16_f32 v99, v102, v103
    ds_write_b128 v13, v[96:99] offset:256
    ds_read_b128 v[32:35], v9 offset:1536
    ds_read_b128 v[36:39], v9 offset:1552
    ds_read_b128 v[40:43], v9 offset:4096
    ds_read_b128 v[44:47], v9 offset:4112
    s_waitcnt lgkmcnt(6)
    v_pk_fma_f32 v[64:65], v[64:65], v[24:25], v[16:17]
    v_pk_fma_f32 v[66:67], v[66:67], v[26:27], v[18:19]
    v_pk_fma_f32 v[68:69], v[68:69], v[28:29], v[20:21]
    v_pk_fma_f32 v[70:71], v[70:71], v[30:31], v[22:23]
    v_pk_fma_f32 v[104:105], v[104:105], v[24:25], v[16:17]
    v_pk_fma_f32 v[106:107], v[106:107], v[26:27], v[18:19]
    v_pk_fma_f32 v[108:109], v[108:109], v[28:29], v[20:21]
    v_pk_fma_f32 v[110:111], v[110:111], v[30:31], v[22:23]
    v_cvt_pk_bf16_f32 v64, v64, v65
    v_cvt_pk_bf16_f32 v65, v66, v67
    v_cvt_pk_bf16_f32 v66, v68, v69
    v_cvt_pk_bf16_f32 v67, v70, v71
    ds_write_b128 v12, v[64:67] offset:512
    v_cvt_pk_bf16_f32 v104, v104, v105
    v_cvt_pk_bf16_f32 v105, v106, v107
    v_cvt_pk_bf16_f32 v106, v108, v109
    v_cvt_pk_bf16_f32 v107, v110, v111
    ds_write_b128 v13, v[104:107] offset:512
    ds_read_b128 v[16:19], v9 offset:2048
    ds_read_b128 v[20:23], v9 offset:2064
    ds_read_b128 v[24:27], v9 offset:4608
    ds_read_b128 v[28:31], v9 offset:4624
    s_waitcnt lgkmcnt(6)
    v_pk_fma_f32 v[72:73], v[72:73], v[40:41], v[32:33]
    v_pk_fma_f32 v[74:75], v[74:75], v[42:43], v[34:35]
    v_pk_fma_f32 v[76:77], v[76:77], v[44:45], v[36:37]
    v_pk_fma_f32 v[78:79], v[78:79], v[46:47], v[38:39]
    v_pk_fma_f32 v[112:113], v[112:113], v[40:41], v[32:33]
    v_pk_fma_f32 v[114:115], v[114:115], v[42:43], v[34:35]
    v_pk_fma_f32 v[116:117], v[116:117], v[44:45], v[36:37]
    v_pk_fma_f32 v[118:119], v[118:119], v[46:47], v[38:39]
    v_cvt_pk_bf16_f32 v72, v72, v73
    v_cvt_pk_bf16_f32 v73, v74, v75
    v_cvt_pk_bf16_f32 v74, v76, v77
    v_cvt_pk_bf16_f32 v75, v78, v79
    ds_write_b128 v12, v[72:75] offset:768
    v_cvt_pk_bf16_f32 v112, v112, v113
    v_cvt_pk_bf16_f32 v113, v114, v115
    v_cvt_pk_bf16_f32 v114, v116, v117
    v_cvt_pk_bf16_f32 v115, v118, v119
    ds_write_b128 v13, v[112:115] offset:768
    s_waitcnt lgkmcnt(2)
    v_pk_fma_f32 v[80:81], v[80:81], v[24:25], v[16:17]
    v_pk_fma_f32 v[82:83], v[82:83], v[26:27], v[18:19]
    v_pk_fma_f32 v[84:85], v[84:85], v[28:29], v[20:21]
    v_pk_fma_f32 v[86:87], v[86:87], v[30:31], v[22:23]
    v_pk_fma_f32 v[120:121], v[120:121], v[24:25], v[16:17]
    v_pk_fma_f32 v[122:123], v[122:123], v[26:27], v[18:19]
    v_pk_fma_f32 v[124:125], v[124:125], v[28:29], v[20:21]
    v_pk_fma_f32 v[126:127], v[126:127], v[30:31], v[22:23]
    v_cvt_pk_bf16_f32 v80, v80, v81
    v_cvt_pk_bf16_f32 v81, v82, v83
    v_cvt_pk_bf16_f32 v82, v84, v85
    v_cvt_pk_bf16_f32 v83, v86, v87
    ds_write_b128 v12, v[80:83] offset:1024
    v_cvt_pk_bf16_f32 v120, v120, v121
    v_cvt_pk_bf16_f32 v121, v122, v123
    v_cvt_pk_bf16_f32 v122, v124, v125
    v_cvt_pk_bf16_f32 v123, v126, v127
    ds_write_b128 v13, v[120:123] offset:1024
    s_waitcnt vmcnt(0) lgkmcnt(0)
    s_barrier
    ds_read_b64_tr_b16 v[32:33], v236 offset:0
    ds_read_b64_tr_b16 v[34:35], v236 offset:160
    ds_read_b128 v[52:55], v240 offset:0
    ds_read_b64_tr_b16 v[36:37], v236 offset:1280
    ds_read_b64_tr_b16 v[38:39], v236 offset:1440
    ds_read_b128 v[56:59], v241 offset:0
    ds_read_b64_tr_b16 v[40:41], v236 offset:2560
    ds_read_b64_tr_b16 v[42:43], v236 offset:2720
    ds_read_b128 v[60:63], v242 offset:0
    ds_read_b64_tr_b16 v[44:45], v236 offset:3840
    ds_read_b64_tr_b16 v[46:47], v236 offset:4000
    ds_read_b128 v[64:67], v243 offset:0
    ds_read_b64_tr_b16 v[48:49], v236 offset:5120
    ds_read_b64_tr_b16 v[50:51], v236 offset:5280
    ds_read_b128 v[68:71], v244 offset:0
    s_cmp_ge_u32 s64, 4
    s_cbranch_scc1 Lvproj_18
    s_waitcnt lgkmcnt(0)
    ds_read_b128 v[72:75], v237 offset:0
    ds_read_b128 v[76:79], v237 offset:64
    ds_read_b128 v[80:83], v237 offset:128
    ds_read_b128 v[84:87], v237 offset:192
    ds_read_b128 v[88:91], v237 offset:256
    v_mfma_f32_16x16x32_bf16 v[28:31], v[32:35], v[52:55], 0
    v_mfma_f32_16x16x32_bf16 v[28:31], v[36:39], v[56:59], v[28:31]
    v_mfma_f32_16x16x32_bf16 v[28:31], v[40:43], v[60:63], v[28:31]
    v_mfma_f32_16x16x32_bf16 v[28:31], v[44:47], v[64:67], v[28:31]
    v_mfma_f32_16x16x32_bf16 v[28:31], v[48:51], v[68:71], v[28:31]
    s_waitcnt lgkmcnt(0)
    v_mfma_f32_16x16x32_bf16 v[28:31], v[32:35], v[72:75], v[28:31]
    v_mfma_f32_16x16x32_bf16 v[28:31], v[36:39], v[76:79], v[28:31]
    v_mfma_f32_16x16x32_bf16 v[28:31], v[40:43], v[80:83], v[28:31]
    v_mfma_f32_16x16x32_bf16 v[28:31], v[44:47], v[84:87], v[28:31]
    v_mfma_f32_16x16x32_bf16 v[28:31], v[48:51], v[88:91], v[28:31]
    s_branch Lkvj_19
Lvproj_18:
    s_waitcnt lgkmcnt(0)
    v_mfma_f32_16x16x32_bf16 v[28:31], v[52:55], v[32:35], 0
    v_mfma_f32_16x16x32_bf16 v[28:31], v[56:59], v[36:39], v[28:31]
    v_mfma_f32_16x16x32_bf16 v[28:31], v[60:63], v[40:43], v[28:31]
    v_mfma_f32_16x16x32_bf16 v[28:31], v[64:67], v[44:47], v[28:31]
    v_mfma_f32_16x16x32_bf16 v[28:31], v[68:71], v[48:51], v[28:31]
Lkvj_19:
    s_add_u32 s73, s29, 128000
    v_add_u32 v18, s73, v2
    s_barrier
    s_nop 4
    ds_write_b128 v18, v[28:31]
    s_waitcnt lgkmcnt(0)
    s_barrier
    s_cmp_ge_u32 s65, 2
    s_cbranch_scc1 Lkvend_20
    ds_read_b128 v[32:35], v18 offset:2048
    ds_read_b128 v[36:39], v18 offset:4096
    ds_read_b128 v[40:43], v18 offset:6144
    s_and_b32 s72, s64, 3
    s_lshr_b32 s72, s72, 1
    s_lshl_b32 s73, s63, 1
    s_add_u32 s72, s72, s73
    s_mul_i32 s72, s72, 3328
    s_add_u32 s72, s72, 131072
    s_and_b32 s73, s64, 1
    s_lshl_b32 s73, s73, 4
    s_waitcnt lgkmcnt(0)
    v_add_f32 v32, v32, v36
    v_add_f32 v28, v28, v40
    v_add_f32 v33, v33, v37
    v_add_f32 v29, v29, v41
    v_add_f32 v34, v34, v38
    v_add_f32 v30, v30, v42
    v_add_f32 v35, v35, v39
    v_add_f32 v31, v31, v43
    v_add_f32 v28, v28, v32
    v_add_f32 v29, v29, v33
    v_add_f32 v30, v30, v34
    v_add_f32 v31, v31, v35
    v_cvt_pk_bf16_f32 v24, v28, v29
    v_cvt_pk_bf16_f32 v25, v30, v31
    s_cmp_ge_u32 s64, 4
    s_cbranch_scc1 Lv2_21
    v_dot2_f32_bf16 v26, v24, v24, 0
    v_dot2_f32_bf16 v26, v25, v25, v26
    s_cmp_eq_u32 s65, 1
    s_cbranch_scc1 Lw1_23
    s_nop 0
    v_mov_b32 v27, v26
    s_nop 1
    v_permlane32_swap_b32 v26, v27
    v_add_f32 v26, v26, v27
    v_mov_b32 v27, v26
    s_nop 1
    v_permlane16_swap_b32 v26, v27
    v_add_f32 v26, v26, v27
    v_add_u32 v30, s73, v232
    v_and_b32 v31, 1, v233
    v_lshl_add_u32 v30, v31, 5, v30
    v_lshlrev_b32 v30, 4, v30
    v_lshrrev_b32 v31, 1, v233
    v_lshl_add_u32 v30, v31, 3, v30
    buffer_store_dwordx2 v[24:25], v30, s[8:11], s72 offen sc1
    s_branch Lj2_22
Lw1_23:
    v_cmp_gt_u32 vcc, 16, v1
    s_nop 1
    v_cndmask_b32 v26, 0, v26, vcc
    v_add_u32 v30, s73, v232
    v_lshlrev_b32 v30, 3, v30
    s_mov_b32 exec_lo, 0xffff
    s_mov_b32 exec_hi, 0
    buffer_store_dwordx2 v[24:25], v30, s[8:11], s72 offen offset:3072 sc1
    s_mov_b64 exec, -1
    s_branch Lj2_22
Lv2_21:
    v_max_f32 v26, |v28|, |v29|
    v_max_f32 v27, |v30|, |v31|
    v_max_f32 v26, v26, v27
    s_lshl_b32 s71, s65, 4
    v_add_u32 v27, s71, v232
    v_cmp_gt_u32 vcc, 20, v27
    s_nop 1
    v_cndmask_b32 v26, 0, v26, vcc
    v_mov_b32 v28, 0x3f803f80
    v_and_b32 v29, 27, v27
    v_cmp_eq_u32 vcc, 20, v27
    v_cmp_eq_u32 s[92:93], 24, v27
    s_nop 3
    s_or_b64 vcc, vcc, s[92:93]
    v_cndmask_b32 v24, v24, v28, vcc
    v_cndmask_b32 v25, v25, v28, vcc
    s_lshl_b32 s73, s73, 6
    s_add_u32 s72, s72, s73
    v_and_b32 v31, 1, v233
    v_lshl_add_u32 v30, v31, 5, v27
    v_lshlrev_b32 v30, 4, v30
    v_lshrrev_b32 v31, 1, v233
    v_lshl_add_u32 v30, v31, 3, v30
    buffer_store_dwordx2 v[24:25], v30, s[8:11], s72 offen offset:1024 sc1
Lj2_22:
    v_max_f32_dpp v26, v26, v26 row_ror:8 row_mask:0xf bank_mask:0xf
    s_nop 1
    v_max_f32_dpp v26, v26, v26 row_ror:4 row_mask:0xf bank_mask:0xf
    s_nop 1
    v_max_f32_dpp v26, v26, v26 row_ror:2 row_mask:0xf bank_mask:0xf
    s_nop 1
    v_max_f32_dpp v26, v26, v26 row_ror:1 row_mask:0xf bank_mask:0xf
    v_mov_b32 v27, v26
    s_nop 1
    v_permlane32_swap_b32 v26, v27
    v_max_f32 v26, v26, v27
    v_mov_b32 v27, v26
    s_nop 1
    v_permlane16_swap_b32 v26, v27
    v_max_f32 v26, v26, v27
    s_lshl_b32 s72, s60, 4
    s_lshl_b32 s73, s65, 3
    s_add_u32 s72, s72, s73
    s_add_u32 s72, s72, 4096
    v_mov_b32 v28, s66
    v_mov_b32 v29, v26
    v_mov_b32 v30, 0
    s_waitcnt vmcnt(0)
    s_mov_b64 exec, 1
    buffer_store_dwordx2 v[28:29], v30, s[8:11], s72 offen sc1
    s_mov_b64 exec, -1
Lkvend_20:
    ds_read_b128 v[48:51], v216 offset:0
    ds_read_b128 v[52:55], v217 offset:0
    ds_read_b128 v[56:59], v218 offset:0
    s_waitcnt lgkmcnt(2)
    v_mfma_f32_32x32x16_bf16 v[16:31], v[128:131], v[48:51], 0
    ds_read_b128 v[48:51], v219 offset:0
    s_waitcnt lgkmcnt(2)
    v_mfma_f32_32x32x16_bf16 v[16:31], v[132:135], v[52:55], v[16:31]
    ds_read_b128 v[52:55], v220 offset:0
    s_waitcnt lgkmcnt(2)
    v_mfma_f32_32x32x16_bf16 v[16:31], v[136:139], v[56:59], v[16:31]
    ds_read_b128 v[56:59], v221 offset:0
    s_waitcnt lgkmcnt(2)
    v_mfma_f32_32x32x16_bf16 v[16:31], v[140:143], v[48:51], v[16:31]
    ds_read_b128 v[48:51], v222 offset:0
    s_waitcnt lgkmcnt(2)
    v_mfma_f32_32x32x16_bf16 v[16:31], v[144:147], v[52:55], v[16:31]
    ds_read_b128 v[52:55], v223 offset:0
    s_waitcnt lgkmcnt(2)
    v_mfma_f32_32x32x16_bf16 v[16:31], v[148:151], v[56:59], v[16:31]
    ds_read_b128 v[56:59], v216 offset:256
    s_waitcnt lgkmcnt(2)
    v_mfma_f32_32x32x16_bf16 v[16:31], v[152:155], v[48:51], v[16:31]
    ds_read_b128 v[48:51], v217 offset:256
    s_waitcnt lgkmcnt(2)
    v_mfma_f32_32x32x16_bf16 v[16:31], v[156:159], v[52:55], v[16:31]
    ds_read_b128 v[52:55], v218 offset:256
    s_waitcnt lgkmcnt(2)
    v_mfma_f32_32x32x16_bf16 v[16:31], v[160:163], v[56:59], v[16:31]
    ds_read_b128 v[56:59], v219 offset:256
    s_waitcnt lgkmcnt(2)
    v_mfma_f32_32x32x16_bf16 v[16:31], v[164:167], v[48:51], v[16:31]
    ds_read_b128 v[48:51], v220 offset:256
    s_waitcnt lgkmcnt(2)
    v_mfma_f32_32x32x16_bf16 v[16:31], v[168:171], v[52:55], v[16:31]
    ds_read_b128 v[52:55], v221 offset:256
    s_waitcnt lgkmcnt(2)
    v_mfma_f32_32x32x16_bf16 v[16:31], v[172:175], v[56:59], v[16:31]
    ds_read_b128 v[56:59], v222 offset:256
    s_waitcnt lgkmcnt(2)
    v_mfma_f32_32x32x16_bf16 v[16:31], v[176:179], v[48:51], v[16:31]
    ds_read_b128 v[48:51], v223 offset:256
    s_waitcnt lgkmcnt(2)
    v_mfma_f32_32x32x16_bf16 v[16:31], v[180:183], v[52:55], v[16:31]
    ds_read_b128 v[52:55], v216 offset:512
    s_waitcnt lgkmcnt(2)
    v_mfma_f32_32x32x16_bf16 v[16:31], v[184:187], v[56:59], v[16:31]
    ds_read_b128 v[56:59], v217 offset:512
    s_waitcnt lgkmcnt(2)
    v_mfma_f32_32x32x16_bf16 v[16:31], v[188:191], v[48:51], v[16:31]
    ds_read_b128 v[48:51], v218 offset:512
    s_waitcnt lgkmcnt(2)
    v_mfma_f32_32x32x16_bf16 v[16:31], v[192:195], v[52:55], v[16:31]
    ds_read_b128 v[52:55], v219 offset:512
    s_waitcnt lgkmcnt(2)
    v_mfma_f32_32x32x16_bf16 v[16:31], v[196:199], v[56:59], v[16:31]
    ds_read_b128 v[56:59], v220 offset:512
    s_waitcnt lgkmcnt(2)
    v_mfma_f32_32x32x16_bf16 v[16:31], v[200:203], v[48:51], v[16:31]
    ds_read_b128 v[48:51], v221 offset:512
    s_waitcnt lgkmcnt(2)
    v_mfma_f32_32x32x16_bf16 v[16:31], v[204:207], v[52:55], v[16:31]
    ds_read_b128 v[52:55], v222 offset:512
    ds_read_b64_tr_b16 v[68:69], v224 offset:0
    ds_read_b64_tr_b16 v[70:71], v224 offset:640
    s_waitcnt lgkmcnt(4)
    v_mfma_f32_32x32x16_bf16 v[16:31], v[208:211], v[56:59], v[16:31]
    ds_read_b128 v[56:59], v223 offset:512
    ds_read_b64_tr_b16 v[72:73], v224 offset:2560
    ds_read_b64_tr_b16 v[74:75], v224 offset:3200
    s_waitcnt lgkmcnt(6)
    v_mfma_f32_32x32x16_bf16 v[16:31], v[212:215], v[48:51], v[16:31]
    ds_read_b128 v[48:51], v216 offset:768
    ds_read_b64_tr_b16 v[64:65], v224 offset:5120
    ds_read_b64_tr_b16 v[66:67], v224 offset:5760
    s_waitcnt lgkmcnt(6)
    v_mfma_f32_32x32x16_bf16 v[16:31], v[68:71], v[52:55], v[16:31]
    ds_read_b128 v[52:55], v217 offset:768
    ds_read_b64_tr_b16 v[68:69], v224 offset:7680
    ds_read_b64_tr_b16 v[70:71], v224 offset:8320
    s_waitcnt lgkmcnt(6)
    v_mfma_f32_32x32x16_bf16 v[16:31], v[72:75], v[56:59], v[16:31]
    ds_read_b128 v[56:59], v218 offset:768
    ds_read_b64_tr_b16 v[72:73], v224 offset:10240
    ds_read_b64_tr_b16 v[74:75], v224 offset:10880
    s_waitcnt lgkmcnt(6)
    v_mfma_f32_32x32x16_bf16 v[16:31], v[64:67], v[48:51], v[16:31]
    ds_read_b128 v[48:51], v219 offset:768
    ds_read_b64_tr_b16 v[64:65], v224 offset:12800
    ds_read_b64_tr_b16 v[66:67], v224 offset:13440
    s_waitcnt lgkmcnt(6)
    v_mfma_f32_32x32x16_bf16 v[16:31], v[68:71], v[52:55], v[16:31]
    ds_read_b128 v[52:55], v220 offset:768
    ds_read_b64_tr_b16 v[68:69], v224 offset:15360
    ds_read_b64_tr_b16 v[70:71], v224 offset:16000
    s_waitcnt lgkmcnt(6)
    v_mfma_f32_32x32x16_bf16 v[16:31], v[72:75], v[56:59], v[16:31]
    ds_read_b128 v[56:59], v221 offset:768
    ds_read_b64_tr_b16 v[72:73], v224 offset:17920
    ds_read_b64_tr_b16 v[74:75], v224 offset:18560
    s_waitcnt lgkmcnt(6)
    v_mfma_f32_32x32x16_bf16 v[16:31], v[64:67], v[48:51], v[16:31]
    ds_read_b128 v[48:51], v222 offset:768
    ds_read_b64_tr_b16 v[64:65], v224 offset:20480
    ds_read_b64_tr_b16 v[66:67], v224 offset:21120
    s_waitcnt lgkmcnt(6)
    v_mfma_f32_32x32x16_bf16 v[16:31], v[68:71], v[52:55], v[16:31]
    ds_read_b128 v[52:55], v223 offset:768
    ds_read_b64_tr_b16 v[68:69], v224 offset:23040
    ds_read_b64_tr_b16 v[70:71], v224 offset:23680
    s_waitcnt lgkmcnt(6)
    v_mfma_f32_32x32x16_bf16 v[16:31], v[72:75], v[56:59], v[16:31]
    ds_read_b128 v[56:59], v216 offset:1024
    ds_read_b64_tr_b16 v[72:73], v224 offset:25600
    ds_read_b64_tr_b16 v[74:75], v224 offset:26240
    s_waitcnt lgkmcnt(6)
    v_mfma_f32_32x32x16_bf16 v[16:31], v[64:67], v[48:51], v[16:31]
    ds_read_b128 v[48:51], v217 offset:1024
    ds_read_b64_tr_b16 v[64:65], v224 offset:28160
    ds_read_b64_tr_b16 v[66:67], v224 offset:28800
    s_waitcnt lgkmcnt(6)
    v_mfma_f32_32x32x16_bf16 v[16:31], v[68:71], v[52:55], v[16:31]
    ds_read_b128 v[52:55], v218 offset:1024
    ds_read_b64_tr_b16 v[68:69], v224 offset:30720
    ds_read_b64_tr_b16 v[70:71], v224 offset:31360
    s_waitcnt lgkmcnt(6)
    v_mfma_f32_32x32x16_bf16 v[16:31], v[72:75], v[56:59], v[16:31]
    ds_read_b128 v[56:59], v219 offset:1024
    ds_read_b64_tr_b16 v[72:73], v224 offset:33280
    ds_read_b64_tr_b16 v[74:75], v224 offset:33920
    s_waitcnt lgkmcnt(6)
    v_mfma_f32_32x32x16_bf16 v[16:31], v[64:67], v[48:51], v[16:31]
    ds_read_b128 v[48:51], v220 offset:1024
    ds_read_b64_tr_b16 v[64:65], v224 offset:35840
    ds_read_b64_tr_b16 v[66:67], v224 offset:36480
    s_waitcnt lgkmcnt(6)
    v_mfma_f32_32x32x16_bf16 v[16:31], v[68:71], v[52:55], v[16:31]
    ds_read_b128 v[52:55], v221 offset:1024
    ds_read_b64_tr_b16 v[68:69], v224 offset:38400
    ds_read_b64_tr_b16 v[70:71], v224 offset:39040
    s_waitcnt lgkmcnt(6)
    v_mfma_f32_32x32x16_bf16 v[16:31], v[72:75], v[56:59], v[16:31]
    ds_read_b128 v[56:59], v222 offset:1024
    ds_read_b64_tr_b16 v[72:73], v224 offset:40960
    ds_read_b64_tr_b16 v[74:75], v224 offset:41600
    s_waitcnt lgkmcnt(6)
    v_mfma_f32_32x32x16_bf16 v[16:31], v[64:67], v[48:51], v[16:31]
    ds_read_b128 v[48:51], v223 offset:1024
    ds_read_b64_tr_b16 v[64:65], v224 offset:43520
    ds_read_b64_tr_b16 v[66:67], v224 offset:44160
    s_waitcnt lgkmcnt(6)
    v_mfma_f32_32x32x16_bf16 v[16:31], v[68:71], v[52:55], v[16:31]
    s_waitcnt lgkmcnt(3)
    v_mfma_f32_32x32x16_bf16 v[16:31], v[72:75], v[56:59], v[16:31]
    s_waitcnt lgkmcnt(0)
    v_mfma_f32_32x32x16_bf16 v[16:31], v[64:67], v[48:51], v[16:31]
    s_mov_b32 s70, 0x3ea52b8e
    s_nop 10
    v_mul_f32 v16, s70, v16
    v_mul_f32 v17, s70, v17
    v_mul_f32 v18, s70, v18
    v_mul_f32 v19, s70, v19
    v_mul_f32 v20, s70, v20
    v_mul_f32 v21, s70, v21
    v_mul_f32 v22, s70, v22
    v_mul_f32 v23, s70, v23
    v_mul_f32 v24, s70, v24
    v_mul_f32 v25, s70, v25
    v_mul_f32 v26, s70, v26
    v_mul_f32 v27, s70, v27
    v_cvt_pk_bf16_f32 v8, v16, v17
    v_cvt_pk_bf16_f32 v9, v18, v19
    v_cvt_pk_bf16_f32 v10, v20, v21
    v_cvt_pk_bf16_f32 v11, v22, v23
    v_cvt_pk_bf16_f32 v12, v24, v25
    v_cvt_pk_bf16_f32 v13, v26, v27
    v_cmp_gt_u32 vcc, 32, v1
    v_mov_b32 v14, 0
    v_mov_b32 v15, 0
    v_cndmask_b32 v12, 0, v12, vcc
    v_cndmask_b32 v13, 0, v13, vcc
    v_dot2_f32_bf16 v108, v8, v8, 0
    v_dot2_f32_bf16 v108, v9, v9, v108
    v_dot2_f32_bf16 v108, v10, v10, v108
    v_dot2_f32_bf16 v108, v11, v11, v108
    v_dot2_f32_bf16 v108, v12, v12, v108
    v_dot2_f32_bf16 v108, v13, v13, v108
    s_nop 2
    v_mov_b32 v40, v108
    s_nop 1
    v_permlane32_swap_b32 v108, v40
    v_add_f32 v108, v108, v40
    v_sqrt_f32 v108, v108
    s_waitcnt lgkmcnt(0)
    s_barrier
    s_lshl_b32 s88, s69, 12
    s_cmp_eq_u32 s69, 3
    s_cselect_b32 s88, 9216, s88
    s_add_u32 s87, s88, 131072
    s_cmp_lg_u32 s65, 3
    s_cbranch_scc1 Lkvo_24
    v_lshlrev_b32 v111, 6, v1
    s_mov_b32 s71, 4096
    s_mov_b32 s90, 0
Lkvp_25:
    buffer_load_dwordx4 v[112:115], v111, s[8:11], s71 offen offset:0 sc1
    buffer_load_dwordx4 v[116:119], v111, s[8:11], s71 offen offset:16 sc1
    buffer_load_dwordx4 v[120:123], v111, s[8:11], s71 offen offset:32 sc1
    buffer_load_dwordx4 v[124:127], v111, s[8:11], s71 offen offset:48 sc1
    s_waitcnt vmcnt(0)
    v_xor_b32 v128, s66, v112
    v_xor_b32 v129, s66, v114
    v_xor_b32 v130, s66, v116
    v_xor_b32 v131, s66, v118
    v_or3_b32 v128, v128, v130, v131
    v_xor_b32 v130, s66, v120
    v_xor_b32 v131, s66, v122
    v_or3_b32 v128, v128, v130, v131
    v_xor_b32 v130, s66, v124
    v_xor_b32 v131, s66, v126
    v_or3_b32 v128, v128, v130, v131
    v_or_b32 v128, v128, v129
    v_cmp_ne_u32 vcc, 0, v128
    s_nop 4
    s_cbranch_vccz Lkvd_26
    s_add_u32 s90, s90, 1
    s_cmp_lt_u32 s90, 400000
    s_cbranch_scc1 Lkvp_25
    v_mov_b32 v254, 2
    v_mov_b32 v255, 0
    s_mov_b32 s20, s56
    s_mov_b32 s21, s57
    s_mov_b32 s22, 256
    s_mov_b32 s23, 0x20000
    buffer_store_dword v254, v255, s[20:23], 0 offen
Lkvd_26:
    v_max3_f32 v113, v113, v117, v121
    v_max3_f32 v115, v115, v119, v123
    v_max_f32 v113, v113, v125
    v_max_f32 v115, v115, v127
    s_nop 0
    v_max_f32_dpp v113, v113, v113 row_ror:8 row_mask:0xf bank_mask:0xf
    v_max_f32_dpp v115, v115, v115 row_ror:8 row_mask:0xf bank_mask:0xf
    s_nop 0
    v_max_f32_dpp v113, v113, v113 row_ror:4 row_mask:0xf bank_mask:0xf
    v_max_f32_dpp v115, v115, v115 row_ror:4 row_mask:0xf bank_mask:0xf
    s_nop 0
    v_max_f32_dpp v113, v113, v113 row_ror:2 row_mask:0xf bank_mask:0xf
    v_max_f32_dpp v115, v115, v115 row_ror:2 row_mask:0xf bank_mask:0xf
    v_mov_b32 v114, v113
    s_nop 1
    v_permlane32_swap_b32 v113, v114
    v_max_f32 v113, v113, v114
    v_mov_b32 v114, v113
    s_nop 1
    v_permlane16_swap_b32 v113, v114
    v_max_f32 v113, v113, v114
    v_mov_b32 v116, v115
    s_nop 1
    v_permlane32_swap_b32 v115, v116
    v_max_f32 v115, v115, v116
    v_mov_b32 v116, v115
    s_nop 1
    v_permlane16_swap_b32 v115, v116
    v_max_f32 v115, v115, v116
    v_lshlrev_b32 v114, 3, v1
    v_add_u32 v114, 162880, v114
    v_mov_b32 v112, v113
    v_mov_b32 v113, v115
    s_mov_b64 exec, 3
    ds_write_b64 v114, v[112:113]
    s_mov_b64 exec, -1
    s_waitcnt lgkmcnt(0)
Lkvo_24:
    s_cmp_lt_u32 s65, 4
    s_cbranch_scc1 Lrs_27
    s_lshl_b32 s72, s60, 2
    s_add_u32 s72, s72, s69
    s_lshl_b32 s42, s72, 12
    s_add_u32 s42, s42, 16777216
    s_mov_b32 s73, 10
    s_mov_b32 s80, 0x1999999a
    s_movk_i32 s81, 1280
    s_cmp_ge_u32 s72, 200
    s_cbranch_scc1 Lrp_28
    s_mul_hi_u32 s31, s72, 171798692
    s_mul_i32 s82, s31, 25
    s_sub_u32 s72, s72, s82
    s_mul_i32 s31, s31, 160
    s_mov_b32 s16, s40
    s_mov_b32 s17, s41
    s_mov_b32 s18, 819200
    s_branch Lrp_30
Lrp_28:
    s_cmp_ge_u32 s72, 744
    s_cbranch_scc1 Lrp_29
    s_sub_u32 s72, s72, 200
    s_mul_hi_u32 s31, s72, 63161284
    s_mul_i32 s82, s31, 68
    s_sub_u32 s72, s72, s82
    s_mul_i32 s31, s31, 160
    s_mov_b32 s16, s48
    s_mov_b32 s17, s49
    s_mov_b32 s18, 2211840
    s_branch Lrp_30
Lrp_29:
    s_sub_u32 s72, s72, 744
    s_mul_hi_u32 s31, s72, 122713352
    s_mul_i32 s82, s31, 35
    s_sub_u32 s72, s72, s82
    s_bitcmp1_b32 s31, 0
    s_cselect_b32 s16, s46, s44
    s_cselect_b32 s17, s47, s45
    s_mov_b32 s18, 2211840
    s_lshr_b32 s31, s31, 1
    s_mul_i32 s82, s31, 7
    s_mul_i32 s73, s31, 6
    s_add_u32 s73, s73, 12
    s_min_u32 s73, s73, 101
    s_cmp_lt_u32 s31, 12
    s_cselect_b32 s31, s82, s73
    s_lshl_b32 s31, s31, 5
    s_mov_b32 s73, 14
    s_mov_b32 s80, 0x12492493
    s_movk_i32 s81, 3456
Lrp_30:
    s_mov_b32 s19, 0x20000
    s_lshl_b32 s72, s72, 8
    s_lshl_b32 s73, s73, 4
    s_sub_u32 s81, s81, s73
    v_add_u32 v112, s72, v1
    v_mul_hi_u32 v113, v112, s80
    v_mul_lo_u32 v113, v113, s81
    v_lshl_add_u32 v176, v112, 4, v113
    v_add_u32 v112, 64, v112
    v_mul_hi_u32 v113, v112, s80
    v_mul_lo_u32 v113, v113, s81
    v_lshl_add_u32 v177, v112, 4, v113
    v_add_u32 v112, 64, v112
    v_mul_hi_u32 v113, v112, s80
    v_mul_lo_u32 v113, v113, s81
    v_lshl_add_u32 v178, v112, 4, v113
    v_add_u32 v112, 64, v112
    v_mul_hi_u32 v113, v112, s80
    v_mul_lo_u32 v113, v113, s81
    v_lshl_add_u32 v179, v112, 4, v113
    s_lshl_b32 s72, s60, 2
    s_add_u32 s72, s72, s69
    s_add_u32 s72, s72, 1024
    s_mov_b32 s73, 10
    s_mov_b32 s80, 0x1999999a
    s_movk_i32 s81, 1280
    s_sub_u32 s72, s72, 744
    s_mul_hi_u32 s84, s72, 122713352
    s_mul_i32 s82, s84, 35
    s_sub_u32 s72, s72, s82
    s_bitcmp1_b32 s84, 0
    s_cselect_b32 s12, s46, s44
    s_cselect_b32 s13, s47, s45
    s_mov_b32 s14, 2211840
    s_lshr_b32 s84, s84, 1
    s_mul_i32 s82, s84, 7
    s_mul_i32 s73, s84, 6
    s_add_u32 s73, s73, 12
    s_min_u32 s73, s73, 101
    s_cmp_lt_u32 s84, 12
    s_cselect_b32 s84, s82, s73
    s_lshl_b32 s84, s84, 5
    s_mov_b32 s73, 14
    s_mov_b32 s80, 0x12492493
    s_movk_i32 s81, 3456
Lrp_33:
    s_mov_b32 s15, 0x20000
    s_lshl_b32 s72, s72, 8
    s_lshl_b32 s73, s73, 4
    s_sub_u32 s81, s81, s73
    v_add_u32 v112, s72, v1
    v_mul_hi_u32 v113, v112, s80
    v_mul_lo_u32 v113, v113, s81
    v_lshl_add_u32 v180, v112, 4, v113
    v_add_u32 v112, 64, v112
    v_mul_hi_u32 v113, v112, s80
    v_mul_lo_u32 v113, v113, s81
    v_lshl_add_u32 v181, v112, 4, v113
    v_add_u32 v112, 64, v112
    v_mul_hi_u32 v113, v112, s80
    v_mul_lo_u32 v113, v113, s81
    v_lshl_add_u32 v182, v112, 4, v113
    v_add_u32 v112, 64, v112
    v_mul_hi_u32 v113, v112, s80
    v_mul_lo_u32 v113, v113, s81
    v_lshl_add_u32 v183, v112, 4, v113
Lrs_27:
    s_mul_i32 s85, s65, 13
    s_min_u32 s85, s85, 87
    s_lshl_b32 s85, s85, 10
    s_mul_i32 s43, s64, 102400
    s_add_u32 s43, s43, s85
    s_add_u32 s43, s43, 16777216
    s_add_u32 s85, s85, 53248
    s_cmp_lt_u32 s60, 108
    s_cselect_b32 s20, s44, s46
    s_cselect_b32 s21, s45, s47
    s_mov_b32 s22, 2211840
    s_mov_b32 s23, 0x20000
    s_sub_u32 s86, s60, 108
    s_cselect_b32 s86, s60, s86
    s_lshl_b32 s86, s86, 5
    s_mul_i32 s89, s65, 3
    s_min_u32 s89, s89, 17
    s_mul_i32 s82, s89, 110592
    s_add_u32 s86, s86, s82
    s_lshl_b32 s89, s89, 10
    v_lshrrev_b32 v110, 1, v1
    v_mul_u32_u24 v110, 3456, v110
    v_and_b32 v113, 1, v1
    v_lshl_add_u32 v110, v113, 4, v110
    s_barrier
    s_cmp_ge_u32 s65, 4
    s_cbranch_scc1 Lfc_34
    s_add_u32 m0, s88, 0
    s_nop 0
    buffer_load_dwordx4 v2, s[8:11], s87 offen offset:0 sc1 lds
    buffer_load_dwordx4 v2, s[8:11], s87 offen offset:1024 sc1 lds
    s_add_u32 m0, s88, 0
    s_nop 0
    buffer_load_dwordx4 v2, s[8:11], s87 offen offset:2048 sc1 lds
    buffer_load_dwordx4 v2, s[8:11], s87 offen offset:3072 sc1 lds
    s_add_u32 s87, s87, 13312
    s_add_u32 m0, s88, 13312
    s_nop 0
    buffer_load_dwordx4 v2, s[8:11], s87 offen offset:0 sc1 lds
    buffer_load_dwordx4 v2, s[8:11], s87 offen offset:1024 sc1 lds
    s_add_u32 m0, s88, 13312
    s_nop 0
    buffer_load_dwordx4 v2, s[8:11], s87 offen offset:2048 sc1 lds
    buffer_load_dwordx4 v2, s[8:11], s87 offen offset:3072 sc1 lds
    s_add_u32 s87, s87, 13312
    s_add_u32 m0, s88, 26624
    s_nop 0
    buffer_load_dwordx4 v2, s[8:11], s87 offen offset:0 sc1 lds
    buffer_load_dwordx4 v2, s[8:11], s87 offen offset:1024 sc1 lds
    s_add_u32 m0, s88, 26624
    s_nop 0
    buffer_load_dwordx4 v2, s[8:11], s87 offen offset:2048 sc1 lds
    buffer_load_dwordx4 v2, s[8:11], s87 offen offset:3072 sc1 lds
    s_add_u32 s87, s87, 13312
Lfc_34:
    v_mov_b32 v114, 162880
    ds_read_b128 v[116:119], v114
    s_waitcnt lgkmcnt(0)
    v_add_f32 v113, v116, v117
    v_sqrt_f32 v113, v113
    v_max_f32 v114, v118, v119
    v_mul_f32 v113, 0x3f810000, v113
    v_mul_f32 v108, v108, v113
    s_or_b32 s70, s60, s65
    s_cmp_lg_u32 s70, 0
    s_cbranch_scc1 Lgen_35
    v_mov_b32 v112, s66
    s_mov_b32 s70, 0
    s_mov_b64 exec, 1
    buffer_store_dword v112, v1, s[8:11], s70 offen sc1
    s_mov_b64 exec, -1
Lgen_35:
    v_mov_b32 v82, 0x3f803f80
    v_mov_b32 v83, 0x00003f80
    v_mov_b32 v86, 0x3f803f80
    v_mov_b32 v87, 0x00003f80
    v_and_b32 v109, 31, v1
    v_lshlrev_b32 v109, 3, v109
    s_waitcnt vmcnt(8)
    s_barrier
    ds_read_b128 v[72:75], v2 offset:0
    ds_read_b64 v[80:81], v109 offset:3072
    ds_read_b128 v[76:79], v2 offset:3328
    ds_read_b64 v[84:85], v109 offset:6400
    ds_read_b128 v[88:91], v2 offset:1024
    ds_read_b128 v[96:99], v2 offset:2048
    s_waitcnt lgkmcnt(4)
    v_mfma_f32_32x32x16_bf16 v[32:47], v[72:75], v[8:11], 0
    v_mfma_f32_32x32x16_bf16 v[32:47], v[80:83], v[12:15], v[32:47]
    v_mov_b32 v115, 0x43480000
    v_mov_b32 v116, 0x47000000
    v_cmp_nlt_f32 s[92:93], v114, v116
    s_nop 8
    v_max3_f32 v112, v32, v33, v34
    v_max3_f32 v112, v112, v35, v36
    v_max3_f32 v112, v112, v37, v38
    v_max3_f32 v112, v112, v39, v40
    v_max3_f32 v112, v112, v41, v42
    v_max3_f32 v112, v112, v43, v44
    v_max3_f32 v112, v112, v45, v46
    v_max_f32 v112, v112, v47
    v_mov_b32 v113, v112
    s_nop 1
    v_permlane32_swap_b32 v112, v113
    v_max_f32 v112, v112, v113
    v_sub_f32 v113, v108, v112
    v_cmp_nle_f32 vcc, v113, v115
    s_nop 3
    s_or_b64 vcc, vcc, s[92:93]
    s_cmp_lg_u64 vcc, 0
    s_cselect_b32 s82, 1, 0
    s_lshl_b32 s70, s65, 2
    s_add_u32 s70, s70, 162816
    v_mov_b32 v113, s70
    v_mov_b32 v114, s82
    ds_write_b32 v113, v114
    v_add_f32 v113, 0xc2c80000, v108
    v_max_f32 v112, v112, v113
    v_mov_b32 v113, 162816
    s_waitcnt lgkmcnt(0)
    s_barrier
    ds_read_b128 v[116:119], v113
    ds_read_b128 v[120:123], v113 offset:16
    s_waitcnt lgkmcnt(0)
    v_or3_b32 v116, v116, v117, v118
    v_or3_b32 v119, v119, v120, v121
    v_or3_b32 v116, v116, v122, v123
    v_or_b32 v116, v116, v119
    s_nop 0
    v_readfirstlane_b32 s82, v116
    s_nop 3
    s_cmp_eq_u32 s82, 0
    s_cbranch_scc1 Lnofb_36
    v_mov_b32 v112, 0xff7fffff
    s_add_u32 s83, s88, 131072
    s_mov_b32 s91, 0
Lmx_37:
    s_cmp_ge_u32 s65, 4
    s_cbranch_scc1 Lmxd_38
    s_add_u32 m0, s88, 39936
    s_nop 0
    buffer_load_dwordx4 v2, s[8:11], s83 offen offset:0 sc1 lds
    buffer_load_dwordx4 v2, s[8:11], s83 offen offset:1024 sc1 lds
    s_add_u32 m0, s88, 39936
    s_nop 0
    buffer_load_dwordx4 v2, s[8:11], s83 offen offset:2048 sc1 lds
    buffer_load_dwordx4 v2, s[8:11], s83 offen offset:3072 sc1 lds
    s_add_u32 s83, s83, 13312
Lmxd_38:
    s_waitcnt vmcnt(0)
    s_barrier
    ds_read_b128 v[120:123], v2 offset:39936
    ds_read_b64 v[124:125], v109 offset:43008
    v_mov_b32 v126, 0
    v_mov_b32 v127, 0
    s_waitcnt lgkmcnt(0)
    v_mfma_f32_32x32x16_bf16 v[48:63], v[120:123], v[8:11], 0
    v_mfma_f32_32x32x16_bf16 v[48:63], v[124:127], v[12:15], v[48:63]
    s_nop 11
    v_max3_f32 v112, v112, v48, v49
    v_max3_f32 v112, v112, v50, v51
    v_max3_f32 v112, v112, v52, v53
    v_max3_f32 v112, v112, v54, v55
    v_max3_f32 v112, v112, v56, v57
    v_max3_f32 v112, v112, v58, v59
    v_max3_f32 v112, v112, v60, v61
    v_max3_f32 v112, v112, v62, v63
    ds_read_b128 v[120:123], v2 offset:43264
    ds_read_b64 v[124:125], v109 offset:46336
    v_mov_b32 v126, 0
    v_mov_b32 v127, 0
    s_waitcnt lgkmcnt(0)
    v_mfma_f32_32x32x16_bf16 v[48:63], v[120:123], v[8:11], 0
    v_mfma_f32_32x32x16_bf16 v[48:63], v[124:127], v[12:15], v[48:63]
    s_nop 11
    v_max3_f32 v112, v112, v48, v49
    v_max3_f32 v112, v112, v50, v51
    v_max3_f32 v112, v112, v52, v53
    v_max3_f32 v112, v112, v54, v55
    v_max3_f32 v112, v112, v56, v57
    v_max3_f32 v112, v112, v58, v59
    v_max3_f32 v112, v112, v60, v61
    v_max3_f32 v112, v112, v62, v63
    ds_read_b128 v[120:123], v2 offset:46592
    ds_read_b64 v[124:125], v109 offset:49664
    v_mov_b32 v126, 0
    v_mov_b32 v127, 0
    s_waitcnt lgkmcnt(0)
    v_mfma_f32_32x32x16_bf16 v[48:63], v[120:123], v[8:11], 0
    v_mfma_f32_32x32x16_bf16 v[48:63], v[124:127], v[12:15], v[48:63]
    s_nop 11
    v_max3_f32 v112, v112, v48, v49
    v_max3_f32 v112, v112, v50, v51
    v_max3_f32 v112, v112, v52, v53
    v_max3_f32 v112, v112, v54, v55
    v_max3_f32 v112, v112, v56, v57
    v_max3_f32 v112, v112, v58, v59
    v_max3_f32 v112, v112, v60, v61
    v_max3_f32 v112, v112, v62, v63
    ds_read_b128 v[120:123], v2 offset:49920
    ds_read_b64 v[124:125], v109 offset:52992
    v_mov_b32 v126, 0
    v_mov_b32 v127, 0
    s_waitcnt lgkmcnt(0)
    v_mfma_f32_32x32x16_bf16 v[48:63], v[120:123], v[8:11], 0
    v_mfma_f32_32x32x16_bf16 v[48:63], v[124:127], v[12:15], v[48:63]
    s_nop 11
    v_max3_f32 v112, v112, v48, v49
    v_max3_f32 v112, v112, v50, v51
    v_max3_f32 v112, v112, v52, v53
    v_max3_f32 v112, v112, v54, v55
    v_max3_f32 v112, v112, v56, v57
    v_max3_f32 v112, v112, v58, v59
    v_max3_f32 v112, v112, v60, v61
    v_max3_f32 v112, v112, v62, v63
    s_barrier
    s_add_u32 s91, s91, 1
    s_cmp_lt_u32 s91, 16
    s_cbranch_scc1 Lmx_37
    v_mov_b32 v113, v112
    s_nop 1
    v_permlane32_swap_b32 v112, v113
    v_max_f32 v112, v112, v113
Lnofb_36:
    v_sub_f32 v112, 0, v112
    v_cvt_pk_bf16_f32 v113, v112, v112
    v_and_b32 v114, 0xffff0000, v113
    v_sub_f32 v112, v112, v114
    v_cvt_pk_bf16_f32 v115, v112, v112
    v_and_b32 v116, 0xffff0000, v115
    v_sub_f32 v112, v112, v116
    v_cvt_pk_bf16_f32 v117, v112, 0
    v_and_b32 v113, 0xffff, v113
    v_or_b32 v113, v113, v116
    v_cmp_gt_u32 vcc, 32, v1
    s_nop 1
    v_cndmask_b32 v14, 0, v113, vcc
    v_cndmask_b32 v15, 0, v117, vcc
    v_mov_b32 v16, 0
    v_mov_b32 v17, 0
    v_mov_b32 v18, 0
    v_mov_b32 v19, 0
    v_mov_b32 v20, 0
    v_mov_b32 v21, 0
    v_mov_b32 v22, 0
    v_mov_b32 v23, 0
    v_mov_b32 v24, 0
    v_mov_b32 v25, 0
    v_mov_b32 v26, 0
    v_mov_b32 v27, 0
    v_mov_b32 v28, 0
    v_mov_b32 v29, 0
    v_mov_b32 v30, 0
    v_mov_b32 v31, 0
    v_mfma_f32_32x32x16_bf16 v[32:47], v[72:75], v[8:11], 0
    v_mfma_f32_32x32x16_bf16 v[32:47], v[80:83], v[12:15], v[32:47]
    v_mov_b32 v60, 0
    v_mov_b32 v61, 0
    v_mov_b32 v62, 0
    v_mov_b32 v63, 0
    v_mov_b32 v68, 0
    v_mov_b32 v69, 0
    v_mov_b32 v100, 0
    v_mov_b32 v101, 0
    v_mov_b32 v102, 0
    v_mov_b32 v103, 0
    s_cmp_ge_u32 s65, 4
    s_cselect_b64 vcc, -1, 0
    s_cbranch_vccz Lpr_39
    s_setprio 1
Lpr_39:
    v_exp_f32 v32, v32
    v_exp_f32 v33, v33
    v_cvt_pk_bf16_f32 v70, v60, v61
    v_exp_f32 v34, v34
    v_cvt_pk_bf16_f32 v71, v62, v63
    v_exp_f32 v35, v35
    s_waitcnt lgkmcnt(2)
    v_mfma_f32_32x32x16_bf16 v[48:63], v[76:79], v[8:11], 0
    ds_read_b128 v[72:75], v2 offset:6656
    ds_read_b64 v[80:81], v109 offset:9728
    v_exp_f32 v36, v36
    v_exp_f32 v37, v37
    v_cvt_pk_bf16_f32 v64, v32, v33
    v_exp_f32 v38, v38
    v_cvt_pk_bf16_f32 v65, v34, v35
    v_exp_f32 v39, v39
    v_mfma_f32_32x32x16_bf16 v[48:63], v[84:87], v[12:15], v[48:63]
    ds_read_b128 v[92:95], v2 offset:4352
    s_cbranch_vccz Lg_44
    buffer_load_dwordx4 v[144:147], v176, s[16:19], s31 offen
Lg_44:
    v_exp_f32 v40, v40
    v_exp_f32 v41, v41
    v_cvt_pk_bf16_f32 v66, v36, v37
    v_exp_f32 v42, v42
    v_cvt_pk_bf16_f32 v67, v38, v39
    v_exp_f32 v43, v43
    v_mfma_f32_32x32x16_bf16 v[16:31], v[100:103], v[68:71], v[16:31]
    ds_read_b128 v[100:103], v2 offset:5376
    s_cbranch_vccz Lg_45
    buffer_load_dwordx4 v[148:151], v177, s[16:19], s31 offen
Lg_45:
    v_exp_f32 v44, v44
    v_exp_f32 v45, v45
    v_cvt_pk_bf16_f32 v68, v40, v41
    v_exp_f32 v46, v46
    v_cvt_pk_bf16_f32 v69, v42, v43
    v_exp_f32 v47, v47
    s_waitcnt lgkmcnt(4)
    v_mfma_f32_32x32x16_bf16 v[16:31], v[88:91], v[64:67], v[16:31]
    v_exp_f32 v48, v48
    v_exp_f32 v49, v49
    v_cvt_pk_bf16_f32 v70, v44, v45
    v_exp_f32 v50, v50
    v_cvt_pk_bf16_f32 v71, v46, v47
    v_exp_f32 v51, v51
    s_waitcnt lgkmcnt(2)
    v_mfma_f32_32x32x16_bf16 v[32:47], v[72:75], v[8:11], 0
    ds_read_b128 v[76:79], v2 offset:9984
    ds_read_b64 v[84:85], v109 offset:13056
    v_exp_f32 v52, v52
    v_exp_f32 v53, v53
    v_cvt_pk_bf16_f32 v64, v48, v49
    v_exp_f32 v54, v54
    v_cvt_pk_bf16_f32 v65, v50, v51
    v_exp_f32 v55, v55
    v_mfma_f32_32x32x16_bf16 v[32:47], v[80:83], v[12:15], v[32:47]
    ds_read_b128 v[88:91], v2 offset:7680
    s_cbranch_vccz Lg_46
    buffer_load_dwordx4 v[152:155], v178, s[16:19], s31 offen
Lg_46:
    v_exp_f32 v56, v56
    v_exp_f32 v57, v57
    v_cvt_pk_bf16_f32 v66, v52, v53
    v_exp_f32 v58, v58
    v_cvt_pk_bf16_f32 v67, v54, v55
    v_exp_f32 v59, v59
    v_mfma_f32_32x32x16_bf16 v[16:31], v[96:99], v[68:71], v[16:31]
    ds_read_b128 v[96:99], v2 offset:8704
    s_cbranch_vccz Lg_47
    buffer_load_dwordx4 v[156:159], v179, s[16:19], s31 offen
Lg_47:
    v_exp_f32 v60, v60
    v_exp_f32 v61, v61
    v_cvt_pk_bf16_f32 v68, v56, v57
    v_exp_f32 v62, v62
    v_cvt_pk_bf16_f32 v69, v58, v59
    v_exp_f32 v63, v63
    s_waitcnt lgkmcnt(4)
    v_mfma_f32_32x32x16_bf16 v[16:31], v[92:95], v[64:67], v[16:31]
    s_cbranch_vccnz Lg_48
    s_waitcnt vmcnt(4)
Lg_48:
    s_barrier
    v_exp_f32 v32, v32
    v_exp_f32 v33, v33
    v_cvt_pk_bf16_f32 v70, v60, v61
    v_exp_f32 v34, v34
    v_cvt_pk_bf16_f32 v71, v62, v63
    v_exp_f32 v35, v35
    s_waitcnt lgkmcnt(2)
    v_mfma_f32_32x32x16_bf16 v[48:63], v[76:79], v[8:11], 0
    ds_read_b128 v[72:75], v2 offset:13312
    ds_read_b64 v[80:81], v109 offset:16384
    v_exp_f32 v36, v36
    v_exp_f32 v37, v37
    v_cvt_pk_bf16_f32 v64, v32, v33
    v_exp_f32 v38, v38
    v_cvt_pk_bf16_f32 v65, v34, v35
    v_exp_f32 v39, v39
    v_mfma_f32_32x32x16_bf16 v[48:63], v[84:87], v[12:15], v[48:63]
    ds_read_b128 v[92:95], v2 offset:11008
    s_cbranch_vccnz Lg_49
    s_add_u32 m0, s88, 39936
    s_nop 0
    buffer_load_dwordx4 v2, s[8:11], s87 offen offset:0 sc1 lds
    buffer_load_dwordx4 v2, s[8:11], s87 offen offset:1024 sc1 lds
Lg_49:
    s_cbranch_vccz Lg_50
    buffer_load_dwordx4 v[160:163], v180, s[12:15], s84 offen
Lg_50:
    v_exp_f32 v40, v40
    v_exp_f32 v41, v41
    v_cvt_pk_bf16_f32 v66, v36, v37
    v_exp_f32 v42, v42
    v_cvt_pk_bf16_f32 v67, v38, v39
    v_exp_f32 v43, v43
    v_mfma_f32_32x32x16_bf16 v[16:31], v[100:103], v[68:71], v[16:31]
    ds_read_b128 v[100:103], v2 offset:12032
    s_cbranch_vccz Lg_51
    buffer_load_dwordx4 v[164:167], v181, s[12:15], s84 offen
Lg_51:
    v_exp_f32 v44, v44
    v_exp_f32 v45, v45
    v_cvt_pk_bf16_f32 v68, v40, v41
    v_exp_f32 v46, v46
    v_cvt_pk_bf16_f32 v69, v42, v43
    v_exp_f32 v47, v47
    s_waitcnt lgkmcnt(4)
    v_mfma_f32_32x32x16_bf16 v[16:31], v[88:91], v[64:67], v[16:31]
    v_exp_f32 v48, v48
    v_exp_f32 v49, v49
    v_cvt_pk_bf16_f32 v70, v44, v45
    v_exp_f32 v50, v50
    v_cvt_pk_bf16_f32 v71, v46, v47
    v_exp_f32 v51, v51
    s_waitcnt lgkmcnt(2)
    v_mfma_f32_32x32x16_bf16 v[32:47], v[72:75], v[8:11], 0
    ds_read_b128 v[76:79], v2 offset:16640
    ds_read_b64 v[84:85], v109 offset:19712
    v_exp_f32 v52, v52
    v_exp_f32 v53, v53
    v_cvt_pk_bf16_f32 v64, v48, v49
    v_exp_f32 v54, v54
    v_cvt_pk_bf16_f32 v65, v50, v51
    v_exp_f32 v55, v55
    v_mfma_f32_32x32x16_bf16 v[32:47], v[80:83], v[12:15], v[32:47]
    ds_read_b128 v[88:91], v2 offset:14336
    s_cbranch_vccnz Lg_52
    s_add_u32 m0, s88, 39936
    s_nop 0
    buffer_load_dwordx4 v2, s[8:11], s87 offen offset:2048 sc1 lds
    buffer_load_dwordx4 v2, s[8:11], s87 offen offset:3072 sc1 lds
    s_add_u32 s87, s87, 13312
Lg_52:
    s_cbranch_vccz Lg_53
    buffer_load_dwordx4 v[168:171], v182, s[12:15], s84 offen
Lg_53:
    v_exp_f32 v56, v56
    v_exp_f32 v57, v57
    v_cvt_pk_bf16_f32 v66, v52, v53
    v_exp_f32 v58, v58
    v_cvt_pk_bf16_f32 v67, v54, v55
    v_exp_f32 v59, v59
    v_mfma_f32_32x32x16_bf16 v[16:31], v[96:99], v[68:71], v[16:31]
    ds_read_b128 v[96:99], v2 offset:15360
    s_cbranch_vccz Lg_54
    buffer_load_dwordx4 v[172:175], v183, s[12:15], s84 offen
Lg_54:
    v_exp_f32 v60, v60
    v_exp_f32 v61, v61
    v_cvt_pk_bf16_f32 v68, v56, v57
    v_exp_f32 v62, v62
    v_cvt_pk_bf16_f32 v69, v58, v59
    v_exp_f32 v63, v63
    s_waitcnt lgkmcnt(4)
    v_mfma_f32_32x32x16_bf16 v[16:31], v[92:95], v[64:67], v[16:31]
    v_exp_f32 v32, v32
    v_exp_f32 v33, v33
    v_cvt_pk_bf16_f32 v70, v60, v61
    v_exp_f32 v34, v34
    v_cvt_pk_bf16_f32 v71, v62, v63
    v_exp_f32 v35, v35
    s_waitcnt lgkmcnt(2)
    v_mfma_f32_32x32x16_bf16 v[48:63], v[76:79], v[8:11], 0
    ds_read_b128 v[72:75], v2 offset:19968
    ds_read_b64 v[80:81], v109 offset:23040
    v_exp_f32 v36, v36
    v_exp_f32 v37, v37
    v_cvt_pk_bf16_f32 v64, v32, v33
    v_exp_f32 v38, v38
    v_cvt_pk_bf16_f32 v65, v34, v35
    v_exp_f32 v39, v39
    v_mfma_f32_32x32x16_bf16 v[48:63], v[84:87], v[12:15], v[48:63]
    ds_read_b128 v[92:95], v2 offset:17664
    v_exp_f32 v40, v40
    v_exp_f32 v41, v41
    v_cvt_pk_bf16_f32 v66, v36, v37
    v_exp_f32 v42, v42
    v_cvt_pk_bf16_f32 v67, v38, v39
    v_exp_f32 v43, v43
    v_mfma_f32_32x32x16_bf16 v[16:31], v[100:103], v[68:71], v[16:31]
    ds_read_b128 v[100:103], v2 offset:18688
    v_exp_f32 v44, v44
    v_exp_f32 v45, v45
    v_cvt_pk_bf16_f32 v68, v40, v41
    v_exp_f32 v46, v46
    v_cvt_pk_bf16_f32 v69, v42, v43
    v_exp_f32 v47, v47
    s_waitcnt lgkmcnt(4)
    v_mfma_f32_32x32x16_bf16 v[16:31], v[88:91], v[64:67], v[16:31]
    v_exp_f32 v48, v48
    v_exp_f32 v49, v49
    v_cvt_pk_bf16_f32 v70, v44, v45
    v_exp_f32 v50, v50
    v_cvt_pk_bf16_f32 v71, v46, v47
    v_exp_f32 v51, v51
    s_waitcnt lgkmcnt(2)
    v_mfma_f32_32x32x16_bf16 v[32:47], v[72:75], v[8:11], 0
    ds_read_b128 v[76:79], v2 offset:23296
    ds_read_b64 v[84:85], v109 offset:26368
    v_exp_f32 v52, v52
    v_exp_f32 v53, v53
    v_cvt_pk_bf16_f32 v64, v48, v49
    v_exp_f32 v54, v54
    v_cvt_pk_bf16_f32 v65, v50, v51
    v_exp_f32 v55, v55
    v_mfma_f32_32x32x16_bf16 v[32:47], v[80:83], v[12:15], v[32:47]
    ds_read_b128 v[88:91], v2 offset:20992
    v_exp_f32 v56, v56
    v_exp_f32 v57, v57
    v_cvt_pk_bf16_f32 v66, v52, v53
    v_exp_f32 v58, v58
    v_cvt_pk_bf16_f32 v67, v54, v55
    v_exp_f32 v59, v59
    v_mfma_f32_32x32x16_bf16 v[16:31], v[96:99], v[68:71], v[16:31]
    ds_read_b128 v[96:99], v2 offset:22016
    v_exp_f32 v60, v60
    v_exp_f32 v61, v61
    v_cvt_pk_bf16_f32 v68, v56, v57
    v_exp_f32 v62, v62
    v_cvt_pk_bf16_f32 v69, v58, v59
    v_exp_f32 v63, v63
    s_waitcnt lgkmcnt(4)
    v_mfma_f32_32x32x16_bf16 v[16:31], v[92:95], v[64:67], v[16:31]
    s_cbranch_vccnz Lg_55
    s_waitcnt vmcnt(4)
Lg_55:
    s_barrier
    v_exp_f32 v32, v32
    v_exp_f32 v33, v33
    v_cvt_pk_bf16_f32 v70, v60, v61
    v_exp_f32 v34, v34
    v_cvt_pk_bf16_f32 v71, v62, v63
    v_exp_f32 v35, v35
    s_waitcnt lgkmcnt(2)
    v_mfma_f32_32x32x16_bf16 v[48:63], v[76:79], v[8:11], 0
    ds_read_b128 v[72:75], v2 offset:26624
    ds_read_b64 v[80:81], v109 offset:29696
    v_exp_f32 v36, v36
    v_exp_f32 v37, v37
    v_cvt_pk_bf16_f32 v64, v32, v33
    v_exp_f32 v38, v38
    v_cvt_pk_bf16_f32 v65, v34, v35
    v_exp_f32 v39, v39
    v_mfma_f32_32x32x16_bf16 v[48:63], v[84:87], v[12:15], v[48:63]
    ds_read_b128 v[92:95], v2 offset:24320
    s_cbranch_vccnz Lg_56
    s_add_u32 m0, s88, 0
    s_nop 0
    buffer_load_dwordx4 v2, s[8:11], s87 offen offset:0 sc1 lds
    buffer_load_dwordx4 v2, s[8:11], s87 offen offset:1024 sc1 lds
Lg_56:
    v_exp_f32 v40, v40
    v_exp_f32 v41, v41
    v_cvt_pk_bf16_f32 v66, v36, v37
    v_exp_f32 v42, v42
    v_cvt_pk_bf16_f32 v67, v38, v39
    v_exp_f32 v43, v43
    v_mfma_f32_32x32x16_bf16 v[16:31], v[100:103], v[68:71], v[16:31]
    ds_read_b128 v[100:103], v2 offset:25344
    v_exp_f32 v44, v44
    v_exp_f32 v45, v45
    v_cvt_pk_bf16_f32 v68, v40, v41
    v_exp_f32 v46, v46
    v_cvt_pk_bf16_f32 v69, v42, v43
    v_exp_f32 v47, v47
    s_waitcnt lgkmcnt(4)
    v_mfma_f32_32x32x16_bf16 v[16:31], v[88:91], v[64:67], v[16:31]
    v_exp_f32 v48, v48
    v_exp_f32 v49, v49
    v_cvt_pk_bf16_f32 v70, v44, v45
    v_exp_f32 v50, v50
    v_cvt_pk_bf16_f32 v71, v46, v47
    v_exp_f32 v51, v51
    s_waitcnt lgkmcnt(2)
    v_mfma_f32_32x32x16_bf16 v[32:47], v[72:75], v[8:11], 0
    ds_read_b128 v[76:79], v2 offset:29952
    ds_read_b64 v[84:85], v109 offset:33024
    v_exp_f32 v52, v52
    v_exp_f32 v53, v53
    v_cvt_pk_bf16_f32 v64, v48, v49
    v_exp_f32 v54, v54
    v_cvt_pk_bf16_f32 v65, v50, v51
    v_exp_f32 v55, v55
    v_mfma_f32_32x32x16_bf16 v[32:47], v[80:83], v[12:15], v[32:47]
    ds_read_b128 v[88:91], v2 offset:27648
    s_cbranch_vccnz Lg_57
    s_add_u32 m0, s88, 0
    s_nop 0
    buffer_load_dwordx4 v2, s[8:11], s87 offen offset:2048 sc1 lds
    buffer_load_dwordx4 v2, s[8:11], s87 offen offset:3072 sc1 lds
    s_add_u32 s87, s87, 13312
Lg_57:
    v_exp_f32 v56, v56
    v_exp_f32 v57, v57
    v_cvt_pk_bf16_f32 v66, v52, v53
    v_exp_f32 v58, v58
    v_cvt_pk_bf16_f32 v67, v54, v55
    v_exp_f32 v59, v59
    v_mfma_f32_32x32x16_bf16 v[16:31], v[96:99], v[68:71], v[16:31]
    ds_read_b128 v[96:99], v2 offset:28672
    v_exp_f32 v60, v60
    v_exp_f32 v61, v61
    v_cvt_pk_bf16_f32 v68, v56, v57
    v_exp_f32 v62, v62
    v_cvt_pk_bf16_f32 v69, v58, v59
    v_exp_f32 v63, v63
    s_waitcnt lgkmcnt(4)
    v_mfma_f32_32x32x16_bf16 v[16:31], v[92:95], v[64:67], v[16:31]
    v_exp_f32 v32, v32
    v_exp_f32 v33, v33
    v_cvt_pk_bf16_f32 v70, v60, v61
    v_exp_f32 v34, v34
    v_cvt_pk_bf16_f32 v71, v62, v63
    v_exp_f32 v35, v35
    s_waitcnt lgkmcnt(2)
    v_mfma_f32_32x32x16_bf16 v[48:63], v[76:79], v[8:11], 0
    ds_read_b128 v[72:75], v2 offset:33280
    ds_read_b64 v[80:81], v109 offset:36352
    v_exp_f32 v36, v36
    v_exp_f32 v37, v37
    v_cvt_pk_bf16_f32 v64, v32, v33
    v_exp_f32 v38, v38
    v_cvt_pk_bf16_f32 v65, v34, v35
    v_exp_f32 v39, v39
    v_mfma_f32_32x32x16_bf16 v[48:63], v[84:87], v[12:15], v[48:63]
    ds_read_b128 v[92:95], v2 offset:30976
    v_exp_f32 v40, v40
    v_exp_f32 v41, v41
    v_cvt_pk_bf16_f32 v66, v36, v37
    v_exp_f32 v42, v42
    v_cvt_pk_bf16_f32 v67, v38, v39
    v_exp_f32 v43, v43
    v_mfma_f32_32x32x16_bf16 v[16:31], v[100:103], v[68:71], v[16:31]
    ds_read_b128 v[100:103], v2 offset:32000
    v_exp_f32 v44, v44
    v_exp_f32 v45, v45
    v_cvt_pk_bf16_f32 v68, v40, v41
    v_exp_f32 v46, v46
    v_cvt_pk_bf16_f32 v69, v42, v43
    v_exp_f32 v47, v47
    s_waitcnt lgkmcnt(4)
    v_mfma_f32_32x32x16_bf16 v[16:31], v[88:91], v[64:67], v[16:31]
    v_exp_f32 v48, v48
    v_exp_f32 v49, v49
    v_cvt_pk_bf16_f32 v70, v44, v45
    v_exp_f32 v50, v50
    v_cvt_pk_bf16_f32 v71, v46, v47
    v_exp_f32 v51, v51
    s_waitcnt lgkmcnt(2)
    v_mfma_f32_32x32x16_bf16 v[32:47], v[72:75], v[8:11], 0
    ds_read_b128 v[76:79], v2 offset:36608
    ds_read_b64 v[84:85], v109 offset:39680
    v_exp_f32 v52, v52
    v_exp_f32 v53, v53
    v_cvt_pk_bf16_f32 v64, v48, v49
    v_exp_f32 v54, v54
    v_cvt_pk_bf16_f32 v65, v50, v51
    v_exp_f32 v55, v55
    v_mfma_f32_32x32x16_bf16 v[32:47], v[80:83], v[12:15], v[32:47]
    ds_read_b128 v[88:91], v2 offset:34304
    v_exp_f32 v56, v56
    v_exp_f32 v57, v57
    v_cvt_pk_bf16_f32 v66, v52, v53
    v_exp_f32 v58, v58
    v_cvt_pk_bf16_f32 v67, v54, v55
    v_exp_f32 v59, v59
    v_mfma_f32_32x32x16_bf16 v[16:31], v[96:99], v[68:71], v[16:31]
    ds_read_b128 v[96:99], v2 offset:35328
    v_exp_f32 v60, v60
    v_exp_f32 v61, v61
    v_cvt_pk_bf16_f32 v68, v56, v57
    v_exp_f32 v62, v62
    v_cvt_pk_bf16_f32 v69, v58, v59
    v_exp_f32 v63, v63
    s_waitcnt lgkmcnt(4)
    v_mfma_f32_32x32x16_bf16 v[16:31], v[92:95], v[64:67], v[16:31]
    s_cbranch_vccnz Lg_58
    s_waitcnt vmcnt(4)
Lg_58:
    s_barrier
    v_exp_f32 v32, v32
    v_exp_f32 v33, v33
    v_cvt_pk_bf16_f32 v70, v60, v61
    v_exp_f32 v34, v34
    v_cvt_pk_bf16_f32 v71, v62, v63
    v_exp_f32 v35, v35
    s_waitcnt lgkmcnt(2)
    v_mfma_f32_32x32x16_bf16 v[48:63], v[76:79], v[8:11], 0
    ds_read_b128 v[72:75], v2 offset:39936
    ds_read_b64 v[80:81], v109 offset:43008
    v_exp_f32 v36, v36
    v_exp_f32 v37, v37
    v_cvt_pk_bf16_f32 v64, v32, v33
    v_exp_f32 v38, v38
    v_cvt_pk_bf16_f32 v65, v34, v35
    v_exp_f32 v39, v39
    v_mfma_f32_32x32x16_bf16 v[48:63], v[84:87], v[12:15], v[48:63]
    ds_read_b128 v[92:95], v2 offset:37632
    s_cbranch_vccnz Lg_59
    s_add_u32 m0, s88, 13312
    s_nop 0
    buffer_load_dwordx4 v2, s[8:11], s87 offen offset:0 sc1 lds
    buffer_load_dwordx4 v2, s[8:11], s87 offen offset:1024 sc1 lds
Lg_59:
    v_exp_f32 v40, v40
    v_exp_f32 v41, v41
    v_cvt_pk_bf16_f32 v66, v36, v37
    v_exp_f32 v42, v42
    v_cvt_pk_bf16_f32 v67, v38, v39
    v_exp_f32 v43, v43
    v_mfma_f32_32x32x16_bf16 v[16:31], v[100:103], v[68:71], v[16:31]
    ds_read_b128 v[100:103], v2 offset:38656
    v_exp_f32 v44, v44
    v_exp_f32 v45, v45
    v_cvt_pk_bf16_f32 v68, v40, v41
    v_exp_f32 v46, v46
    v_cvt_pk_bf16_f32 v69, v42, v43
    v_exp_f32 v47, v47
    s_waitcnt lgkmcnt(4)
    v_mfma_f32_32x32x16_bf16 v[16:31], v[88:91], v[64:67], v[16:31]
    v_exp_f32 v48, v48
    v_exp_f32 v49, v49
    v_cvt_pk_bf16_f32 v70, v44, v45
    v_exp_f32 v50, v50
    v_cvt_pk_bf16_f32 v71, v46, v47
    v_exp_f32 v51, v51
    s_waitcnt lgkmcnt(2)
    v_mfma_f32_32x32x16_bf16 v[32:47], v[72:75], v[8:11], 0
    ds_read_b128 v[76:79], v2 offset:43264
    ds_read_b64 v[84:85], v109 offset:46336
    v_exp_f32 v52, v52
    v_exp_f32 v53, v53
    v_cvt_pk_bf16_f32 v64, v48, v49
    v_exp_f32 v54, v54
    v_cvt_pk_bf16_f32 v65, v50, v51
    v_exp_f32 v55, v55
    v_mfma_f32_32x32x16_bf16 v[32:47], v[80:83], v[12:15], v[32:47]
    ds_read_b128 v[88:91], v2 offset:40960
    s_cbranch_vccnz Lg_60
    s_add_u32 m0, s88, 13312
    s_nop 0
    buffer_load_dwordx4 v2, s[8:11], s87 offen offset:2048 sc1 lds
    buffer_load_dwordx4 v2, s[8:11], s87 offen offset:3072 sc1 lds
    s_add_u32 s87, s87, 13312
Lg_60:
    v_exp_f32 v56, v56
    v_exp_f32 v57, v57
    v_cvt_pk_bf16_f32 v66, v52, v53
    v_exp_f32 v58, v58
    v_cvt_pk_bf16_f32 v67, v54, v55
    v_exp_f32 v59, v59
    v_mfma_f32_32x32x16_bf16 v[16:31], v[96:99], v[68:71], v[16:31]
    ds_read_b128 v[96:99], v2 offset:41984
    v_exp_f32 v60, v60
    v_exp_f32 v61, v61
    v_cvt_pk_bf16_f32 v68, v56, v57
    v_exp_f32 v62, v62
    v_cvt_pk_bf16_f32 v69, v58, v59
    v_exp_f32 v63, v63
    s_waitcnt lgkmcnt(4)
    v_mfma_f32_32x32x16_bf16 v[16:31], v[92:95], v[64:67], v[16:31]
    v_exp_f32 v32, v32
    v_exp_f32 v33, v33
    v_cvt_pk_bf16_f32 v70, v60, v61
    v_exp_f32 v34, v34
    v_cvt_pk_bf16_f32 v71, v62, v63
    v_exp_f32 v35, v35
    s_waitcnt lgkmcnt(2)
    v_mfma_f32_32x32x16_bf16 v[48:63], v[76:79], v[8:11], 0
    ds_read_b128 v[72:75], v2 offset:46592
    ds_read_b64 v[80:81], v109 offset:49664
    v_exp_f32 v36, v36
    v_exp_f32 v37, v37
    v_cvt_pk_bf16_f32 v64, v32, v33
    v_exp_f32 v38, v38
    v_cvt_pk_bf16_f32 v65, v34, v35
    v_exp_f32 v39, v39
    v_mfma_f32_32x32x16_bf16 v[48:63], v[84:87], v[12:15], v[48:63]
    ds_read_b128 v[92:95], v2 offset:44288
    s_cbranch_vccz Lg_61
    s_waitcnt vmcnt(7)
    buffer_store_dwordx4 v[144:147], v2, s[8:11], s42 offen offset:0 sc1
Lg_61:
    v_exp_f32 v40, v40
    v_exp_f32 v41, v41
    v_cvt_pk_bf16_f32 v66, v36, v37
    v_exp_f32 v42, v42
    v_cvt_pk_bf16_f32 v67, v38, v39
    v_exp_f32 v43, v43
    v_mfma_f32_32x32x16_bf16 v[16:31], v[100:103], v[68:71], v[16:31]
    ds_read_b128 v[100:103], v2 offset:45312
    s_cbranch_vccz Lg_62
    s_waitcnt vmcnt(7)
    buffer_store_dwordx4 v[148:151], v2, s[8:11], s42 offen offset:1024 sc1
Lg_62:
    v_exp_f32 v44, v44
    v_exp_f32 v45, v45
    v_cvt_pk_bf16_f32 v68, v40, v41
    v_exp_f32 v46, v46
    v_cvt_pk_bf16_f32 v69, v42, v43
    v_exp_f32 v47, v47
    s_waitcnt lgkmcnt(4)
    v_mfma_f32_32x32x16_bf16 v[16:31], v[88:91], v[64:67], v[16:31]
    v_exp_f32 v48, v48
    v_exp_f32 v49, v49
    v_cvt_pk_bf16_f32 v70, v44, v45
    v_exp_f32 v50, v50
    v_cvt_pk_bf16_f32 v71, v46, v47
    v_exp_f32 v51, v51
    s_waitcnt lgkmcnt(2)
    v_mfma_f32_32x32x16_bf16 v[32:47], v[72:75], v[8:11], 0
    ds_read_b128 v[76:79], v2 offset:49920
    ds_read_b64 v[84:85], v109 offset:52992
    v_exp_f32 v52, v52
    v_exp_f32 v53, v53
    v_cvt_pk_bf16_f32 v64, v48, v49
    v_exp_f32 v54, v54
    v_cvt_pk_bf16_f32 v65, v50, v51
    v_exp_f32 v55, v55
    v_mfma_f32_32x32x16_bf16 v[32:47], v[80:83], v[12:15], v[32:47]
    ds_read_b128 v[88:91], v2 offset:47616
    s_cbranch_vccz Lg_63
    s_waitcnt vmcnt(7)
    buffer_store_dwordx4 v[152:155], v2, s[8:11], s42 offen offset:2048 sc1
Lg_63:
    v_exp_f32 v56, v56
    v_exp_f32 v57, v57
    v_cvt_pk_bf16_f32 v66, v52, v53
    v_exp_f32 v58, v58
    v_cvt_pk_bf16_f32 v67, v54, v55
    v_exp_f32 v59, v59
    v_mfma_f32_32x32x16_bf16 v[16:31], v[96:99], v[68:71], v[16:31]
    ds_read_b128 v[96:99], v2 offset:48640
    s_cbranch_vccz Lg_64
    s_waitcnt vmcnt(7)
    buffer_store_dwordx4 v[156:159], v2, s[8:11], s42 offen offset:3072 sc1
Lg_64:
    v_exp_f32 v60, v60
    v_exp_f32 v61, v61
    v_cvt_pk_bf16_f32 v68, v56, v57
    v_exp_f32 v62, v62
    v_cvt_pk_bf16_f32 v69, v58, v59
    v_exp_f32 v63, v63
    s_waitcnt lgkmcnt(4)
    v_mfma_f32_32x32x16_bf16 v[16:31], v[92:95], v[64:67], v[16:31]
    s_cbranch_vccnz Lg_65
    s_waitcnt vmcnt(4)
Lg_65:
    s_barrier
    v_exp_f32 v32, v32
    v_exp_f32 v33, v33
    v_cvt_pk_bf16_f32 v70, v60, v61
    v_exp_f32 v34, v34
    v_cvt_pk_bf16_f32 v71, v62, v63
    v_exp_f32 v35, v35
    s_waitcnt lgkmcnt(2)
    v_mfma_f32_32x32x16_bf16 v[48:63], v[76:79], v[8:11], 0
    ds_read_b128 v[72:75], v2 offset:0
    ds_read_b64 v[80:81], v109 offset:3072
    v_exp_f32 v36, v36
    v_exp_f32 v37, v37
    v_cvt_pk_bf16_f32 v64, v32, v33
    v_exp_f32 v38, v38
    v_cvt_pk_bf16_f32 v65, v34, v35
    v_exp_f32 v39, v39
    v_mfma_f32_32x32x16_bf16 v[48:63], v[84:87], v[12:15], v[48:63]
    ds_read_b128 v[92:95], v2 offset:50944
    s_cbranch_vccnz Lg_66
    s_add_u32 m0, s88, 26624
    s_nop 0
    buffer_load_dwordx4 v2, s[8:11], s87 offen offset:0 sc1 lds
    buffer_load_dwordx4 v2, s[8:11], s87 offen offset:1024 sc1 lds
Lg_66:
    s_cbranch_vccz Lg_67
    s_waitcnt vmcnt(7)
    s_add_u32 s42, s42, 4194304
    buffer_store_dwordx4 v[160:163], v2, s[8:11], s42 offen offset:0 sc1
Lg_67:
    v_exp_f32 v40, v40
    v_exp_f32 v41, v41
    v_cvt_pk_bf16_f32 v66, v36, v37
    v_exp_f32 v42, v42
    v_cvt_pk_bf16_f32 v67, v38, v39
    v_exp_f32 v43, v43
    v_mfma_f32_32x32x16_bf16 v[16:31], v[100:103], v[68:71], v[16:31]
    ds_read_b128 v[100:103], v2 offset:51968
    s_cbranch_vccz Lg_68
    s_waitcnt vmcnt(7)
    buffer_store_dwordx4 v[164:167], v2, s[8:11], s42 offen offset:1024 sc1
Lg_68:
    v_exp_f32 v44, v44
    v_exp_f32 v45, v45
    v_cvt_pk_bf16_f32 v68, v40, v41
    v_exp_f32 v46, v46
    v_cvt_pk_bf16_f32 v69, v42, v43
    v_exp_f32 v47, v47
    s_waitcnt lgkmcnt(4)
    v_mfma_f32_32x32x16_bf16 v[16:31], v[88:91], v[64:67], v[16:31]
    v_exp_f32 v48, v48
    v_exp_f32 v49, v49
    v_cvt_pk_bf16_f32 v70, v44, v45
    v_exp_f32 v50, v50
    v_cvt_pk_bf16_f32 v71, v46, v47
    v_exp_f32 v51, v51
    s_waitcnt lgkmcnt(2)
    v_mfma_f32_32x32x16_bf16 v[32:47], v[72:75], v[8:11], 0
    ds_read_b128 v[76:79], v2 offset:3328
    ds_read_b64 v[84:85], v109 offset:6400
    v_exp_f32 v52, v52
    v_exp_f32 v53, v53
    v_cvt_pk_bf16_f32 v64, v48, v49
    v_exp_f32 v54, v54
    v_cvt_pk_bf16_f32 v65, v50, v51
    v_exp_f32 v55, v55
    v_mfma_f32_32x32x16_bf16 v[32:47], v[80:83], v[12:15], v[32:47]
    ds_read_b128 v[88:91], v2 offset:1024
    s_cbranch_vccnz Lg_69
    s_add_u32 m0, s88, 26624
    s_nop 0
    buffer_load_dwordx4 v2, s[8:11], s87 offen offset:2048 sc1 lds
    buffer_load_dwordx4 v2, s[8:11], s87 offen offset:3072 sc1 lds
    s_add_u32 s87, s87, 13312
Lg_69:
    s_cbranch_vccz Lg_70
    s_waitcnt vmcnt(7)
    buffer_store_dwordx4 v[168:171], v2, s[8:11], s42 offen offset:2048 sc1
Lg_70:
    v_exp_f32 v56, v56
    v_exp_f32 v57, v57
    v_cvt_pk_bf16_f32 v66, v52, v53
    v_exp_f32 v58, v58
    v_cvt_pk_bf16_f32 v67, v54, v55
    v_exp_f32 v59, v59
    v_mfma_f32_32x32x16_bf16 v[16:31], v[96:99], v[68:71], v[16:31]
    ds_read_b128 v[96:99], v2 offset:2048
    s_cbranch_vccz Lg_71
    s_waitcnt vmcnt(7)
    buffer_store_dwordx4 v[172:175], v2, s[8:11], s42 offen offset:3072 sc1
Lg_71:
    v_exp_f32 v60, v60
    v_exp_f32 v61, v61
    v_cvt_pk_bf16_f32 v68, v56, v57
    v_exp_f32 v62, v62
    v_cvt_pk_bf16_f32 v69, v58, v59
    v_exp_f32 v63, v63
    s_waitcnt lgkmcnt(4)
    v_mfma_f32_32x32x16_bf16 v[16:31], v[92:95], v[64:67], v[16:31]
    v_exp_f32 v32, v32
    v_exp_f32 v33, v33
    v_cvt_pk_bf16_f32 v70, v60, v61
    v_exp_f32 v34, v34
    v_cvt_pk_bf16_f32 v71, v62, v63
    v_exp_f32 v35, v35
    s_waitcnt lgkmcnt(2)
    v_mfma_f32_32x32x16_bf16 v[48:63], v[76:79], v[8:11], 0
    ds_read_b128 v[72:75], v2 offset:6656
    ds_read_b64 v[80:81], v109 offset:9728
    v_exp_f32 v36, v36
    v_exp_f32 v37, v37
    v_cvt_pk_bf16_f32 v64, v32, v33
    v_exp_f32 v38, v38
    v_cvt_pk_bf16_f32 v65, v34, v35
    v_exp_f32 v39, v39
    v_mfma_f32_32x32x16_bf16 v[48:63], v[84:87], v[12:15], v[48:63]
    ds_read_b128 v[92:95], v2 offset:4352
    v_exp_f32 v40, v40
    v_exp_f32 v41, v41
    v_cvt_pk_bf16_f32 v66, v36, v37
    v_exp_f32 v42, v42
    v_cvt_pk_bf16_f32 v67, v38, v39
    v_exp_f32 v43, v43
    v_mfma_f32_32x32x16_bf16 v[16:31], v[100:103], v[68:71], v[16:31]
    ds_read_b128 v[100:103], v2 offset:5376
    v_exp_f32 v44, v44
    v_exp_f32 v45, v45
    v_cvt_pk_bf16_f32 v68, v40, v41
    v_exp_f32 v46, v46
    v_cvt_pk_bf16_f32 v69, v42, v43
    v_exp_f32 v47, v47
    s_waitcnt lgkmcnt(4)
    v_mfma_f32_32x32x16_bf16 v[16:31], v[88:91], v[64:67], v[16:31]
    v_exp_f32 v48, v48
    v_exp_f32 v49, v49
    v_cvt_pk_bf16_f32 v70, v44, v45
    v_exp_f32 v50, v50
    v_cvt_pk_bf16_f32 v71, v46, v47
    v_exp_f32 v51, v51
    s_waitcnt lgkmcnt(2)
    v_mfma_f32_32x32x16_bf16 v[32:47], v[72:75], v[8:11], 0
    ds_read_b128 v[76:79], v2 offset:9984
    ds_read_b64 v[84:85], v109 offset:13056
    v_exp_f32 v52, v52
    v_exp_f32 v53, v53
    v_cvt_pk_bf16_f32 v64, v48, v49
    v_exp_f32 v54, v54
    v_cvt_pk_bf16_f32 v65, v50, v51
    v_exp_f32 v55, v55
    v_mfma_f32_32x32x16_bf16 v[32:47], v[80:83], v[12:15], v[32:47]
    ds_read_b128 v[88:91], v2 offset:7680
    v_exp_f32 v56, v56
    v_exp_f32 v57, v57
    v_cvt_pk_bf16_f32 v66, v52, v53
    v_exp_f32 v58, v58
    v_cvt_pk_bf16_f32 v67, v54, v55
    v_exp_f32 v59, v59
    v_mfma_f32_32x32x16_bf16 v[16:31], v[96:99], v[68:71], v[16:31]
    ds_read_b128 v[96:99], v2 offset:8704
    v_exp_f32 v60, v60
    v_exp_f32 v61, v61
    v_cvt_pk_bf16_f32 v68, v56, v57
    v_exp_f32 v62, v62
    v_cvt_pk_bf16_f32 v69, v58, v59
    v_exp_f32 v63, v63
    s_waitcnt lgkmcnt(4)
    v_mfma_f32_32x32x16_bf16 v[16:31], v[92:95], v[64:67], v[16:31]
    s_cbranch_vccnz Lg_72
    s_waitcnt vmcnt(4)
Lg_72:
    s_barrier
    v_exp_f32 v32, v32
    v_exp_f32 v33, v33
    v_cvt_pk_bf16_f32 v70, v60, v61
    v_exp_f32 v34, v34
    v_cvt_pk_bf16_f32 v71, v62, v63
    v_exp_f32 v35, v35
    s_waitcnt lgkmcnt(2)
    v_mfma_f32_32x32x16_bf16 v[48:63], v[76:79], v[8:11], 0
    ds_read_b128 v[72:75], v2 offset:13312
    ds_read_b64 v[80:81], v109 offset:16384
    v_exp_f32 v36, v36
    v_exp_f32 v37, v37
    v_cvt_pk_bf16_f32 v64, v32, v33
    v_exp_f32 v38, v38
    v_cvt_pk_bf16_f32 v65, v34, v35
    v_exp_f32 v39, v39
    v_mfma_f32_32x32x16_bf16 v[48:63], v[84:87], v[12:15], v[48:63]
    ds_read_b128 v[92:95], v2 offset:11008
    s_cbranch_vccnz Lg_73
    s_add_u32 m0, s88, 39936
    s_nop 0
    buffer_load_dwordx4 v2, s[8:11], s87 offen offset:0 sc1 lds
    buffer_load_dwordx4 v2, s[8:11], s87 offen offset:1024 sc1 lds
Lg_73:
    v_exp_f32 v40, v40
    v_exp_f32 v41, v41
    v_cvt_pk_bf16_f32 v66, v36, v37
    v_exp_f32 v42, v42
    v_cvt_pk_bf16_f32 v67, v38, v39
    v_exp_f32 v43, v43
    v_mfma_f32_32x32x16_bf16 v[16:31], v[100:103], v[68:71], v[16:31]
    ds_read_b128 v[100:103], v2 offset:12032
    v_exp_f32 v44, v44
    v_exp_f32 v45, v45
    v_cvt_pk_bf16_f32 v68, v40, v41
    v_exp_f32 v46, v46
    v_cvt_pk_bf16_f32 v69, v42, v43
    v_exp_f32 v47, v47
    s_waitcnt lgkmcnt(4)
    v_mfma_f32_32x32x16_bf16 v[16:31], v[88:91], v[64:67], v[16:31]
    v_exp_f32 v48, v48
    v_exp_f32 v49, v49
    v_cvt_pk_bf16_f32 v70, v44, v45
    v_exp_f32 v50, v50
    v_cvt_pk_bf16_f32 v71, v46, v47
    v_exp_f32 v51, v51
    s_waitcnt lgkmcnt(2)
    v_mfma_f32_32x32x16_bf16 v[32:47], v[72:75], v[8:11], 0
    ds_read_b128 v[76:79], v2 offset:16640
    ds_read_b64 v[84:85], v109 offset:19712
    v_exp_f32 v52, v52
    v_exp_f32 v53, v53
    v_cvt_pk_bf16_f32 v64, v48, v49
    v_exp_f32 v54, v54
    v_cvt_pk_bf16_f32 v65, v50, v51
    v_exp_f32 v55, v55
    v_mfma_f32_32x32x16_bf16 v[32:47], v[80:83], v[12:15], v[32:47]
    ds_read_b128 v[88:91], v2 offset:14336
    s_cbranch_vccnz Lg_74
    s_add_u32 m0, s88, 39936
    s_nop 0
    buffer_load_dwordx4 v2, s[8:11], s87 offen offset:2048 sc1 lds
    buffer_load_dwordx4 v2, s[8:11], s87 offen offset:3072 sc1 lds
    s_add_u32 s87, s87, 13312
Lg_74:
    v_exp_f32 v56, v56
    v_exp_f32 v57, v57
    v_cvt_pk_bf16_f32 v66, v52, v53
    v_exp_f32 v58, v58
    v_cvt_pk_bf16_f32 v67, v54, v55
    v_exp_f32 v59, v59
    v_mfma_f32_32x32x16_bf16 v[16:31], v[96:99], v[68:71], v[16:31]
    ds_read_b128 v[96:99], v2 offset:15360
    v_exp_f32 v60, v60
    v_exp_f32 v61, v61
    v_cvt_pk_bf16_f32 v68, v56, v57
    v_exp_f32 v62, v62
    v_cvt_pk_bf16_f32 v69, v58, v59
    v_exp_f32 v63, v63
    s_waitcnt lgkmcnt(4)
    v_mfma_f32_32x32x16_bf16 v[16:31], v[92:95], v[64:67], v[16:31]
    v_exp_f32 v32, v32
    v_exp_f32 v33, v33
    v_cvt_pk_bf16_f32 v70, v60, v61
    v_exp_f32 v34, v34
    v_cvt_pk_bf16_f32 v71, v62, v63
    v_exp_f32 v35, v35
    s_waitcnt lgkmcnt(2)
    v_mfma_f32_32x32x16_bf16 v[48:63], v[76:79], v[8:11], 0
    ds_read_b128 v[72:75], v2 offset:19968
    ds_read_b64 v[80:81], v109 offset:23040
    v_exp_f32 v36, v36
    v_exp_f32 v37, v37
    v_cvt_pk_bf16_f32 v64, v32, v33
    v_exp_f32 v38, v38
    v_cvt_pk_bf16_f32 v65, v34, v35
    v_exp_f32 v39, v39
    v_mfma_f32_32x32x16_bf16 v[48:63], v[84:87], v[12:15], v[48:63]
    ds_read_b128 v[92:95], v2 offset:17664
    v_exp_f32 v40, v40
    v_exp_f32 v41, v41
    v_cvt_pk_bf16_f32 v66, v36, v37
    v_exp_f32 v42, v42
    v_cvt_pk_bf16_f32 v67, v38, v39
    v_exp_f32 v43, v43
    v_mfma_f32_32x32x16_bf16 v[16:31], v[100:103], v[68:71], v[16:31]
    ds_read_b128 v[100:103], v2 offset:18688
    v_exp_f32 v44, v44
    v_exp_f32 v45, v45
    v_cvt_pk_bf16_f32 v68, v40, v41
    v_exp_f32 v46, v46
    v_cvt_pk_bf16_f32 v69, v42, v43
    v_exp_f32 v47, v47
    s_waitcnt lgkmcnt(4)
    v_mfma_f32_32x32x16_bf16 v[16:31], v[88:91], v[64:67], v[16:31]
    v_exp_f32 v48, v48
    v_exp_f32 v49, v49
    v_cvt_pk_bf16_f32 v70, v44, v45
    v_exp_f32 v50, v50
    v_cvt_pk_bf16_f32 v71, v46, v47
    v_exp_f32 v51, v51
    s_waitcnt lgkmcnt(2)
    v_mfma_f32_32x32x16_bf16 v[32:47], v[72:75], v[8:11], 0
    ds_read_b128 v[76:79], v2 offset:23296
    ds_read_b64 v[84:85], v109 offset:26368
    v_exp_f32 v52, v52
    v_exp_f32 v53, v53
    v_cvt_pk_bf16_f32 v64, v48, v49
    v_exp_f32 v54, v54
    v_cvt_pk_bf16_f32 v65, v50, v51
    v_exp_f32 v55, v55
    v_mfma_f32_32x32x16_bf16 v[32:47], v[80:83], v[12:15], v[32:47]
    ds_read_b128 v[88:91], v2 offset:20992
    v_exp_f32 v56, v56
    v_exp_f32 v57, v57
    v_cvt_pk_bf16_f32 v66, v52, v53
    v_exp_f32 v58, v58
    v_cvt_pk_bf16_f32 v67, v54, v55
    v_exp_f32 v59, v59
    v_mfma_f32_32x32x16_bf16 v[16:31], v[96:99], v[68:71], v[16:31]
    ds_read_b128 v[96:99], v2 offset:22016
    v_exp_f32 v60, v60
    v_exp_f32 v61, v61
    v_cvt_pk_bf16_f32 v68, v56, v57
    v_exp_f32 v62, v62
    v_cvt_pk_bf16_f32 v69, v58, v59
    v_exp_f32 v63, v63
    s_waitcnt lgkmcnt(4)
    v_mfma_f32_32x32x16_bf16 v[16:31], v[92:95], v[64:67], v[16:31]
    s_cbranch_vccnz Lg_75
    s_waitcnt vmcnt(4)
Lg_75:
    s_barrier
    v_exp_f32 v32, v32
    v_exp_f32 v33, v33
    v_cvt_pk_bf16_f32 v70, v60, v61
    v_exp_f32 v34, v34
    v_cvt_pk_bf16_f32 v71, v62, v63
    v_exp_f32 v35, v35
    s_waitcnt lgkmcnt(2)
    v_mfma_f32_32x32x16_bf16 v[48:63], v[76:79], v[8:11], 0
    ds_read_b128 v[72:75], v2 offset:26624
    ds_read_b64 v[80:81], v109 offset:29696
    v_exp_f32 v36, v36
    v_exp_f32 v37, v37
    v_cvt_pk_bf16_f32 v64, v32, v33
    v_exp_f32 v38, v38
    v_cvt_pk_bf16_f32 v65, v34, v35
    v_exp_f32 v39, v39
    v_mfma_f32_32x32x16_bf16 v[48:63], v[84:87], v[12:15], v[48:63]
    ds_read_b128 v[92:95], v2 offset:24320
    s_cbranch_vccnz Lg_76
    s_add_u32 m0, s88, 0
    s_nop 0
    buffer_load_dwordx4 v2, s[8:11], s87 offen offset:0 sc1 lds
    buffer_load_dwordx4 v2, s[8:11], s87 offen offset:1024 sc1 lds
Lg_76:
    v_exp_f32 v40, v40
    v_exp_f32 v41, v41
    v_cvt_pk_bf16_f32 v66, v36, v37
    v_exp_f32 v42, v42
    v_cvt_pk_bf16_f32 v67, v38, v39
    v_exp_f32 v43, v43
    v_mfma_f32_32x32x16_bf16 v[16:31], v[100:103], v[68:71], v[16:31]
    ds_read_b128 v[100:103], v2 offset:25344
    v_exp_f32 v44, v44
    v_exp_f32 v45, v45
    v_cvt_pk_bf16_f32 v68, v40, v41
    v_exp_f32 v46, v46
    v_cvt_pk_bf16_f32 v69, v42, v43
    v_exp_f32 v47, v47
    s_waitcnt lgkmcnt(4)
    v_mfma_f32_32x32x16_bf16 v[16:31], v[88:91], v[64:67], v[16:31]
    v_exp_f32 v48, v48
    v_exp_f32 v49, v49
    v_cvt_pk_bf16_f32 v70, v44, v45
    v_exp_f32 v50, v50
    v_cvt_pk_bf16_f32 v71, v46, v47
    v_exp_f32 v51, v51
    s_waitcnt lgkmcnt(2)
    v_mfma_f32_32x32x16_bf16 v[32:47], v[72:75], v[8:11], 0
    ds_read_b128 v[76:79], v2 offset:29952
    ds_read_b64 v[84:85], v109 offset:33024
    v_exp_f32 v52, v52
    v_exp_f32 v53, v53
    v_cvt_pk_bf16_f32 v64, v48, v49
    v_exp_f32 v54, v54
    v_cvt_pk_bf16_f32 v65, v50, v51
    v_exp_f32 v55, v55
    v_mfma_f32_32x32x16_bf16 v[32:47], v[80:83], v[12:15], v[32:47]
    ds_read_b128 v[88:91], v2 offset:27648
    s_cbranch_vccnz Lg_77
    s_add_u32 m0, s88, 0
    s_nop 0
    buffer_load_dwordx4 v2, s[8:11], s87 offen offset:2048 sc1 lds
    buffer_load_dwordx4 v2, s[8:11], s87 offen offset:3072 sc1 lds
    s_add_u32 s87, s87, 13312
Lg_77:
    v_exp_f32 v56, v56
    v_exp_f32 v57, v57
    v_cvt_pk_bf16_f32 v66, v52, v53
    v_exp_f32 v58, v58
    v_cvt_pk_bf16_f32 v67, v54, v55
    v_exp_f32 v59, v59
    v_mfma_f32_32x32x16_bf16 v[16:31], v[96:99], v[68:71], v[16:31]
    ds_read_b128 v[96:99], v2 offset:28672
    v_exp_f32 v60, v60
    v_exp_f32 v61, v61
    v_cvt_pk_bf16_f32 v68, v56, v57
    v_exp_f32 v62, v62
    v_cvt_pk_bf16_f32 v69, v58, v59
    v_exp_f32 v63, v63
    s_waitcnt lgkmcnt(4)
    v_mfma_f32_32x32x16_bf16 v[16:31], v[92:95], v[64:67], v[16:31]
    v_exp_f32 v32, v32
    v_exp_f32 v33, v33
    v_cvt_pk_bf16_f32 v70, v60, v61
    v_exp_f32 v34, v34
    v_cvt_pk_bf16_f32 v71, v62, v63
    v_exp_f32 v35, v35
    s_waitcnt lgkmcnt(2)
    v_mfma_f32_32x32x16_bf16 v[48:63], v[76:79], v[8:11], 0
    ds_read_b128 v[72:75], v2 offset:33280
    ds_read_b64 v[80:81], v109 offset:36352
    v_exp_f32 v36, v36
    v_exp_f32 v37, v37
    v_cvt_pk_bf16_f32 v64, v32, v33
    v_exp_f32 v38, v38
    v_cvt_pk_bf16_f32 v65, v34, v35
    v_exp_f32 v39, v39
    v_mfma_f32_32x32x16_bf16 v[48:63], v[84:87], v[12:15], v[48:63]
    ds_read_b128 v[92:95], v2 offset:30976
    v_exp_f32 v40, v40
    v_exp_f32 v41, v41
    v_cvt_pk_bf16_f32 v66, v36, v37
    v_exp_f32 v42, v42
    v_cvt_pk_bf16_f32 v67, v38, v39
    v_exp_f32 v43, v43
    v_mfma_f32_32x32x16_bf16 v[16:31], v[100:103], v[68:71], v[16:31]
    ds_read_b128 v[100:103], v2 offset:32000
    v_exp_f32 v44, v44
    v_exp_f32 v45, v45
    v_cvt_pk_bf16_f32 v68, v40, v41
    v_exp_f32 v46, v46
    v_cvt_pk_bf16_f32 v69, v42, v43
    v_exp_f32 v47, v47
    s_waitcnt lgkmcnt(4)
    v_mfma_f32_32x32x16_bf16 v[16:31], v[88:91], v[64:67], v[16:31]
    v_exp_f32 v48, v48
    v_exp_f32 v49, v49
    v_cvt_pk_bf16_f32 v70, v44, v45
    v_exp_f32 v50, v50
    v_cvt_pk_bf16_f32 v71, v46, v47
    v_exp_f32 v51, v51
    s_waitcnt lgkmcnt(2)
    v_mfma_f32_32x32x16_bf16 v[32:47], v[72:75], v[8:11], 0
    ds_read_b128 v[76:79], v2 offset:36608
    ds_read_b64 v[84:85], v109 offset:39680
    v_exp_f32 v52, v52
    v_exp_f32 v53, v53
    v_cvt_pk_bf16_f32 v64, v48, v49
    v_exp_f32 v54, v54
    v_cvt_pk_bf16_f32 v65, v50, v51
    v_exp_f32 v55, v55
    v_mfma_f32_32x32x16_bf16 v[32:47], v[80:83], v[12:15], v[32:47]
    ds_read_b128 v[88:91], v2 offset:34304
    s_cbranch_vccz Lg_78
    s_waitcnt vmcnt(0)
Lg_78:
    v_exp_f32 v56, v56
    v_exp_f32 v57, v57
    v_cvt_pk_bf16_f32 v66, v52, v53
    v_exp_f32 v58, v58
    v_cvt_pk_bf16_f32 v67, v54, v55
    v_exp_f32 v59, v59
    v_mfma_f32_32x32x16_bf16 v[16:31], v[96:99], v[68:71], v[16:31]
    ds_read_b128 v[96:99], v2 offset:35328
    v_exp_f32 v60, v60
    v_exp_f32 v61, v61
    v_cvt_pk_bf16_f32 v68, v56, v57
    v_exp_f32 v62, v62
    v_cvt_pk_bf16_f32 v69, v58, v59
    v_exp_f32 v63, v63
    s_waitcnt lgkmcnt(4)
    v_mfma_f32_32x32x16_bf16 v[16:31], v[92:95], v[64:67], v[16:31]
    s_cbranch_vccnz Lg_79
    s_waitcnt vmcnt(4)
Lg_79:
    s_barrier
    v_exp_f32 v32, v32
    v_exp_f32 v33, v33
    v_cvt_pk_bf16_f32 v70, v60, v61
    v_exp_f32 v34, v34
    v_cvt_pk_bf16_f32 v71, v62, v63
    v_exp_f32 v35, v35
    s_waitcnt lgkmcnt(2)
    v_mfma_f32_32x32x16_bf16 v[48:63], v[76:79], v[8:11], 0
    ds_read_b128 v[72:75], v2 offset:39936
    ds_read_b64 v[80:81], v109 offset:43008
    v_exp_f32 v36, v36
    v_exp_f32 v37, v37
    v_cvt_pk_bf16_f32 v64, v32, v33
    v_exp_f32 v38, v38
    v_cvt_pk_bf16_f32 v65, v34, v35
    v_exp_f32 v39, v39
    v_mfma_f32_32x32x16_bf16 v[48:63], v[84:87], v[12:15], v[48:63]
    ds_read_b128 v[92:95], v2 offset:37632
    s_cbranch_vccnz Lg_80
    s_add_u32 m0, s88, 13312
    s_nop 0
    buffer_load_dwordx4 v2, s[8:11], s87 offen offset:0 sc1 lds
    buffer_load_dwordx4 v2, s[8:11], s87 offen offset:1024 sc1 lds
Lg_80:
    v_exp_f32 v40, v40
    v_exp_f32 v41, v41
    v_cvt_pk_bf16_f32 v66, v36, v37
    v_exp_f32 v42, v42
    v_cvt_pk_bf16_f32 v67, v38, v39
    v_exp_f32 v43, v43
    v_mfma_f32_32x32x16_bf16 v[16:31], v[100:103], v[68:71], v[16:31]
    ds_read_b128 v[100:103], v2 offset:38656
    s_cmp_lg_u32 s65, 4
    s_cbranch_scc1 Lbg_40
    s_lshl_b32 s72, s60, 2
    s_add_u32 s72, s72, 98304
    v_mov_b32 v112, s66
    s_mov_b64 exec, 1
    buffer_store_dword v112, v1, s[8:11], s72 offen sc1
    s_mov_b64 exec, -1
Lbg_40:
    v_exp_f32 v44, v44
    v_exp_f32 v45, v45
    v_cvt_pk_bf16_f32 v68, v40, v41
    v_exp_f32 v46, v46
    v_cvt_pk_bf16_f32 v69, v42, v43
    v_exp_f32 v47, v47
    s_waitcnt lgkmcnt(4)
    v_mfma_f32_32x32x16_bf16 v[16:31], v[88:91], v[64:67], v[16:31]
    v_exp_f32 v48, v48
    v_exp_f32 v49, v49
    v_cvt_pk_bf16_f32 v70, v44, v45
    v_exp_f32 v50, v50
    v_cvt_pk_bf16_f32 v71, v46, v47
    v_exp_f32 v51, v51
    s_waitcnt lgkmcnt(2)
    v_mfma_f32_32x32x16_bf16 v[32:47], v[72:75], v[8:11], 0
    ds_read_b128 v[76:79], v2 offset:43264
    ds_read_b64 v[84:85], v109 offset:46336
    v_exp_f32 v52, v52
    v_exp_f32 v53, v53
    v_cvt_pk_bf16_f32 v64, v48, v49
    v_exp_f32 v54, v54
    v_cvt_pk_bf16_f32 v65, v50, v51
    v_exp_f32 v55, v55
    v_mfma_f32_32x32x16_bf16 v[32:47], v[80:83], v[12:15], v[32:47]
    ds_read_b128 v[88:91], v2 offset:40960
    s_cbranch_vccnz Lg_81
    s_add_u32 m0, s88, 13312
    s_nop 0
    buffer_load_dwordx4 v2, s[8:11], s87 offen offset:2048 sc1 lds
    buffer_load_dwordx4 v2, s[8:11], s87 offen offset:3072 sc1 lds
    s_add_u32 s87, s87, 13312
Lg_81:
    v_exp_f32 v56, v56
    v_exp_f32 v57, v57
    v_cvt_pk_bf16_f32 v66, v52, v53
    v_exp_f32 v58, v58
    v_cvt_pk_bf16_f32 v67, v54, v55
    v_exp_f32 v59, v59
    v_mfma_f32_32x32x16_bf16 v[16:31], v[96:99], v[68:71], v[16:31]
    ds_read_b128 v[96:99], v2 offset:41984
    v_exp_f32 v60, v60
    v_exp_f32 v61, v61
    v_cvt_pk_bf16_f32 v68, v56, v57
    v_exp_f32 v62, v62
    v_cvt_pk_bf16_f32 v69, v58, v59
    v_exp_f32 v63, v63
    s_waitcnt lgkmcnt(4)
    v_mfma_f32_32x32x16_bf16 v[16:31], v[92:95], v[64:67], v[16:31]
    v_exp_f32 v32, v32
    v_exp_f32 v33, v33
    v_cvt_pk_bf16_f32 v70, v60, v61
    v_exp_f32 v34, v34
    v_cvt_pk_bf16_f32 v71, v62, v63
    v_exp_f32 v35, v35
    s_waitcnt lgkmcnt(2)
    v_mfma_f32_32x32x16_bf16 v[48:63], v[76:79], v[8:11], 0
    ds_read_b128 v[72:75], v2 offset:46592
    ds_read_b64 v[80:81], v109 offset:49664
    v_exp_f32 v36, v36
    v_exp_f32 v37, v37
    v_cvt_pk_bf16_f32 v64, v32, v33
    v_exp_f32 v38, v38
    v_cvt_pk_bf16_f32 v65, v34, v35
    v_exp_f32 v39, v39
    v_mfma_f32_32x32x16_bf16 v[48:63], v[84:87], v[12:15], v[48:63]
    ds_read_b128 v[92:95], v2 offset:44288
    v_exp_f32 v40, v40
    v_exp_f32 v41, v41
    v_cvt_pk_bf16_f32 v66, v36, v37
    v_exp_f32 v42, v42
    v_cvt_pk_bf16_f32 v67, v38, v39
    v_exp_f32 v43, v43
    v_mfma_f32_32x32x16_bf16 v[16:31], v[100:103], v[68:71], v[16:31]
    ds_read_b128 v[100:103], v2 offset:45312
    v_exp_f32 v44, v44
    v_exp_f32 v45, v45
    v_cvt_pk_bf16_f32 v68, v40, v41
    v_exp_f32 v46, v46
    v_cvt_pk_bf16_f32 v69, v42, v43
    v_exp_f32 v47, v47
    s_waitcnt lgkmcnt(4)
    v_mfma_f32_32x32x16_bf16 v[16:31], v[88:91], v[64:67], v[16:31]
    v_exp_f32 v48, v48
    v_exp_f32 v49, v49
    v_cvt_pk_bf16_f32 v70, v44, v45
    v_exp_f32 v50, v50
    v_cvt_pk_bf16_f32 v71, v46, v47
    v_exp_f32 v51, v51
    s_waitcnt lgkmcnt(2)
    v_mfma_f32_32x32x16_bf16 v[32:47], v[72:75], v[8:11], 0
    ds_read_b128 v[76:79], v2 offset:49920
    ds_read_b64 v[84:85], v109 offset:52992
    v_exp_f32 v52, v52
    v_exp_f32 v53, v53
    v_cvt_pk_bf16_f32 v64, v48, v49
    v_exp_f32 v54, v54
    v_cvt_pk_bf16_f32 v65, v50, v51
    v_exp_f32 v55, v55
    v_mfma_f32_32x32x16_bf16 v[32:47], v[80:83], v[12:15], v[32:47]
    ds_read_b128 v[88:91], v2 offset:47616
    v_exp_f32 v56, v56
    v_exp_f32 v57, v57
    v_cvt_pk_bf16_f32 v66, v52, v53
    v_exp_f32 v58, v58
    v_cvt_pk_bf16_f32 v67, v54, v55
    v_exp_f32 v59, v59
    v_mfma_f32_32x32x16_bf16 v[16:31], v[96:99], v[68:71], v[16:31]
    ds_read_b128 v[96:99], v2 offset:48640
    v_exp_f32 v60, v60
    v_exp_f32 v61, v61
    v_cvt_pk_bf16_f32 v68, v56, v57
    v_exp_f32 v62, v62
    v_cvt_pk_bf16_f32 v69, v58, v59
    v_exp_f32 v63, v63
    s_waitcnt lgkmcnt(4)
    v_mfma_f32_32x32x16_bf16 v[16:31], v[92:95], v[64:67], v[16:31]
    s_cbranch_vccnz Lg_82
    s_waitcnt vmcnt(4)
Lg_82:
    s_barrier
    v_exp_f32 v32, v32
    v_exp_f32 v33, v33
    v_cvt_pk_bf16_f32 v70, v60, v61
    v_exp_f32 v34, v34
    v_cvt_pk_bf16_f32 v71, v62, v63
    v_exp_f32 v35, v35
    s_waitcnt lgkmcnt(2)
    v_mfma_f32_32x32x16_bf16 v[48:63], v[76:79], v[8:11], 0
    ds_read_b128 v[72:75], v2 offset:0
    ds_read_b64 v[80:81], v109 offset:3072
    v_exp_f32 v36, v36
    v_exp_f32 v37, v37
    v_cvt_pk_bf16_f32 v64, v32, v33
    v_exp_f32 v38, v38
    v_cvt_pk_bf16_f32 v65, v34, v35
    v_exp_f32 v39, v39
    v_mfma_f32_32x32x16_bf16 v[48:63], v[84:87], v[12:15], v[48:63]
    ds_read_b128 v[92:95], v2 offset:50944
    s_cbranch_vccnz Lg_83
    s_add_u32 m0, s88, 26624
    s_nop 0
    buffer_load_dwordx4 v2, s[8:11], s87 offen offset:0 sc1 lds
    buffer_load_dwordx4 v2, s[8:11], s87 offen offset:1024 sc1 lds
Lg_83:
    v_exp_f32 v40, v40
    v_exp_f32 v41, v41
    v_cvt_pk_bf16_f32 v66, v36, v37
    v_exp_f32 v42, v42
    v_cvt_pk_bf16_f32 v67, v38, v39
    v_exp_f32 v43, v43
    v_mfma_f32_32x32x16_bf16 v[16:31], v[100:103], v[68:71], v[16:31]
    ds_read_b128 v[100:103], v2 offset:51968
    v_exp_f32 v44, v44
    v_exp_f32 v45, v45
    v_cvt_pk_bf16_f32 v68, v40, v41
    v_exp_f32 v46, v46
    v_cvt_pk_bf16_f32 v69, v42, v43
    v_exp_f32 v47, v47
    s_waitcnt lgkmcnt(4)
    v_mfma_f32_32x32x16_bf16 v[16:31], v[88:91], v[64:67], v[16:31]
    v_exp_f32 v48, v48
    v_exp_f32 v49, v49
    v_cvt_pk_bf16_f32 v70, v44, v45
    v_exp_f32 v50, v50
    v_cvt_pk_bf16_f32 v71, v46, v47
    v_exp_f32 v51, v51
    s_waitcnt lgkmcnt(2)
    v_mfma_f32_32x32x16_bf16 v[32:47], v[72:75], v[8:11], 0
    ds_read_b128 v[76:79], v2 offset:3328
    ds_read_b64 v[84:85], v109 offset:6400
    v_exp_f32 v52, v52
    v_exp_f32 v53, v53
    v_cvt_pk_bf16_f32 v64, v48, v49
    v_exp_f32 v54, v54
    v_cvt_pk_bf16_f32 v65, v50, v51
    v_exp_f32 v55, v55
    v_mfma_f32_32x32x16_bf16 v[32:47], v[80:83], v[12:15], v[32:47]
    ds_read_b128 v[88:91], v2 offset:1024
    s_cbranch_vccnz Lg_84
    s_add_u32 m0, s88, 26624
    s_nop 0
    buffer_load_dwordx4 v2, s[8:11], s87 offen offset:2048 sc1 lds
    buffer_load_dwordx4 v2, s[8:11], s87 offen offset:3072 sc1 lds
    s_add_u32 s87, s87, 13312
Lg_84:
    v_exp_f32 v56, v56
    v_exp_f32 v57, v57
    v_cvt_pk_bf16_f32 v66, v52, v53
    v_exp_f32 v58, v58
    v_cvt_pk_bf16_f32 v67, v54, v55
    v_exp_f32 v59, v59
    v_mfma_f32_32x32x16_bf16 v[16:31], v[96:99], v[68:71], v[16:31]
    ds_read_b128 v[96:99], v2 offset:2048
    v_exp_f32 v60, v60
    v_exp_f32 v61, v61
    v_cvt_pk_bf16_f32 v68, v56, v57
    v_exp_f32 v62, v62
    v_cvt_pk_bf16_f32 v69, v58, v59
    v_exp_f32 v63, v63
    s_waitcnt lgkmcnt(4)
    v_mfma_f32_32x32x16_bf16 v[16:31], v[92:95], v[64:67], v[16:31]
    v_exp_f32 v32, v32
    v_exp_f32 v33, v33
    v_cvt_pk_bf16_f32 v70, v60, v61
    v_exp_f32 v34, v34
    v_cvt_pk_bf16_f32 v71, v62, v63
    v_exp_f32 v35, v35
    s_waitcnt lgkmcnt(2)
    v_mfma_f32_32x32x16_bf16 v[48:63], v[76:79], v[8:11], 0
    ds_read_b128 v[72:75], v2 offset:6656
    ds_read_b64 v[80:81], v109 offset:9728
    v_exp_f32 v36, v36
    v_exp_f32 v37, v37
    v_cvt_pk_bf16_f32 v64, v32, v33
    v_exp_f32 v38, v38
    v_cvt_pk_bf16_f32 v65, v34, v35
    v_exp_f32 v39, v39
    v_mfma_f32_32x32x16_bf16 v[48:63], v[84:87], v[12:15], v[48:63]
    ds_read_b128 v[92:95], v2 offset:4352
    s_cmp_lg_u32 s65, 7
    s_cbranch_scc1 Lbg_41
    s_mov_b32 s90, 0
Lbg_42:
    s_mov_b32 s72, 98304
    s_mov_b32 s73, 8192
    buffer_load_dwordx4 v[112:115], v2, s[8:11], s72 offen sc1
    v_min_u32 v120, 624, v2
    buffer_load_dwordx4 v[116:119], v120, s[8:11], s73 offen sc1
    s_waitcnt vmcnt(0)
    v_xor_b32 v112, s66, v112
    v_xor_b32 v113, s66, v113
    v_xor_b32 v114, s66, v114
    v_xor_b32 v115, s66, v115
    v_xor_b32 v116, s66, v116
    v_xor_b32 v117, s66, v117
    v_xor_b32 v118, s66, v118
    v_xor_b32 v119, s66, v119
    v_or3_b32 v112, v112, v113, v114
    v_or3_b32 v115, v115, v116, v117
    v_or3_b32 v112, v112, v118, v119
    v_or_b32 v112, v112, v115
    v_cmp_ne_u32 s[92:93], 0, v112
    s_nop 4
    s_cmp_eq_u64 s[92:93], 0
    s_cbranch_scc1 Lbg_41
    s_add_u32 s90, s90, 1
    s_cmp_lt_u32 s90, 400000
    s_cbranch_scc1 Lbg_42
Lbg_41:
    v_exp_f32 v40, v40
    v_exp_f32 v41, v41
    v_cvt_pk_bf16_f32 v66, v36, v37
    v_exp_f32 v42, v42
    v_cvt_pk_bf16_f32 v67, v38, v39
    v_exp_f32 v43, v43
    v_mfma_f32_32x32x16_bf16 v[16:31], v[100:103], v[68:71], v[16:31]
    ds_read_b128 v[100:103], v2 offset:5376
    v_exp_f32 v44, v44
    v_exp_f32 v45, v45
    v_cvt_pk_bf16_f32 v68, v40, v41
    v_exp_f32 v46, v46
    v_cvt_pk_bf16_f32 v69, v42, v43
    v_exp_f32 v47, v47
    s_waitcnt lgkmcnt(4)
    v_mfma_f32_32x32x16_bf16 v[16:31], v[88:91], v[64:67], v[16:31]
    v_exp_f32 v48, v48
    v_exp_f32 v49, v49
    v_cvt_pk_bf16_f32 v70, v44, v45
    v_exp_f32 v50, v50
    v_cvt_pk_bf16_f32 v71, v46, v47
    v_exp_f32 v51, v51
    s_waitcnt lgkmcnt(2)
    v_mfma_f32_32x32x16_bf16 v[32:47], v[72:75], v[8:11], 0
    ds_read_b128 v[76:79], v2 offset:9984
    ds_read_b64 v[84:85], v109 offset:13056
    v_exp_f32 v52, v52
    v_exp_f32 v53, v53
    v_cvt_pk_bf16_f32 v64, v48, v49
    v_exp_f32 v54, v54
    v_cvt_pk_bf16_f32 v65, v50, v51
    v_exp_f32 v55, v55
    v_mfma_f32_32x32x16_bf16 v[32:47], v[80:83], v[12:15], v[32:47]
    ds_read_b128 v[88:91], v2 offset:7680
    v_exp_f32 v56, v56
    v_exp_f32 v57, v57
    v_cvt_pk_bf16_f32 v66, v52, v53
    v_exp_f32 v58, v58
    v_cvt_pk_bf16_f32 v67, v54, v55
    v_exp_f32 v59, v59
    v_mfma_f32_32x32x16_bf16 v[16:31], v[96:99], v[68:71], v[16:31]
    ds_read_b128 v[96:99], v2 offset:8704
    v_exp_f32 v60, v60
    v_exp_f32 v61, v61
    v_cvt_pk_bf16_f32 v68, v56, v57
    v_exp_f32 v62, v62
    v_cvt_pk_bf16_f32 v69, v58, v59
    v_exp_f32 v63, v63
    s_waitcnt lgkmcnt(4)
    v_mfma_f32_32x32x16_bf16 v[16:31], v[92:95], v[64:67], v[16:31]
    s_cbranch_vccnz Lg_85
    s_waitcnt vmcnt(4)
Lg_85:
    s_barrier
    v_exp_f32 v32, v32
    v_exp_f32 v33, v33
    v_cvt_pk_bf16_f32 v70, v60, v61
    v_exp_f32 v34, v34
    v_cvt_pk_bf16_f32 v71, v62, v63
    v_exp_f32 v35, v35
    s_waitcnt lgkmcnt(2)
    v_mfma_f32_32x32x16_bf16 v[48:63], v[76:79], v[8:11], 0
    ds_read_b128 v[72:75], v2 offset:13312
    ds_read_b64 v[80:81], v109 offset:16384
    v_exp_f32 v36, v36
    v_exp_f32 v37, v37
    v_cvt_pk_bf16_f32 v64, v32, v33
    v_exp_f32 v38, v38
    v_cvt_pk_bf16_f32 v65, v34, v35
    v_exp_f32 v39, v39
    v_mfma_f32_32x32x16_bf16 v[48:63], v[84:87], v[12:15], v[48:63]
    ds_read_b128 v[92:95], v2 offset:11008
    s_cbranch_vccnz Lg_86
    s_add_u32 m0, s88, 39936
    s_nop 0
    buffer_load_dwordx4 v2, s[8:11], s87 offen offset:0 sc1 lds
    buffer_load_dwordx4 v2, s[8:11], s87 offen offset:1024 sc1 lds
Lg_86:
    v_exp_f32 v40, v40
    v_exp_f32 v41, v41
    v_cvt_pk_bf16_f32 v66, v36, v37
    v_exp_f32 v42, v42
    v_cvt_pk_bf16_f32 v67, v38, v39
    v_exp_f32 v43, v43
    v_mfma_f32_32x32x16_bf16 v[16:31], v[100:103], v[68:71], v[16:31]
    ds_read_b128 v[100:103], v2 offset:12032
    s_add_u32 m0, s85, 0
    s_nop 0
    buffer_load_dwordx4 v2, s[8:11], s43 offen offset:0 sc1 lds
    v_exp_f32 v44, v44
    v_exp_f32 v45, v45
    v_cvt_pk_bf16_f32 v68, v40, v41
    v_exp_f32 v46, v46
    v_cvt_pk_bf16_f32 v69, v42, v43
    v_exp_f32 v47, v47
    s_waitcnt lgkmcnt(4)
    v_mfma_f32_32x32x16_bf16 v[16:31], v[88:91], v[64:67], v[16:31]
    v_exp_f32 v48, v48
    v_exp_f32 v49, v49
    v_cvt_pk_bf16_f32 v70, v44, v45
    v_exp_f32 v50, v50
    v_cvt_pk_bf16_f32 v71, v46, v47
    v_exp_f32 v51, v51
    s_waitcnt lgkmcnt(2)
    v_mfma_f32_32x32x16_bf16 v[32:47], v[72:75], v[8:11], 0
    ds_read_b128 v[76:79], v2 offset:16640
    ds_read_b64 v[84:85], v109 offset:19712
    v_exp_f32 v52, v52
    v_exp_f32 v53, v53
    v_cvt_pk_bf16_f32 v64, v48, v49
    v_exp_f32 v54, v54
    v_cvt_pk_bf16_f32 v65, v50, v51
    v_exp_f32 v55, v55
    v_mfma_f32_32x32x16_bf16 v[32:47], v[80:83], v[12:15], v[32:47]
    ds_read_b128 v[88:91], v2 offset:14336
    s_cbranch_vccnz Lg_87
    s_add_u32 m0, s88, 39936
    s_nop 0
    buffer_load_dwordx4 v2, s[8:11], s87 offen offset:2048 sc1 lds
    buffer_load_dwordx4 v2, s[8:11], s87 offen offset:3072 sc1 lds
    s_add_u32 s87, s87, 13312
Lg_87:
    v_exp_f32 v56, v56
    v_exp_f32 v57, v57
    v_cvt_pk_bf16_f32 v66, v52, v53
    v_exp_f32 v58, v58
    v_cvt_pk_bf16_f32 v67, v54, v55
    v_exp_f32 v59, v59
    v_mfma_f32_32x32x16_bf16 v[16:31], v[96:99], v[68:71], v[16:31]
    ds_read_b128 v[96:99], v2 offset:15360
    s_min_u32 s72, s65, 2
    s_lshl_b32 s72, s72, 10
    s_add_u32 m0, s72, 155648
    s_add_u32 s72, s72, 59392
    buffer_load_dwordx4 v2, s[8:11], s72 offen sc1 lds
    v_exp_f32 v60, v60
    v_exp_f32 v61, v61
    v_cvt_pk_bf16_f32 v68, v56, v57
    v_exp_f32 v62, v62
    v_cvt_pk_bf16_f32 v69, v58, v59
    v_exp_f32 v63, v63
    s_waitcnt lgkmcnt(4)
    v_mfma_f32_32x32x16_bf16 v[16:31], v[92:95], v[64:67], v[16:31]
    v_exp_f32 v32, v32
    v_exp_f32 v33, v33
    v_cvt_pk_bf16_f32 v70, v60, v61
    v_exp_f32 v34, v34
    v_cvt_pk_bf16_f32 v71, v62, v63
    v_exp_f32 v35, v35
    s_waitcnt lgkmcnt(2)
    v_mfma_f32_32x32x16_bf16 v[48:63], v[76:79], v[8:11], 0
    ds_read_b128 v[72:75], v2 offset:19968
    ds_read_b64 v[80:81], v109 offset:23040
    v_exp_f32 v36, v36
    v_exp_f32 v37, v37
    v_cvt_pk_bf16_f32 v64, v32, v33
    v_exp_f32 v38, v38
    v_cvt_pk_bf16_f32 v65, v34, v35
    v_exp_f32 v39, v39
    v_mfma_f32_32x32x16_bf16 v[48:63], v[84:87], v[12:15], v[48:63]
    ds_read_b128 v[92:95], v2 offset:17664
    s_add_u32 m0, s85, 0
    s_nop 0
    buffer_load_dwordx4 v2, s[8:11], s43 offen offset:1024 sc1 lds
    v_exp_f32 v40, v40
    v_exp_f32 v41, v41
    v_cvt_pk_bf16_f32 v66, v36, v37
    v_exp_f32 v42, v42
    v_cvt_pk_bf16_f32 v67, v38, v39
    v_exp_f32 v43, v43
    v_mfma_f32_32x32x16_bf16 v[16:31], v[100:103], v[68:71], v[16:31]
    ds_read_b128 v[100:103], v2 offset:18688
    v_exp_f32 v44, v44
    v_exp_f32 v45, v45
    v_cvt_pk_bf16_f32 v68, v40, v41
    v_exp_f32 v46, v46
    v_cvt_pk_bf16_f32 v69, v42, v43
    v_exp_f32 v47, v47
    s_waitcnt lgkmcnt(4)
    v_mfma_f32_32x32x16_bf16 v[16:31], v[88:91], v[64:67], v[16:31]
    v_exp_f32 v48, v48
    v_exp_f32 v49, v49
    v_cvt_pk_bf16_f32 v70, v44, v45
    v_exp_f32 v50, v50
    v_cvt_pk_bf16_f32 v71, v46, v47
    v_exp_f32 v51, v51
    s_waitcnt lgkmcnt(2)
    v_mfma_f32_32x32x16_bf16 v[32:47], v[72:75], v[8:11], 0
    ds_read_b128 v[76:79], v2 offset:23296
    ds_read_b64 v[84:85], v109 offset:26368
    v_exp_f32 v52, v52
    v_exp_f32 v53, v53
    v_cvt_pk_bf16_f32 v64, v48, v49
    v_exp_f32 v54, v54
    v_cvt_pk_bf16_f32 v65, v50, v51
    v_exp_f32 v55, v55
    v_mfma_f32_32x32x16_bf16 v[32:47], v[80:83], v[12:15], v[32:47]
    ds_read_b128 v[88:91], v2 offset:20992
    s_add_u32 m0, s85, 0
    s_nop 0
    buffer_load_dwordx4 v2, s[8:11], s43 offen offset:2048 sc1 lds
    v_exp_f32 v56, v56
    v_exp_f32 v57, v57
    v_cvt_pk_bf16_f32 v66, v52, v53
    v_exp_f32 v58, v58
    v_cvt_pk_bf16_f32 v67, v54, v55
    v_exp_f32 v59, v59
    v_mfma_f32_32x32x16_bf16 v[16:31], v[96:99], v[68:71], v[16:31]
    ds_read_b128 v[96:99], v2 offset:22016
    v_exp_f32 v60, v60
    v_exp_f32 v61, v61
    v_cvt_pk_bf16_f32 v68, v56, v57
    v_exp_f32 v62, v62
    v_cvt_pk_bf16_f32 v69, v58, v59
    v_exp_f32 v63, v63
    s_waitcnt lgkmcnt(4)
    v_mfma_f32_32x32x16_bf16 v[16:31], v[92:95], v[64:67], v[16:31]
    s_cbranch_vccnz Lg_88
    s_waitcnt vmcnt(8)
Lg_88:
    s_barrier
    v_exp_f32 v32, v32
    v_exp_f32 v33, v33
    v_cvt_pk_bf16_f32 v70, v60, v61
    v_exp_f32 v34, v34
    v_cvt_pk_bf16_f32 v71, v62, v63
    v_exp_f32 v35, v35
    s_waitcnt lgkmcnt(2)
    v_mfma_f32_32x32x16_bf16 v[48:63], v[76:79], v[8:11], 0
    ds_read_b128 v[72:75], v2 offset:26624
    ds_read_b64 v[80:81], v109 offset:29696
    v_exp_f32 v36, v36
    v_exp_f32 v37, v37
    v_cvt_pk_bf16_f32 v64, v32, v33
    v_exp_f32 v38, v38
    v_cvt_pk_bf16_f32 v65, v34, v35
    v_exp_f32 v39, v39
    v_mfma_f32_32x32x16_bf16 v[48:63], v[84:87], v[12:15], v[48:63]
    ds_read_b128 v[92:95], v2 offset:24320
    s_cbranch_vccnz Lg_89
    s_add_u32 m0, s88, 0
    s_nop 0
    buffer_load_dwordx4 v2, s[8:11], s87 offen offset:0 sc1 lds
    buffer_load_dwordx4 v2, s[8:11], s87 offen offset:1024 sc1 lds
Lg_89:
    v_exp_f32 v40, v40
    v_exp_f32 v41, v41
    v_cvt_pk_bf16_f32 v66, v36, v37
    v_exp_f32 v42, v42
    v_cvt_pk_bf16_f32 v67, v38, v39
    v_exp_f32 v43, v43
    v_mfma_f32_32x32x16_bf16 v[16:31], v[100:103], v[68:71], v[16:31]
    ds_read_b128 v[100:103], v2 offset:25344
    s_add_u32 m0, s85, 0
    s_nop 0
    buffer_load_dwordx4 v2, s[8:11], s43 offen offset:3072 sc1 lds
    s_add_u32 s43, s43, 4096
    v_exp_f32 v44, v44
    v_exp_f32 v45, v45
    v_cvt_pk_bf16_f32 v68, v40, v41
    v_exp_f32 v46, v46
    v_cvt_pk_bf16_f32 v69, v42, v43
    v_exp_f32 v47, v47
    s_waitcnt lgkmcnt(4)
    v_mfma_f32_32x32x16_bf16 v[16:31], v[88:91], v[64:67], v[16:31]
    v_exp_f32 v48, v48
    v_exp_f32 v49, v49
    v_cvt_pk_bf16_f32 v70, v44, v45
    v_exp_f32 v50, v50
    v_cvt_pk_bf16_f32 v71, v46, v47
    v_exp_f32 v51, v51
    s_waitcnt lgkmcnt(2)
    v_mfma_f32_32x32x16_bf16 v[32:47], v[72:75], v[8:11], 0
    ds_read_b128 v[76:79], v2 offset:29952
    ds_read_b64 v[84:85], v109 offset:33024
    v_exp_f32 v52, v52
    v_exp_f32 v53, v53
    v_cvt_pk_bf16_f32 v64, v48, v49
    v_exp_f32 v54, v54
    v_cvt_pk_bf16_f32 v65, v50, v51
    v_exp_f32 v55, v55
    v_mfma_f32_32x32x16_bf16 v[32:47], v[80:83], v[12:15], v[32:47]
    ds_read_b128 v[88:91], v2 offset:27648
    s_cbranch_vccnz Lg_90
    s_add_u32 m0, s88, 0
    s_nop 0
    buffer_load_dwordx4 v2, s[8:11], s87 offen offset:2048 sc1 lds
    buffer_load_dwordx4 v2, s[8:11], s87 offen offset:3072 sc1 lds
    s_add_u32 s87, s87, 13312
Lg_90:
    v_exp_f32 v56, v56
    v_exp_f32 v57, v57
    v_cvt_pk_bf16_f32 v66, v52, v53
    v_exp_f32 v58, v58
    v_cvt_pk_bf16_f32 v67, v54, v55
    v_exp_f32 v59, v59
    v_mfma_f32_32x32x16_bf16 v[16:31], v[96:99], v[68:71], v[16:31]
    ds_read_b128 v[96:99], v2 offset:28672
    v_exp_f32 v60, v60
    v_exp_f32 v61, v61
    v_cvt_pk_bf16_f32 v68, v56, v57
    v_exp_f32 v62, v62
    v_cvt_pk_bf16_f32 v69, v58, v59
    v_exp_f32 v63, v63
    s_waitcnt lgkmcnt(4)
    v_mfma_f32_32x32x16_bf16 v[16:31], v[92:95], v[64:67], v[16:31]
    v_exp_f32 v32, v32
    v_exp_f32 v33, v33
    v_cvt_pk_bf16_f32 v70, v60, v61
    v_exp_f32 v34, v34
    v_cvt_pk_bf16_f32 v71, v62, v63
    v_exp_f32 v35, v35
    s_waitcnt lgkmcnt(2)
    v_mfma_f32_32x32x16_bf16 v[48:63], v[76:79], v[8:11], 0
    ds_read_b128 v[72:75], v2 offset:33280
    ds_read_b64 v[80:81], v109 offset:36352
    v_exp_f32 v36, v36
    v_exp_f32 v37, v37
    v_cvt_pk_bf16_f32 v64, v32, v33
    v_exp_f32 v38, v38
    v_cvt_pk_bf16_f32 v65, v34, v35
    v_exp_f32 v39, v39
    v_mfma_f32_32x32x16_bf16 v[48:63], v[84:87], v[12:15], v[48:63]
    ds_read_b128 v[92:95], v2 offset:30976
    s_add_u32 m0, s85, 4096
    s_nop 0
    buffer_load_dwordx4 v2, s[8:11], s43 offen offset:0 sc1 lds
    v_exp_f32 v40, v40
    v_exp_f32 v41, v41
    v_cvt_pk_bf16_f32 v66, v36, v37
    v_exp_f32 v42, v42
    v_cvt_pk_bf16_f32 v67, v38, v39
    v_exp_f32 v43, v43
    v_mfma_f32_32x32x16_bf16 v[16:31], v[100:103], v[68:71], v[16:31]
    ds_read_b128 v[100:103], v2 offset:32000
    v_exp_f32 v44, v44
    v_exp_f32 v45, v45
    v_cvt_pk_bf16_f32 v68, v40, v41
    v_exp_f32 v46, v46
    v_cvt_pk_bf16_f32 v69, v42, v43
    v_exp_f32 v47, v47
    s_waitcnt lgkmcnt(4)
    v_mfma_f32_32x32x16_bf16 v[16:31], v[88:91], v[64:67], v[16:31]
    v_exp_f32 v48, v48
    v_exp_f32 v49, v49
    v_cvt_pk_bf16_f32 v70, v44, v45
    v_exp_f32 v50, v50
    v_cvt_pk_bf16_f32 v71, v46, v47
    v_exp_f32 v51, v51
    s_waitcnt lgkmcnt(2)
    v_mfma_f32_32x32x16_bf16 v[32:47], v[72:75], v[8:11], 0
    ds_read_b128 v[76:79], v2 offset:36608
    ds_read_b64 v[84:85], v109 offset:39680
    v_exp_f32 v52, v52
    v_exp_f32 v53, v53
    v_cvt_pk_bf16_f32 v64, v48, v49
    v_exp_f32 v54, v54
    v_cvt_pk_bf16_f32 v65, v50, v51
    v_exp_f32 v55, v55
    v_mfma_f32_32x32x16_bf16 v[32:47], v[80:83], v[12:15], v[32:47]
    ds_read_b128 v[88:91], v2 offset:34304
    s_add_u32 m0, s85, 4096
    s_nop 0
    buffer_load_dwordx4 v2, s[8:11], s43 offen offset:1024 sc1 lds
    v_exp_f32 v56, v56
    v_exp_f32 v57, v57
    v_cvt_pk_bf16_f32 v66, v52, v53
    v_exp_f32 v58, v58
    v_cvt_pk_bf16_f32 v67, v54, v55
    v_exp_f32 v59, v59
    v_mfma_f32_32x32x16_bf16 v[16:31], v[96:99], v[68:71], v[16:31]
    ds_read_b128 v[96:99], v2 offset:35328
    v_exp_f32 v60, v60
    v_exp_f32 v61, v61
    v_cvt_pk_bf16_f32 v68, v56, v57
    v_exp_f32 v62, v62
    v_cvt_pk_bf16_f32 v69, v58, v59
    v_exp_f32 v63, v63
    s_waitcnt lgkmcnt(4)
    v_mfma_f32_32x32x16_bf16 v[16:31], v[92:95], v[64:67], v[16:31]
    s_cbranch_vccnz Lg_91
    s_waitcnt vmcnt(10)
Lg_91:
    s_barrier
    v_exp_f32 v32, v32
    v_exp_f32 v33, v33
    v_cvt_pk_bf16_f32 v70, v60, v61
    v_exp_f32 v34, v34
    v_cvt_pk_bf16_f32 v71, v62, v63
    v_exp_f32 v35, v35
    s_waitcnt lgkmcnt(2)
    v_mfma_f32_32x32x16_bf16 v[48:63], v[76:79], v[8:11], 0
    ds_read_b128 v[72:75], v2 offset:39936
    ds_read_b64 v[80:81], v109 offset:43008
    v_exp_f32 v36, v36
    v_exp_f32 v37, v37
    v_cvt_pk_bf16_f32 v64, v32, v33
    v_exp_f32 v38, v38
    v_cvt_pk_bf16_f32 v65, v34, v35
    v_exp_f32 v39, v39
    v_mfma_f32_32x32x16_bf16 v[48:63], v[84:87], v[12:15], v[48:63]
    ds_read_b128 v[92:95], v2 offset:37632
    s_cbranch_vccnz Lg_92
    s_add_u32 m0, s88, 13312
    s_nop 0
    buffer_load_dwordx4 v2, s[8:11], s87 offen offset:0 sc1 lds
    buffer_load_dwordx4 v2, s[8:11], s87 offen offset:1024 sc1 lds
Lg_92:
    v_exp_f32 v40, v40
    v_exp_f32 v41, v41
    v_cvt_pk_bf16_f32 v66, v36, v37
    v_exp_f32 v42, v42
    v_cvt_pk_bf16_f32 v67, v38, v39
    v_exp_f32 v43, v43
    v_mfma_f32_32x32x16_bf16 v[16:31], v[100:103], v[68:71], v[16:31]
    ds_read_b128 v[100:103], v2 offset:38656
    s_add_u32 m0, s85, 4096
    s_nop 0
    buffer_load_dwordx4 v2, s[8:11], s43 offen offset:2048 sc1 lds
    v_exp_f32 v44, v44
    v_exp_f32 v45, v45
    v_cvt_pk_bf16_f32 v68, v40, v41
    v_exp_f32 v46, v46
    v_cvt_pk_bf16_f32 v69, v42, v43
    v_exp_f32 v47, v47
    s_waitcnt lgkmcnt(4)
    v_mfma_f32_32x32x16_bf16 v[16:31], v[88:91], v[64:67], v[16:31]
    v_exp_f32 v48, v48
    v_exp_f32 v49, v49
    v_cvt_pk_bf16_f32 v70, v44, v45
    v_exp_f32 v50, v50
    v_cvt_pk_bf16_f32 v71, v46, v47
    v_exp_f32 v51, v51
    s_waitcnt lgkmcnt(2)
    v_mfma_f32_32x32x16_bf16 v[32:47], v[72:75], v[8:11], 0
    ds_read_b128 v[76:79], v2 offset:43264
    ds_read_b64 v[84:85], v109 offset:46336
    v_exp_f32 v52, v52
    v_exp_f32 v53, v53
    v_cvt_pk_bf16_f32 v64, v48, v49
    v_exp_f32 v54, v54
    v_cvt_pk_bf16_f32 v65, v50, v51
    v_exp_f32 v55, v55
    v_mfma_f32_32x32x16_bf16 v[32:47], v[80:83], v[12:15], v[32:47]
    ds_read_b128 v[88:91], v2 offset:40960
    s_cbranch_vccnz Lg_93
    s_add_u32 m0, s88, 13312
    s_nop 0
    buffer_load_dwordx4 v2, s[8:11], s87 offen offset:2048 sc1 lds
    buffer_load_dwordx4 v2, s[8:11], s87 offen offset:3072 sc1 lds
    s_add_u32 s87, s87, 13312
Lg_93:
    v_exp_f32 v56, v56
    v_exp_f32 v57, v57
    v_cvt_pk_bf16_f32 v66, v52, v53
    v_exp_f32 v58, v58
    v_cvt_pk_bf16_f32 v67, v54, v55
    v_exp_f32 v59, v59
    v_mfma_f32_32x32x16_bf16 v[16:31], v[96:99], v[68:71], v[16:31]
    ds_read_b128 v[96:99], v2 offset:41984
    v_exp_f32 v60, v60
    v_exp_f32 v61, v61
    v_cvt_pk_bf16_f32 v68, v56, v57
    v_exp_f32 v62, v62
    v_cvt_pk_bf16_f32 v69, v58, v59
    v_exp_f32 v63, v63
    s_waitcnt lgkmcnt(4)
    v_mfma_f32_32x32x16_bf16 v[16:31], v[92:95], v[64:67], v[16:31]
    v_exp_f32 v32, v32
    v_exp_f32 v33, v33
    v_cvt_pk_bf16_f32 v70, v60, v61
    v_exp_f32 v34, v34
    v_cvt_pk_bf16_f32 v71, v62, v63
    v_exp_f32 v35, v35
    s_waitcnt lgkmcnt(2)
    v_mfma_f32_32x32x16_bf16 v[48:63], v[76:79], v[8:11], 0
    ds_read_b128 v[72:75], v2 offset:46592
    ds_read_b64 v[80:81], v109 offset:49664
    v_exp_f32 v36, v36
    v_exp_f32 v37, v37
    v_cvt_pk_bf16_f32 v64, v32, v33
    v_exp_f32 v38, v38
    v_cvt_pk_bf16_f32 v65, v34, v35
    v_exp_f32 v39, v39
    v_mfma_f32_32x32x16_bf16 v[48:63], v[84:87], v[12:15], v[48:63]
    ds_read_b128 v[92:95], v2 offset:44288
    s_add_u32 m0, s85, 4096
    s_nop 0
    buffer_load_dwordx4 v2, s[8:11], s43 offen offset:3072 sc1 lds
    s_add_u32 s43, s43, 4096
    v_exp_f32 v40, v40
    v_exp_f32 v41, v41
    v_cvt_pk_bf16_f32 v66, v36, v37
    v_exp_f32 v42, v42
    v_cvt_pk_bf16_f32 v67, v38, v39
    v_exp_f32 v43, v43
    v_mfma_f32_32x32x16_bf16 v[16:31], v[100:103], v[68:71], v[16:31]
    ds_read_b128 v[100:103], v2 offset:45312
    v_exp_f32 v44, v44
    v_exp_f32 v45, v45
    v_cvt_pk_bf16_f32 v68, v40, v41
    v_exp_f32 v46, v46
    v_cvt_pk_bf16_f32 v69, v42, v43
    v_exp_f32 v47, v47
    s_waitcnt lgkmcnt(4)
    v_mfma_f32_32x32x16_bf16 v[16:31], v[88:91], v[64:67], v[16:31]
    v_exp_f32 v48, v48
    v_exp_f32 v49, v49
    v_cvt_pk_bf16_f32 v70, v44, v45
    v_exp_f32 v50, v50
    v_cvt_pk_bf16_f32 v71, v46, v47
    v_exp_f32 v51, v51
    s_waitcnt lgkmcnt(2)
    v_mfma_f32_32x32x16_bf16 v[32:47], v[72:75], v[8:11], 0
    ds_read_b128 v[76:79], v2 offset:49920
    ds_read_b64 v[84:85], v109 offset:52992
    v_exp_f32 v52, v52
    v_exp_f32 v53, v53
    v_cvt_pk_bf16_f32 v64, v48, v49
    v_exp_f32 v54, v54
    v_cvt_pk_bf16_f32 v65, v50, v51
    v_exp_f32 v55, v55
    v_mfma_f32_32x32x16_bf16 v[32:47], v[80:83], v[12:15], v[32:47]
    ds_read_b128 v[88:91], v2 offset:47616
    s_add_u32 m0, s85, 8192
    s_nop 0
    buffer_load_dwordx4 v2, s[8:11], s43 offen offset:0 sc1 lds
    v_exp_f32 v56, v56
    v_exp_f32 v57, v57
    v_cvt_pk_bf16_f32 v66, v52, v53
    v_exp_f32 v58, v58
    v_cvt_pk_bf16_f32 v67, v54, v55
    v_exp_f32 v59, v59
    v_mfma_f32_32x32x16_bf16 v[16:31], v[96:99], v[68:71], v[16:31]
    ds_read_b128 v[96:99], v2 offset:48640
    v_exp_f32 v60, v60
    v_exp_f32 v61, v61
    v_cvt_pk_bf16_f32 v68, v56, v57
    v_exp_f32 v62, v62
    v_cvt_pk_bf16_f32 v69, v58, v59
    v_exp_f32 v63, v63
    s_waitcnt lgkmcnt(4)
    v_mfma_f32_32x32x16_bf16 v[16:31], v[92:95], v[64:67], v[16:31]
    s_cbranch_vccnz Lg_94
    s_waitcnt vmcnt(9)
Lg_94:
    s_barrier
    v_exp_f32 v32, v32
    v_exp_f32 v33, v33
    v_cvt_pk_bf16_f32 v70, v60, v61
    v_exp_f32 v34, v34
    v_cvt_pk_bf16_f32 v71, v62, v63
    v_exp_f32 v35, v35
    s_waitcnt lgkmcnt(2)
    v_mfma_f32_32x32x16_bf16 v[48:63], v[76:79], v[8:11], 0
    ds_read_b128 v[72:75], v2 offset:0
    ds_read_b64 v[80:81], v109 offset:3072
    v_exp_f32 v36, v36
    v_exp_f32 v37, v37
    v_cvt_pk_bf16_f32 v64, v32, v33
    v_exp_f32 v38, v38
    v_cvt_pk_bf16_f32 v65, v34, v35
    v_exp_f32 v39, v39
    v_mfma_f32_32x32x16_bf16 v[48:63], v[84:87], v[12:15], v[48:63]
    ds_read_b128 v[92:95], v2 offset:50944
    s_cbranch_vccnz Lg_95
    s_add_u32 m0, s88, 26624
    s_nop 0
    buffer_load_dwordx4 v2, s[8:11], s87 offen offset:0 sc1 lds
    buffer_load_dwordx4 v2, s[8:11], s87 offen offset:1024 sc1 lds
Lg_95:
    v_exp_f32 v40, v40
    v_exp_f32 v41, v41
    v_cvt_pk_bf16_f32 v66, v36, v37
    v_exp_f32 v42, v42
    v_cvt_pk_bf16_f32 v67, v38, v39
    v_exp_f32 v43, v43
    v_mfma_f32_32x32x16_bf16 v[16:31], v[100:103], v[68:71], v[16:31]
    ds_read_b128 v[100:103], v2 offset:51968
    s_add_u32 m0, s85, 8192
    s_nop 0
    buffer_load_dwordx4 v2, s[8:11], s43 offen offset:1024 sc1 lds
    v_exp_f32 v44, v44
    v_exp_f32 v45, v45
    v_cvt_pk_bf16_f32 v68, v40, v41
    v_exp_f32 v46, v46
    v_cvt_pk_bf16_f32 v69, v42, v43
    v_exp_f32 v47, v47
    s_waitcnt lgkmcnt(4)
    v_mfma_f32_32x32x16_bf16 v[16:31], v[88:91], v[64:67], v[16:31]
    v_exp_f32 v48, v48
    v_exp_f32 v49, v49
    v_cvt_pk_bf16_f32 v70, v44, v45
    v_exp_f32 v50, v50
    v_cvt_pk_bf16_f32 v71, v46, v47
    v_exp_f32 v51, v51
    s_waitcnt lgkmcnt(2)
    v_mfma_f32_32x32x16_bf16 v[32:47], v[72:75], v[8:11], 0
    ds_read_b128 v[76:79], v2 offset:3328
    ds_read_b64 v[84:85], v109 offset:6400
    v_exp_f32 v52, v52
    v_exp_f32 v53, v53
    v_cvt_pk_bf16_f32 v64, v48, v49
    v_exp_f32 v54, v54
    v_cvt_pk_bf16_f32 v65, v50, v51
    v_exp_f32 v55, v55
    v_mfma_f32_32x32x16_bf16 v[32:47], v[80:83], v[12:15], v[32:47]
    ds_read_b128 v[88:91], v2 offset:1024
    s_cbranch_vccnz Lg_96
    s_add_u32 m0, s88, 26624
    s_nop 0
    buffer_load_dwordx4 v2, s[8:11], s87 offen offset:2048 sc1 lds
    buffer_load_dwordx4 v2, s[8:11], s87 offen offset:3072 sc1 lds
    s_add_u32 s87, s87, 13312
Lg_96:
    v_exp_f32 v56, v56
    v_exp_f32 v57, v57
    v_cvt_pk_bf16_f32 v66, v52, v53
    v_exp_f32 v58, v58
    v_cvt_pk_bf16_f32 v67, v54, v55
    v_exp_f32 v59, v59
    v_mfma_f32_32x32x16_bf16 v[16:31], v[96:99], v[68:71], v[16:31]
    ds_read_b128 v[96:99], v2 offset:2048
    v_exp_f32 v60, v60
    v_exp_f32 v61, v61
    v_cvt_pk_bf16_f32 v68, v56, v57
    v_exp_f32 v62, v62
    v_cvt_pk_bf16_f32 v69, v58, v59
    v_exp_f32 v63, v63
    s_waitcnt lgkmcnt(4)
    v_mfma_f32_32x32x16_bf16 v[16:31], v[92:95], v[64:67], v[16:31]
    v_exp_f32 v32, v32
    v_exp_f32 v33, v33
    v_cvt_pk_bf16_f32 v70, v60, v61
    v_exp_f32 v34, v34
    v_cvt_pk_bf16_f32 v71, v62, v63
    v_exp_f32 v35, v35
    s_waitcnt lgkmcnt(2)
    v_mfma_f32_32x32x16_bf16 v[48:63], v[76:79], v[8:11], 0
    ds_read_b128 v[72:75], v2 offset:6656
    ds_read_b64 v[80:81], v109 offset:9728
    v_exp_f32 v36, v36
    v_exp_f32 v37, v37
    v_cvt_pk_bf16_f32 v64, v32, v33
    v_exp_f32 v38, v38
    v_cvt_pk_bf16_f32 v65, v34, v35
    v_exp_f32 v39, v39
    v_mfma_f32_32x32x16_bf16 v[48:63], v[84:87], v[12:15], v[48:63]
    ds_read_b128 v[92:95], v2 offset:4352
    s_add_u32 m0, s85, 8192
    s_nop 0
    buffer_load_dwordx4 v2, s[8:11], s43 offen offset:2048 sc1 lds
    v_exp_f32 v40, v40
    v_exp_f32 v41, v41
    v_cvt_pk_bf16_f32 v66, v36, v37
    v_exp_f32 v42, v42
    v_cvt_pk_bf16_f32 v67, v38, v39
    v_exp_f32 v43, v43
    v_mfma_f32_32x32x16_bf16 v[16:31], v[100:103], v[68:71], v[16:31]
    ds_read_b128 v[100:103], v2 offset:5376
    v_exp_f32 v44, v44
    v_exp_f32 v45, v45
    v_cvt_pk_bf16_f32 v68, v40, v41
    v_exp_f32 v46, v46
    v_cvt_pk_bf16_f32 v69, v42, v43
    v_exp_f32 v47, v47
    s_waitcnt lgkmcnt(4)
    v_mfma_f32_32x32x16_bf16 v[16:31], v[88:91], v[64:67], v[16:31]
    v_exp_f32 v48, v48
    v_exp_f32 v49, v49
    v_cvt_pk_bf16_f32 v70, v44, v45
    v_exp_f32 v50, v50
    v_cvt_pk_bf16_f32 v71, v46, v47
    v_exp_f32 v51, v51
    s_waitcnt lgkmcnt(2)
    v_mfma_f32_32x32x16_bf16 v[32:47], v[72:75], v[8:11], 0
    ds_read_b128 v[76:79], v2 offset:9984
    ds_read_b64 v[84:85], v109 offset:13056
    v_exp_f32 v52, v52
    v_exp_f32 v53, v53
    v_cvt_pk_bf16_f32 v64, v48, v49
    v_exp_f32 v54, v54
    v_cvt_pk_bf16_f32 v65, v50, v51
    v_exp_f32 v55, v55
    v_mfma_f32_32x32x16_bf16 v[32:47], v[80:83], v[12:15], v[32:47]
    ds_read_b128 v[88:91], v2 offset:7680
    s_add_u32 m0, s85, 8192
    s_nop 0
    buffer_load_dwordx4 v2, s[8:11], s43 offen offset:3072 sc1 lds
    s_add_u32 s43, s43, 4096
    v_exp_f32 v56, v56
    v_exp_f32 v57, v57
    v_cvt_pk_bf16_f32 v66, v52, v53
    v_exp_f32 v58, v58
    v_cvt_pk_bf16_f32 v67, v54, v55
    v_exp_f32 v59, v59
    v_mfma_f32_32x32x16_bf16 v[16:31], v[96:99], v[68:71], v[16:31]
    ds_read_b128 v[96:99], v2 offset:8704
    v_exp_f32 v60, v60
    v_exp_f32 v61, v61
    v_cvt_pk_bf16_f32 v68, v56, v57
    v_exp_f32 v62, v62
    v_cvt_pk_bf16_f32 v69, v58, v59
    v_exp_f32 v63, v63
    s_waitcnt lgkmcnt(4)
    v_mfma_f32_32x32x16_bf16 v[16:31], v[92:95], v[64:67], v[16:31]
    s_cbranch_vccnz Lg_97
    s_waitcnt vmcnt(9)
Lg_97:
    s_barrier
    v_exp_f32 v32, v32
    v_exp_f32 v33, v33
    v_cvt_pk_bf16_f32 v70, v60, v61
    v_exp_f32 v34, v34
    v_cvt_pk_bf16_f32 v71, v62, v63
    v_exp_f32 v35, v35
    s_waitcnt lgkmcnt(2)
    v_mfma_f32_32x32x16_bf16 v[48:63], v[76:79], v[8:11], 0
    ds_read_b128 v[72:75], v2 offset:13312
    ds_read_b64 v[80:81], v109 offset:16384
    v_exp_f32 v36, v36
    v_exp_f32 v37, v37
    v_cvt_pk_bf16_f32 v64, v32, v33
    v_exp_f32 v38, v38
    v_cvt_pk_bf16_f32 v65, v34, v35
    v_exp_f32 v39, v39
    v_mfma_f32_32x32x16_bf16 v[48:63], v[84:87], v[12:15], v[48:63]
    ds_read_b128 v[92:95], v2 offset:11008
    s_cbranch_vccnz Lg_98
    s_add_u32 m0, s88, 39936
    s_nop 0
    buffer_load_dwordx4 v2, s[8:11], s87 offen offset:0 sc1 lds
    buffer_load_dwordx4 v2, s[8:11], s87 offen offset:1024 sc1 lds
Lg_98:
    v_exp_f32 v40, v40
    v_exp_f32 v41, v41
    v_cvt_pk_bf16_f32 v66, v36, v37
    v_exp_f32 v42, v42
    v_cvt_pk_bf16_f32 v67, v38, v39
    v_exp_f32 v43, v43
    v_mfma_f32_32x32x16_bf16 v[16:31], v[100:103], v[68:71], v[16:31]
    ds_read_b128 v[100:103], v2 offset:12032
    s_add_u32 m0, s85, 12288
    s_nop 0
    buffer_load_dwordx4 v2, s[8:11], s43 offen offset:0 sc1 lds
    v_exp_f32 v44, v44
    v_exp_f32 v45, v45
    v_cvt_pk_bf16_f32 v68, v40, v41
    v_exp_f32 v46, v46
    v_cvt_pk_bf16_f32 v69, v42, v43
    v_exp_f32 v47, v47
    s_waitcnt lgkmcnt(4)
    v_mfma_f32_32x32x16_bf16 v[16:31], v[88:91], v[64:67], v[16:31]
    v_exp_f32 v48, v48
    v_exp_f32 v49, v49
    v_cvt_pk_bf16_f32 v70, v44, v45
    v_exp_f32 v50, v50
    v_cvt_pk_bf16_f32 v71, v46, v47
    v_exp_f32 v51, v51
    s_waitcnt lgkmcnt(2)
    v_mfma_f32_32x32x16_bf16 v[32:47], v[72:75], v[8:11], 0
    ds_read_b128 v[76:79], v2 offset:16640
    ds_read_b64 v[84:85], v109 offset:19712
    v_exp_f32 v52, v52
    v_exp_f32 v53, v53
    v_cvt_pk_bf16_f32 v64, v48, v49
    v_exp_f32 v54, v54
    v_cvt_pk_bf16_f32 v65, v50, v51
    v_exp_f32 v55, v55
    v_mfma_f32_32x32x16_bf16 v[32:47], v[80:83], v[12:15], v[32:47]
    ds_read_b128 v[88:91], v2 offset:14336
    s_cbranch_vccnz Lg_99
    s_add_u32 m0, s88, 39936
    s_nop 0
    buffer_load_dwordx4 v2, s[8:11], s87 offen offset:2048 sc1 lds
    buffer_load_dwordx4 v2, s[8:11], s87 offen offset:3072 sc1 lds
    s_add_u32 s87, s87, 13312
Lg_99:
    v_exp_f32 v56, v56
    v_exp_f32 v57, v57
    v_cvt_pk_bf16_f32 v66, v52, v53
    v_exp_f32 v58, v58
    v_cvt_pk_bf16_f32 v67, v54, v55
    v_exp_f32 v59, v59
    v_mfma_f32_32x32x16_bf16 v[16:31], v[96:99], v[68:71], v[16:31]
    ds_read_b128 v[96:99], v2 offset:15360
    v_exp_f32 v60, v60
    v_exp_f32 v61, v61
    v_cvt_pk_bf16_f32 v68, v56, v57
    v_exp_f32 v62, v62
    v_cvt_pk_bf16_f32 v69, v58, v59
    v_exp_f32 v63, v63
    s_waitcnt lgkmcnt(4)
    v_mfma_f32_32x32x16_bf16 v[16:31], v[92:95], v[64:67], v[16:31]
    v_exp_f32 v32, v32
    v_exp_f32 v33, v33
    v_cvt_pk_bf16_f32 v70, v60, v61
    v_exp_f32 v34, v34
    v_cvt_pk_bf16_f32 v71, v62, v63
    v_exp_f32 v35, v35
    s_waitcnt lgkmcnt(2)
    v_mfma_f32_32x32x16_bf16 v[48:63], v[76:79], v[8:11], 0
    ds_read_b128 v[72:75], v2 offset:19968
    ds_read_b64 v[80:81], v109 offset:23040
    v_exp_f32 v36, v36
    v_exp_f32 v37, v37
    v_cvt_pk_bf16_f32 v64, v32, v33
    v_exp_f32 v38, v38
    v_cvt_pk_bf16_f32 v65, v34, v35
    v_exp_f32 v39, v39
    v_mfma_f32_32x32x16_bf16 v[48:63], v[84:87], v[12:15], v[48:63]
    ds_read_b128 v[92:95], v2 offset:17664
    v_exp_f32 v40, v40
    v_exp_f32 v41, v41
    v_cvt_pk_bf16_f32 v66, v36, v37
    v_exp_f32 v42, v42
    v_cvt_pk_bf16_f32 v67, v38, v39
    v_exp_f32 v43, v43
    v_mfma_f32_32x32x16_bf16 v[16:31], v[100:103], v[68:71], v[16:31]
    ds_read_b128 v[100:103], v2 offset:18688
    v_exp_f32 v44, v44
    v_exp_f32 v45, v45
    v_cvt_pk_bf16_f32 v68, v40, v41
    v_exp_f32 v46, v46
    v_cvt_pk_bf16_f32 v69, v42, v43
    v_exp_f32 v47, v47
    s_waitcnt lgkmcnt(4)
    v_mfma_f32_32x32x16_bf16 v[16:31], v[88:91], v[64:67], v[16:31]
    v_exp_f32 v48, v48
    v_exp_f32 v49, v49
    v_cvt_pk_bf16_f32 v70, v44, v45
    v_exp_f32 v50, v50
    v_cvt_pk_bf16_f32 v71, v46, v47
    v_exp_f32 v51, v51
    s_waitcnt lgkmcnt(2)
    v_mfma_f32_32x32x16_bf16 v[32:47], v[72:75], v[8:11], 0
    ds_read_b128 v[76:79], v2 offset:23296
    ds_read_b64 v[84:85], v109 offset:26368
    v_exp_f32 v52, v52
    v_exp_f32 v53, v53
    v_cvt_pk_bf16_f32 v64, v48, v49
    v_exp_f32 v54, v54
    v_cvt_pk_bf16_f32 v65, v50, v51
    v_exp_f32 v55, v55
    v_mfma_f32_32x32x16_bf16 v[32:47], v[80:83], v[12:15], v[32:47]
    ds_read_b128 v[88:91], v2 offset:20992
    v_exp_f32 v56, v56
    v_exp_f32 v57, v57
    v_cvt_pk_bf16_f32 v66, v52, v53
    v_exp_f32 v58, v58
    v_cvt_pk_bf16_f32 v67, v54, v55
    v_exp_f32 v59, v59
    v_mfma_f32_32x32x16_bf16 v[16:31], v[96:99], v[68:71], v[16:31]
    ds_read_b128 v[96:99], v2 offset:22016
    v_exp_f32 v60, v60
    v_exp_f32 v61, v61
    v_cvt_pk_bf16_f32 v68, v56, v57
    v_exp_f32 v62, v62
    v_cvt_pk_bf16_f32 v69, v58, v59
    v_exp_f32 v63, v63
    s_waitcnt lgkmcnt(4)
    v_mfma_f32_32x32x16_bf16 v[16:31], v[92:95], v[64:67], v[16:31]
    s_cbranch_vccnz Lg_100
    s_waitcnt vmcnt(7)
Lg_100:
    s_barrier
    v_exp_f32 v32, v32
    v_exp_f32 v33, v33
    v_cvt_pk_bf16_f32 v70, v60, v61
    v_exp_f32 v34, v34
    v_cvt_pk_bf16_f32 v71, v62, v63
    v_exp_f32 v35, v35
    s_waitcnt lgkmcnt(2)
    v_mfma_f32_32x32x16_bf16 v[48:63], v[76:79], v[8:11], 0
    ds_read_b128 v[72:75], v2 offset:26624
    ds_read_b64 v[80:81], v109 offset:29696
    v_exp_f32 v36, v36
    v_exp_f32 v37, v37
    v_cvt_pk_bf16_f32 v64, v32, v33
    v_exp_f32 v38, v38
    v_cvt_pk_bf16_f32 v65, v34, v35
    v_exp_f32 v39, v39
    v_mfma_f32_32x32x16_bf16 v[48:63], v[84:87], v[12:15], v[48:63]
    ds_read_b128 v[92:95], v2 offset:24320
    v_exp_f32 v40, v40
    v_exp_f32 v41, v41
    v_cvt_pk_bf16_f32 v66, v36, v37
    v_exp_f32 v42, v42
    v_cvt_pk_bf16_f32 v67, v38, v39
    v_exp_f32 v43, v43
    v_mfma_f32_32x32x16_bf16 v[16:31], v[100:103], v[68:71], v[16:31]
    ds_read_b128 v[100:103], v2 offset:25344
    v_exp_f32 v44, v44
    v_exp_f32 v45, v45
    v_cvt_pk_bf16_f32 v68, v40, v41
    v_exp_f32 v46, v46
    v_cvt_pk_bf16_f32 v69, v42, v43
    v_exp_f32 v47, v47
    s_waitcnt lgkmcnt(4)
    v_mfma_f32_32x32x16_bf16 v[16:31], v[88:91], v[64:67], v[16:31]
    v_exp_f32 v48, v48
    v_exp_f32 v49, v49
    v_cvt_pk_bf16_f32 v70, v44, v45
    v_exp_f32 v50, v50
    v_cvt_pk_bf16_f32 v71, v46, v47
    v_exp_f32 v51, v51
    s_waitcnt lgkmcnt(2)
    v_mfma_f32_32x32x16_bf16 v[32:47], v[72:75], v[8:11], 0
    ds_read_b128 v[76:79], v2 offset:29952
    ds_read_b64 v[84:85], v109 offset:33024
    v_exp_f32 v52, v52
    v_exp_f32 v53, v53
    v_cvt_pk_bf16_f32 v64, v48, v49
    v_exp_f32 v54, v54
    v_cvt_pk_bf16_f32 v65, v50, v51
    v_exp_f32 v55, v55
    v_mfma_f32_32x32x16_bf16 v[32:47], v[80:83], v[12:15], v[32:47]
    ds_read_b128 v[88:91], v2 offset:27648
    v_exp_f32 v56, v56
    v_exp_f32 v57, v57
    v_cvt_pk_bf16_f32 v66, v52, v53
    v_exp_f32 v58, v58
    v_cvt_pk_bf16_f32 v67, v54, v55
    v_exp_f32 v59, v59
    v_mfma_f32_32x32x16_bf16 v[16:31], v[96:99], v[68:71], v[16:31]
    ds_read_b128 v[96:99], v2 offset:28672
    v_exp_f32 v60, v60
    v_exp_f32 v61, v61
    v_cvt_pk_bf16_f32 v68, v56, v57
    v_exp_f32 v62, v62
    v_cvt_pk_bf16_f32 v69, v58, v59
    v_exp_f32 v63, v63
    s_waitcnt lgkmcnt(4)
    v_mfma_f32_32x32x16_bf16 v[16:31], v[92:95], v[64:67], v[16:31]
    v_exp_f32 v32, v32
    v_exp_f32 v33, v33
    v_cvt_pk_bf16_f32 v70, v60, v61
    v_exp_f32 v34, v34
    v_cvt_pk_bf16_f32 v71, v62, v63
    v_exp_f32 v35, v35
    s_waitcnt lgkmcnt(2)
    v_mfma_f32_32x32x16_bf16 v[48:63], v[76:79], v[8:11], 0
    ds_read_b128 v[72:75], v2 offset:33280
    ds_read_b64 v[80:81], v109 offset:36352
    v_exp_f32 v36, v36
    v_exp_f32 v37, v37
    v_cvt_pk_bf16_f32 v64, v32, v33
    v_exp_f32 v38, v38
    v_cvt_pk_bf16_f32 v65, v34, v35
    v_exp_f32 v39, v39
    v_mfma_f32_32x32x16_bf16 v[48:63], v[84:87], v[12:15], v[48:63]
    ds_read_b128 v[92:95], v2 offset:30976
    v_exp_f32 v40, v40
    v_exp_f32 v41, v41
    v_cvt_pk_bf16_f32 v66, v36, v37
    v_exp_f32 v42, v42
    v_cvt_pk_bf16_f32 v67, v38, v39
    v_exp_f32 v43, v43
    v_mfma_f32_32x32x16_bf16 v[16:31], v[100:103], v[68:71], v[16:31]
    ds_read_b128 v[100:103], v2 offset:32000
    v_exp_f32 v44, v44
    v_exp_f32 v45, v45
    v_cvt_pk_bf16_f32 v68, v40, v41
    v_exp_f32 v46, v46
    v_cvt_pk_bf16_f32 v69, v42, v43
    v_exp_f32 v47, v47
    s_waitcnt lgkmcnt(4)
    v_mfma_f32_32x32x16_bf16 v[16:31], v[88:91], v[64:67], v[16:31]
    v_exp_f32 v48, v48
    v_exp_f32 v49, v49
    v_cvt_pk_bf16_f32 v70, v44, v45
    v_exp_f32 v50, v50
    v_cvt_pk_bf16_f32 v71, v46, v47
    v_exp_f32 v51, v51
    s_waitcnt lgkmcnt(2)
    v_mfma_f32_32x32x16_bf16 v[32:47], v[72:75], v[8:11], 0
    ds_read_b128 v[76:79], v2 offset:36608
    ds_read_b64 v[84:85], v109 offset:39680
    v_exp_f32 v52, v52
    v_exp_f32 v53, v53
    v_cvt_pk_bf16_f32 v64, v48, v49
    v_exp_f32 v54, v54
    v_cvt_pk_bf16_f32 v65, v50, v51
    v_exp_f32 v55, v55
    v_mfma_f32_32x32x16_bf16 v[32:47], v[80:83], v[12:15], v[32:47]
    ds_read_b128 v[88:91], v2 offset:34304
    v_exp_f32 v56, v56
    v_exp_f32 v57, v57
    v_cvt_pk_bf16_f32 v66, v52, v53
    v_exp_f32 v58, v58
    v_cvt_pk_bf16_f32 v67, v54, v55
    v_exp_f32 v59, v59
    v_mfma_f32_32x32x16_bf16 v[16:31], v[96:99], v[68:71], v[16:31]
    ds_read_b128 v[96:99], v2 offset:35328
    v_exp_f32 v60, v60
    v_exp_f32 v61, v61
    v_cvt_pk_bf16_f32 v68, v56, v57
    v_exp_f32 v62, v62
    v_cvt_pk_bf16_f32 v69, v58, v59
    v_exp_f32 v63, v63
    s_waitcnt lgkmcnt(4)
    v_mfma_f32_32x32x16_bf16 v[16:31], v[92:95], v[64:67], v[16:31]
    s_cbranch_vccnz Lg_101
    s_waitcnt vmcnt(0)
Lg_101:
    s_barrier
    v_exp_f32 v32, v32
    v_exp_f32 v33, v33
    v_cvt_pk_bf16_f32 v70, v60, v61
    v_exp_f32 v34, v34
    v_cvt_pk_bf16_f32 v71, v62, v63
    v_exp_f32 v35, v35
    s_waitcnt lgkmcnt(2)
    v_mfma_f32_32x32x16_bf16 v[48:63], v[76:79], v[8:11], 0
    ds_read_b128 v[72:75], v2 offset:39936
    ds_read_b64 v[80:81], v109 offset:43008
    v_exp_f32 v36, v36
    v_exp_f32 v37, v37
    v_cvt_pk_bf16_f32 v64, v32, v33
    v_exp_f32 v38, v38
    v_cvt_pk_bf16_f32 v65, v34, v35
    v_exp_f32 v39, v39
    v_mfma_f32_32x32x16_bf16 v[48:63], v[84:87], v[12:15], v[48:63]
    ds_read_b128 v[92:95], v2 offset:37632
    s_add_u32 m0, s89, 0
    s_nop 0
    buffer_load_dwordx4 v110, s[20:23], s86 offen lds
    s_add_u32 s86, s86, 110592
    v_exp_f32 v40, v40
    v_exp_f32 v41, v41
    v_cvt_pk_bf16_f32 v66, v36, v37
    v_exp_f32 v42, v42
    v_cvt_pk_bf16_f32 v67, v38, v39
    v_exp_f32 v43, v43
    v_mfma_f32_32x32x16_bf16 v[16:31], v[100:103], v[68:71], v[16:31]
    ds_read_b128 v[100:103], v2 offset:38656
    v_exp_f32 v44, v44
    v_exp_f32 v45, v45
    v_cvt_pk_bf16_f32 v68, v40, v41
    v_exp_f32 v46, v46
    v_cvt_pk_bf16_f32 v69, v42, v43
    v_exp_f32 v47, v47
    s_waitcnt lgkmcnt(4)
    v_mfma_f32_32x32x16_bf16 v[16:31], v[88:91], v[64:67], v[16:31]
    v_exp_f32 v48, v48
    v_exp_f32 v49, v49
    v_cvt_pk_bf16_f32 v70, v44, v45
    v_exp_f32 v50, v50
    v_cvt_pk_bf16_f32 v71, v46, v47
    v_exp_f32 v51, v51
    s_waitcnt lgkmcnt(2)
    v_mfma_f32_32x32x16_bf16 v[32:47], v[72:75], v[8:11], 0
    ds_read_b128 v[76:79], v2 offset:43264
    ds_read_b64 v[84:85], v109 offset:46336
    v_exp_f32 v52, v52
    v_exp_f32 v53, v53
    v_cvt_pk_bf16_f32 v64, v48, v49
    v_exp_f32 v54, v54
    v_cvt_pk_bf16_f32 v65, v50, v51
    v_exp_f32 v55, v55
    v_mfma_f32_32x32x16_bf16 v[32:47], v[80:83], v[12:15], v[32:47]
    ds_read_b128 v[88:91], v2 offset:40960
    s_add_u32 m0, s89, 1024
    s_nop 0
    buffer_load_dwordx4 v110, s[20:23], s86 offen lds
    s_add_u32 s86, s86, 110592
    v_exp_f32 v56, v56
    v_exp_f32 v57, v57
    v_cvt_pk_bf16_f32 v66, v52, v53
    v_exp_f32 v58, v58
    v_cvt_pk_bf16_f32 v67, v54, v55
    v_exp_f32 v59, v59
    v_mfma_f32_32x32x16_bf16 v[16:31], v[96:99], v[68:71], v[16:31]
    ds_read_b128 v[96:99], v2 offset:41984
    v_exp_f32 v60, v60
    v_exp_f32 v61, v61
    v_cvt_pk_bf16_f32 v68, v56, v57
    v_exp_f32 v62, v62
    v_cvt_pk_bf16_f32 v69, v58, v59
    v_exp_f32 v63, v63
    s_waitcnt lgkmcnt(4)
    v_mfma_f32_32x32x16_bf16 v[16:31], v[92:95], v[64:67], v[16:31]
    v_exp_f32 v32, v32
    v_exp_f32 v33, v33
    v_cvt_pk_bf16_f32 v70, v60, v61
    v_exp_f32 v34, v34
    v_cvt_pk_bf16_f32 v71, v62, v63
    v_exp_f32 v35, v35
    s_waitcnt lgkmcnt(2)
    v_mfma_f32_32x32x16_bf16 v[48:63], v[76:79], v[8:11], 0
    ds_read_b128 v[72:75], v2 offset:46592
    ds_read_b64 v[80:81], v109 offset:49664
    v_exp_f32 v36, v36
    v_exp_f32 v37, v37
    v_cvt_pk_bf16_f32 v64, v32, v33
    v_exp_f32 v38, v38
    v_cvt_pk_bf16_f32 v65, v34, v35
    v_exp_f32 v39, v39
    v_mfma_f32_32x32x16_bf16 v[48:63], v[84:87], v[12:15], v[48:63]
    ds_read_b128 v[92:95], v2 offset:44288
    v_exp_f32 v40, v40
    v_exp_f32 v41, v41
    v_cvt_pk_bf16_f32 v66, v36, v37
    v_exp_f32 v42, v42
    v_cvt_pk_bf16_f32 v67, v38, v39
    v_exp_f32 v43, v43
    v_mfma_f32_32x32x16_bf16 v[16:31], v[100:103], v[68:71], v[16:31]
    ds_read_b128 v[100:103], v2 offset:45312
    v_exp_f32 v44, v44
    v_exp_f32 v45, v45
    v_cvt_pk_bf16_f32 v68, v40, v41
    v_exp_f32 v46, v46
    v_cvt_pk_bf16_f32 v69, v42, v43
    v_exp_f32 v47, v47
    s_waitcnt lgkmcnt(4)
    v_mfma_f32_32x32x16_bf16 v[16:31], v[88:91], v[64:67], v[16:31]
    v_exp_f32 v48, v48
    v_exp_f32 v49, v49
    v_cvt_pk_bf16_f32 v70, v44, v45
    v_exp_f32 v50, v50
    v_cvt_pk_bf16_f32 v71, v46, v47
    v_exp_f32 v51, v51
    s_waitcnt lgkmcnt(2)
    v_mfma_f32_32x32x16_bf16 v[32:47], v[72:75], v[8:11], 0
    ds_read_b128 v[76:79], v2 offset:49920
    ds_read_b64 v[84:85], v109 offset:52992
    v_exp_f32 v52, v52
    v_exp_f32 v53, v53
    v_cvt_pk_bf16_f32 v64, v48, v49
    v_exp_f32 v54, v54
    v_cvt_pk_bf16_f32 v65, v50, v51
    v_exp_f32 v55, v55
    v_mfma_f32_32x32x16_bf16 v[32:47], v[80:83], v[12:15], v[32:47]
    ds_read_b128 v[88:91], v2 offset:47616
    v_exp_f32 v56, v56
    v_exp_f32 v57, v57
    v_cvt_pk_bf16_f32 v66, v52, v53
    v_exp_f32 v58, v58
    v_cvt_pk_bf16_f32 v67, v54, v55
    v_exp_f32 v59, v59
    v_mfma_f32_32x32x16_bf16 v[16:31], v[96:99], v[68:71], v[16:31]
    ds_read_b128 v[96:99], v2 offset:48640
    v_exp_f32 v60, v60
    v_exp_f32 v61, v61
    v_cvt_pk_bf16_f32 v68, v56, v57
    v_exp_f32 v62, v62
    v_cvt_pk_bf16_f32 v69, v58, v59
    v_exp_f32 v63, v63
    s_waitcnt lgkmcnt(4)
    v_mfma_f32_32x32x16_bf16 v[16:31], v[92:95], v[64:67], v[16:31]
    s_barrier
    v_exp_f32 v32, v32
    v_exp_f32 v33, v33
    v_cvt_pk_bf16_f32 v70, v60, v61
    v_exp_f32 v34, v34
    v_cvt_pk_bf16_f32 v71, v62, v63
    v_exp_f32 v35, v35
    s_waitcnt lgkmcnt(2)
    v_mfma_f32_32x32x16_bf16 v[48:63], v[76:79], v[8:11], 0
    ds_read_b128 v[72:75], v2 offset:0
    ds_read_b64 v[80:81], v109 offset:3072
    v_exp_f32 v36, v36
    v_exp_f32 v37, v37
    v_cvt_pk_bf16_f32 v64, v32, v33
    v_exp_f32 v38, v38
    v_cvt_pk_bf16_f32 v65, v34, v35
    v_exp_f32 v39, v39
    v_mfma_f32_32x32x16_bf16 v[48:63], v[84:87], v[12:15], v[48:63]
    ds_read_b128 v[92:95], v2 offset:50944
    s_add_u32 m0, s89, 2048
    s_nop 0
    buffer_load_dwordx4 v110, s[20:23], s86 offen lds
    v_exp_f32 v40, v40
    v_exp_f32 v41, v41
    v_cvt_pk_bf16_f32 v66, v36, v37
    v_exp_f32 v42, v42
    v_cvt_pk_bf16_f32 v67, v38, v39
    v_exp_f32 v43, v43
    v_mfma_f32_32x32x16_bf16 v[16:31], v[100:103], v[68:71], v[16:31]
    ds_read_b128 v[100:103], v2 offset:51968
    v_exp_f32 v44, v44
    v_exp_f32 v45, v45
    v_cvt_pk_bf16_f32 v68, v40, v41
    v_exp_f32 v46, v46
    v_cvt_pk_bf16_f32 v69, v42, v43
    v_exp_f32 v47, v47
    s_waitcnt lgkmcnt(4)
    v_mfma_f32_32x32x16_bf16 v[16:31], v[88:91], v[64:67], v[16:31]
    v_exp_f32 v48, v48
    v_exp_f32 v49, v49
    v_cvt_pk_bf16_f32 v70, v44, v45
    v_exp_f32 v50, v50
    v_cvt_pk_bf16_f32 v71, v46, v47
    v_exp_f32 v51, v51
    s_waitcnt lgkmcnt(2)
    v_mfma_f32_32x32x16_bf16 v[32:47], v[72:75], v[8:11], 0
    ds_read_b128 v[76:79], v2 offset:3328
    ds_read_b64 v[84:85], v109 offset:6400
    v_exp_f32 v52, v52
    v_exp_f32 v53, v53
    v_cvt_pk_bf16_f32 v64, v48, v49
    v_exp_f32 v54, v54
    v_cvt_pk_bf16_f32 v65, v50, v51
    v_exp_f32 v55, v55
    v_mfma_f32_32x32x16_bf16 v[32:47], v[80:83], v[12:15], v[32:47]
    ds_read_b128 v[88:91], v2 offset:1024
    v_exp_f32 v56, v56
    v_exp_f32 v57, v57
    v_cvt_pk_bf16_f32 v66, v52, v53
    v_exp_f32 v58, v58
    v_cvt_pk_bf16_f32 v67, v54, v55
    v_exp_f32 v59, v59
    v_mfma_f32_32x32x16_bf16 v[16:31], v[96:99], v[68:71], v[16:31]
    ds_read_b128 v[96:99], v2 offset:2048
    v_exp_f32 v60, v60
    v_exp_f32 v61, v61
    v_cvt_pk_bf16_f32 v68, v56, v57
    v_exp_f32 v62, v62
    v_cvt_pk_bf16_f32 v69, v58, v59
    v_exp_f32 v63, v63
    s_waitcnt lgkmcnt(4)
    v_mfma_f32_32x32x16_bf16 v[16:31], v[92:95], v[64:67], v[16:31]
    s_setprio 0
    v_cvt_pk_bf16_f32 v70, v60, v61
    v_cvt_pk_bf16_f32 v71, v62, v63
    s_waitcnt lgkmcnt(0)
    s_nop 0
    v_mfma_f32_32x32x16_bf16 v[16:31], v[100:103], v[68:71], v[16:31]
    s_lshl_b32 s70, s63, 2
    s_lshl_b32 s71, s97, 1
    s_add_u32 s70, s70, s71
    s_mul_i32 s70, s70, 24576
    s_add_u32 s70, s70, 1048576
    s_lshl_b32 s71, s64, 2
    s_add_u32 s71, s71, s69
    s_mul_i32 s71, s71, 768
    s_add_u32 s70, s70, s71
    v_bfe_u32 v32, v1, 4, 1
    v_mul_u32_u24 v32, 24576, v32
    v_and_b32 v33, 15, v1
    v_lshl_add_u32 v32, v33, 4, v32
    v_lshrrev_b32 v33, 5, v1
    v_lshl_add_u32 v33, v33, 8, v32
    v_cmp_gt_u32 vcc, 32, v1
    v_mov_b32 v50, 0
    v_mov_b32 v51, 0
    v_cndmask_b32 v40, v24, v28, vcc
    v_rcp_f32 v40, v40
    s_nop 0
    v_mul_f32 v16, v16, v40
    v_mul_f32 v17, v17, v40
    v_mul_f32 v18, v18, v40
    v_mul_f32 v19, v19, v40
    v_mul_f32 v20, v20, v40
    v_mul_f32 v21, v21, v40
    v_mul_f32 v22, v22, v40
    v_mul_f32 v23, v23, v40
    v_mul_f32 v24, v24, v40
    v_mul_f32 v25, v25, v40
    v_mul_f32 v26, v26, v40
    v_mul_f32 v27, v27, v40
    v_cvt_pk_bf16_f32 v44, v16, v17
    v_cvt_pk_bf16_f32 v45, v18, v19
    v_cvt_pk_bf16_f32 v46, v20, v21
    v_cvt_pk_bf16_f32 v47, v22, v23
    v_cvt_pk_bf16_f32 v48, v24, v25
    v_cvt_pk_bf16_f32 v49, v26, v27
    buffer_store_dwordx4 v[44:47], v33, s[8:11], s70 offen sc1
    s_mov_b32 exec_hi, 0
    buffer_store_dwordx4 v[48:51], v32, s[8:11], s70 offen offset:512 sc1
    s_mov_b64 exec, -1
    s_lshl_b32 s70, s60, 2
    s_add_u32 s70, s70, 12288
    v_mov_b32 v255, s66
    s_waitcnt vmcnt(0)
    s_barrier
    s_cmp_lg_u32 s65, 0
    s_cbranch_scc1 Lwf_102
    s_mov_b64 exec, 1
    buffer_store_dword v255, v1, s[8:11], s70 offen sc1
    s_mov_b64 exec, -1
Lwf_102:
    s_mul_i32 s98, s62, 7
    s_mul_i32 s72, s62, 6
    s_add_u32 s72, s72, 12
    s_min_u32 s72, s72, 101
    s_cmp_lt_u32 s62, 12
    s_cselect_b32 s98, s98, s72
    s_lshl_b32 s85, s65, 11
    s_mul_i32 s84, s62, 286720
    s_add_u32 s84, s84, s85
    s_add_u32 s84, s84, 19824640
    s_add_u32 s85, s85, 20480
    s_mul_i32 s71, s97, 48
    s_mul_i32 s72, s64, 80
    s_add_u32 s71, s71, s72
    v_lshrrev_b32 v28, 4, v1
    v_lshlrev_b32 v29, 4, v28
    s_lshl_b32 s80, s71, 2
    s_add_u32 s80, s80, 49152
    s_add_u32 s81, s80, 5120
    s_add_u32 s82, s80, 7680
    v_and_b32 v253, 15, v1
    v_mul_u32_u24 v253, 1280, v253
    v_lshl_add_u32 v253, v28, 3, v253
    s_mul_i32 s72, s28, 20480
    s_lshl_b32 s71, s71, 1
    s_add_u32 s30, s72, s71
    s_cmp_lg_u32 s65, 7
    s_cbranch_scc1 Lnoutj_103
    s_cmp_ge_u32 s60, 216
    s_cbranch_scc1 Lnoutj_103
    v_lshrrev_b32 v42, 4, v1
    v_bfe_u32 v41, v1, 2, 2
    v_lshl_add_u32 v40, v42, 3, v41
    v_lshlrev_b32 v40, 5, v40
    v_and_b32 v41, 3, v1
    v_lshl_add_u32 v40, v41, 3, v40
    v_add_u32 v40, 0, v40
    v_and_b32 v43, 1, v1
    v_xor_b32 v43, 1, v43
    v_mul_u32_u24 v43, 1280, v43
    v_lshl_add_u32 v43, v42, 4, v43
    v_add_u32 v43, 155648, v43
    ds_read_b64_tr_b16 v[128:129], v40 offset:0
    ds_read_b64_tr_b16 v[130:131], v40 offset:128
    ds_read_b128 v[132:135], v43 offset:0
    ds_read_b64_tr_b16 v[136:137], v40 offset:1024
    ds_read_b64_tr_b16 v[138:139], v40 offset:1152
    ds_read_b128 v[140:143], v43 offset:64
    ds_read_b64_tr_b16 v[144:145], v40 offset:2048
    ds_read_b64_tr_b16 v[146:147], v40 offset:2176
    ds_read_b128 v[148:151], v43 offset:128
    ds_read_b64_tr_b16 v[152:153], v40 offset:3072
    ds_read_b64_tr_b16 v[154:155], v40 offset:3200
    ds_read_b128 v[156:159], v43 offset:192
    s_waitcnt lgkmcnt(9)
    v_mfma_f32_16x16x32_bf16 v[44:47], v[128:131], v[132:135], 0
    ds_read_b64_tr_b16 v[160:161], v40 offset:4096
    ds_read_b64_tr_b16 v[162:163], v40 offset:4224
    ds_read_b128 v[164:167], v43 offset:256
    s_waitcnt lgkmcnt(9)
    v_mfma_f32_16x16x32_bf16 v[44:47], v[136:139], v[140:143], v[44:47]
    ds_read_b64_tr_b16 v[168:169], v40 offset:5120
    ds_read_b64_tr_b16 v[170:171], v40 offset:5248
    ds_read_b128 v[172:175], v43 offset:320
    s_waitcnt lgkmcnt(9)
    v_mfma_f32_16x16x32_bf16 v[44:47], v[144:147], v[148:151], v[44:47]
    ds_read_b64_tr_b16 v[176:177], v40 offset:6144
    ds_read_b64_tr_b16 v[178:179], v40 offset:6272
    ds_read_b128 v[180:183], v43 offset:384
    s_waitcnt lgkmcnt(9)
    v_mfma_f32_16x16x32_bf16 v[44:47], v[152:155], v[156:159], v[44:47]
    ds_read_b64_tr_b16 v[184:185], v40 offset:7168
    ds_read_b64_tr_b16 v[186:187], v40 offset:7296
    ds_read_b128 v[188:191], v43 offset:448
    s_waitcnt lgkmcnt(9)
    v_mfma_f32_16x16x32_bf16 v[44:47], v[160:163], v[164:167], v[44:47]
    ds_read_b64_tr_b16 v[192:193], v40 offset:8192
    ds_read_b64_tr_b16 v[194:195], v40 offset:8320
    ds_read_b128 v[196:199], v43 offset:512
    s_waitcnt lgkmcnt(9)
    v_mfma_f32_16x16x32_bf16 v[44:47], v[168:171], v[172:175], v[44:47]
    ds_read_b64_tr_b16 v[200:201], v40 offset:9216
    ds_read_b64_tr_b16 v[202:203], v40 offset:9344
    ds_read_b128 v[204:207], v43 offset:576
    s_waitcnt lgkmcnt(9)
    v_mfma_f32_16x16x32_bf16 v[44:47], v[176:179], v[180:183], v[44:47]
    s_waitcnt lgkmcnt(6)
    v_mfma_f32_16x16x32_bf16 v[44:47], v[184:187], v[188:191], v[44:47]
    s_waitcnt lgkmcnt(3)
    v_mfma_f32_16x16x32_bf16 v[44:47], v[192:195], v[196:199], v[44:47]
    s_waitcnt lgkmcnt(0)
    v_mfma_f32_16x16x32_bf16 v[44:47], v[200:203], v[204:207], v[44:47]
    ds_read_b64_tr_b16 v[128:129], v40 offset:10240
    ds_read_b64_tr_b16 v[130:131], v40 offset:10368
    ds_read_b128 v[132:135], v43 offset:640
    ds_read_b64_tr_b16 v[136:137], v40 offset:11264
    ds_read_b64_tr_b16 v[138:139], v40 offset:11392
    ds_read_b128 v[140:143], v43 offset:704
    ds_read_b64_tr_b16 v[144:145], v40 offset:12288
    ds_read_b64_tr_b16 v[146:147], v40 offset:12416
    ds_read_b128 v[148:151], v43 offset:768
    ds_read_b64_tr_b16 v[152:153], v40 offset:13312
    ds_read_b64_tr_b16 v[154:155], v40 offset:13440
    ds_read_b128 v[156:159], v43 offset:832
    s_waitcnt lgkmcnt(9)
    v_mfma_f32_16x16x32_bf16 v[44:47], v[128:131], v[132:135], v[44:47]
    ds_read_b64_tr_b16 v[160:161], v40 offset:14336
    ds_read_b64_tr_b16 v[162:163], v40 offset:14464
    ds_read_b128 v[164:167], v43 offset:896
    s_waitcnt lgkmcnt(9)
    v_mfma_f32_16x16x32_bf16 v[44:47], v[136:139], v[140:143], v[44:47]
    ds_read_b64_tr_b16 v[168:169], v40 offset:15360
    ds_read_b64_tr_b16 v[170:171], v40 offset:15488
    ds_read_b128 v[172:175], v43 offset:960
    s_waitcnt lgkmcnt(9)
    v_mfma_f32_16x16x32_bf16 v[44:47], v[144:147], v[148:151], v[44:47]
    ds_read_b64_tr_b16 v[176:177], v40 offset:16384
    ds_read_b64_tr_b16 v[178:179], v40 offset:16512
    ds_read_b128 v[180:183], v43 offset:1024
    s_waitcnt lgkmcnt(9)
    v_mfma_f32_16x16x32_bf16 v[44:47], v[152:155], v[156:159], v[44:47]
    ds_read_b64_tr_b16 v[184:185], v40 offset:17408
    ds_read_b64_tr_b16 v[186:187], v40 offset:17536
    ds_read_b128 v[188:191], v43 offset:1088
    s_waitcnt lgkmcnt(9)
    v_mfma_f32_16x16x32_bf16 v[44:47], v[160:163], v[164:167], v[44:47]
    ds_read_b64_tr_b16 v[192:193], v40 offset:18432
    ds_read_b64_tr_b16 v[194:195], v40 offset:18560
    ds_read_b128 v[196:199], v43 offset:1152
    s_waitcnt lgkmcnt(9)
    v_mfma_f32_16x16x32_bf16 v[44:47], v[168:171], v[172:175], v[44:47]
    ds_read_b64_tr_b16 v[200:201], v40 offset:19456
    ds_read_b64_tr_b16 v[202:203], v40 offset:19584
    ds_read_b128 v[204:207], v43 offset:1216
    s_waitcnt lgkmcnt(9)
    v_mfma_f32_16x16x32_bf16 v[44:47], v[176:179], v[180:183], v[44:47]
    s_waitcnt lgkmcnt(6)
    v_mfma_f32_16x16x32_bf16 v[44:47], v[184:187], v[188:191], v[44:47]
    s_waitcnt lgkmcnt(3)
    v_mfma_f32_16x16x32_bf16 v[44:47], v[192:195], v[196:199], v[44:47]
    s_waitcnt lgkmcnt(0)
    v_mfma_f32_16x16x32_bf16 v[44:47], v[200:203], v[204:207], v[44:47]
    s_cmp_lt_u32 s60, 108
    s_cselect_b32 s72, 0, 13824
    s_sub_u32 s73, s60, 108
    s_cselect_b32 s73, s60, s73
    s_lshl_b32 s73, s73, 6
    s_add_u32 s72, s72, s73
    s_add_u32 s72, s72, 65536
    v_and_b32 v40, 15, v1
    v_mul_u32_u24 v41, 6912, v40
    v_lshl_add_u32 v41, v42, 4, v41
    s_mov_b32 exec_lo, 0x00030003
    s_mov_b32 exec_hi, 0x00030003
    buffer_store_dwordx4 v[44:47], v41, s[8:11], s72 offen sc1
    s_mov_b64 exec, -1
Lnoutj_103:
    s_mul_i32 s73, s97, 51200
    s_add_u32 s73, s73, 53248
    v_and_b32 v44, 3, v1
    v_lshl_add_u32 v44, v44, 3, s73
    v_bfe_u32 v46, v1, 2, 2
    s_movk_i32 s89, 160
    v_add_u32 v40, 0, v28
    v_mul_u32_u24 v41, 86, v40
    v_lshrrev_b32 v41, 8, v41
    v_mul_u32_u24 v42, 3, v41
    v_sub_u32 v42, v40, v42
    v_mul_u32_u24 v41, 20, v41
    v_lshlrev_b32 v43, 2, v42
    v_cmp_eq_u32 vcc, 2, v42
    v_add_u32 v41, v41, v46
    s_nop 0
    v_cndmask_b32 v43, v43, 16, vcc
    v_add_u32 v43, v41, v43
    v_add_u32 v45, 8, v43
    v_cndmask_b32 v45, v45, v43, vcc
    v_mad_u32_u24 v33, v43, s89, v44
    v_mad_u32_u24 v34, v45, s89, v44
    v_add_u32 v40, 4, v28
    v_mul_u32_u24 v41, 86, v40
    v_lshrrev_b32 v41, 8, v41
    v_mul_u32_u24 v42, 3, v41
    v_sub_u32 v42, v40, v42
    v_mul_u32_u24 v41, 20, v41
    v_lshlrev_b32 v43, 2, v42
    v_cmp_eq_u32 vcc, 2, v42
    v_add_u32 v41, v41, v46
    s_nop 0
    v_cndmask_b32 v43, v43, 16, vcc
    v_add_u32 v43, v41, v43
    v_add_u32 v45, 8, v43
    v_cndmask_b32 v45, v45, v43, vcc
    v_mad_u32_u24 v35, v43, s89, v44
    v_mad_u32_u24 v36, v45, s89, v44
    v_add_u32 v40, 8, v28
    v_mul_u32_u24 v41, 86, v40
    v_lshrrev_b32 v41, 8, v41
    v_mul_u32_u24 v42, 3, v41
    v_sub_u32 v42, v40, v42
    v_mul_u32_u24 v41, 20, v41
    v_lshlrev_b32 v43, 2, v42
    v_cmp_eq_u32 vcc, 2, v42
    v_add_u32 v41, v41, v46
    s_nop 0
    v_cndmask_b32 v43, v43, 16, vcc
    v_add_u32 v43, v41, v43
    v_add_u32 v45, 8, v43
    v_cndmask_b32 v45, v45, v43, vcc
    v_mad_u32_u24 v37, v43, s89, v44
    v_mad_u32_u24 v38, v45, s89, v44
    ds_read_b64_tr_b16 v[56:57], v33 offset:0
    ds_read_b64_tr_b16 v[58:59], v34 offset:0
    ds_read_b64_tr_b16 v[60:61], v33 offset:32
    ds_read_b64_tr_b16 v[62:63], v34 offset:32
    ds_read_b64_tr_b16 v[64:65], v33 offset:64
    ds_read_b64_tr_b16 v[66:67], v34 offset:64
    ds_read_b64_tr_b16 v[68:69], v33 offset:96
    ds_read_b64_tr_b16 v[70:71], v34 offset:96
    ds_read_b64_tr_b16 v[72:73], v33 offset:128
    ds_read_b64_tr_b16 v[74:75], v34 offset:128
    ds_read_b64_tr_b16 v[76:77], v35 offset:0
    ds_read_b64_tr_b16 v[78:79], v36 offset:0
    ds_read_b64_tr_b16 v[80:81], v35 offset:32
    ds_read_b64_tr_b16 v[82:83], v36 offset:32
    ds_read_b64_tr_b16 v[84:85], v35 offset:64
    ds_read_b64_tr_b16 v[86:87], v36 offset:64
    ds_read_b64_tr_b16 v[88:89], v35 offset:96
    ds_read_b64_tr_b16 v[90:91], v36 offset:96
    ds_read_b64_tr_b16 v[92:93], v35 offset:128
    ds_read_b64_tr_b16 v[94:95], v36 offset:128
    ds_read_b64_tr_b16 v[96:97], v37 offset:0
    ds_read_b64_tr_b16 v[98:99], v38 offset:0
    ds_read_b64_tr_b16 v[100:101], v37 offset:32
    ds_read_b64_tr_b16 v[102:103], v38 offset:32
    ds_read_b64_tr_b16 v[104:105], v37 offset:64
    ds_read_b64_tr_b16 v[106:107], v38 offset:64
    ds_read_b64_tr_b16 v[108:109], v37 offset:96
    ds_read_b64_tr_b16 v[110:111], v38 offset:96
    ds_read_b64_tr_b16 v[112:113], v37 offset:128
    ds_read_b64_tr_b16 v[114:115], v38 offset:128
    ds_read_b64_tr_b16 v[116:117], v33 offset:12800
    ds_read_b64_tr_b16 v[118:119], v34 offset:12800
    ds_read_b64_tr_b16 v[120:121], v33 offset:12832
    ds_read_b64_tr_b16 v[122:123], v34 offset:12832
    ds_read_b64_tr_b16 v[124:125], v33 offset:12864
    ds_read_b64_tr_b16 v[126:127], v34 offset:12864
    ds_read_b64_tr_b16 v[128:129], v33 offset:12896
    ds_read_b64_tr_b16 v[130:131], v34 offset:12896
    ds_read_b64_tr_b16 v[132:133], v33 offset:12928
    ds_read_b64_tr_b16 v[134:135], v34 offset:12928
    ds_read_b64_tr_b16 v[136:137], v35 offset:12800
    ds_read_b64_tr_b16 v[138:139], v36 offset:12800
    ds_read_b64_tr_b16 v[140:141], v35 offset:12832
    ds_read_b64_tr_b16 v[142:143], v36 offset:12832
    ds_read_b64_tr_b16 v[144:145], v35 offset:12864
    ds_read_b64_tr_b16 v[146:147], v36 offset:12864
    ds_read_b64_tr_b16 v[148:149], v35 offset:12896
    ds_read_b64_tr_b16 v[150:151], v36 offset:12896
    ds_read_b64_tr_b16 v[152:153], v35 offset:12928
    ds_read_b64_tr_b16 v[154:155], v36 offset:12928
    s_and_b32 s74, s60, 0xf8
    s_cmp_lg_u32 s65, 6
    s_cbranch_scc1 Lwp_104
    s_lshl_b32 s71, s74, 2
    s_add_u32 s71, s71, 12288
    v_lshlrev_b32 v47, 2, v1
    s_mov_b32 exec_lo, 255
    s_mov_b32 exec_hi, 0
    s_mov_b32 s90, 0
    buffer_load_dword v48, v47, s[8:11], s71 offen sc1
Lpoll_105:
    buffer_load_dword v49, v47, s[8:11], s71 offen sc1
    s_waitcnt vmcnt(1)
    v_cmp_ne_u32 vcc, s66, v48
    s_nop 4
    s_cbranch_vccz Lpdone_106
    buffer_load_dword v48, v47, s[8:11], s71 offen sc1
    s_waitcnt vmcnt(1)
    v_cmp_ne_u32 vcc, s66, v49
    s_nop 4
    s_cbranch_vccz Lpdone_106
    s_add_u32 s90, s90, 1
    s_cmp_lt_u32 s90, 400000
    s_cbranch_scc1 Lpoll_105
    v_mov_b32 v254, 5
    v_mov_b32 v255, 0
    s_mov_b32 s20, s56
    s_mov_b32 s21, s57
    s_mov_b32 s22, 256
    s_mov_b32 s23, 0x20000
    buffer_store_dword v254, v255, s[20:23], 0 offen
Lpdone_106:
    s_mov_b64 exec, -1
Lwp_104:
    s_barrier
    s_mul_i32 s71, s28, 24
    s_mul_i32 s72, s97, 12
    s_add_u32 s71, s71, s72
    s_lshl_b32 s71, s71, 10
    s_add_u32 s71, s71, 1048576
    buffer_load_dwordx4 v[156:159], v2, s[8:11], s71 offen offset:0 sc1
    buffer_load_dwordx4 v[160:163], v2, s[8:11], s71 offen offset:1024 sc1
    buffer_load_dwordx4 v[164:167], v2, s[8:11], s71 offen offset:2048 sc1
    buffer_load_dwordx4 v[168:171], v2, s[8:11], s71 offen offset:3072 sc1
    s_add_u32 s71, s71, 4096
    buffer_load_dwordx4 v[172:175], v2, s[8:11], s71 offen offset:0 sc1
    buffer_load_dwordx4 v[176:179], v2, s[8:11], s71 offen offset:1024 sc1
    buffer_load_dwordx4 v[180:183], v2, s[8:11], s71 offen offset:2048 sc1
    buffer_load_dwordx4 v[184:187], v2, s[8:11], s71 offen offset:3072 sc1
    s_add_u32 s71, s71, 4096
    buffer_load_dwordx4 v[188:191], v2, s[8:11], s71 offen offset:0 sc1
    buffer_load_dwordx4 v[192:195], v2, s[8:11], s71 offen offset:1024 sc1
    buffer_load_dwordx4 v[240:243], v2, s[8:11], s71 offen offset:2048 sc1
    buffer_load_dwordx4 v[244:247], v2, s[8:11], s71 offen offset:3072 sc1
    s_waitcnt vmcnt(11) lgkmcnt(0)
    v_mfma_f32_16x16x32_bf16 v[8:11], v[56:59], v[156:159], 0
    v_mfma_f32_16x16x32_bf16 v[12:15], v[60:63], v[156:159], 0
    v_mfma_f32_16x16x32_bf16 v[16:19], v[64:67], v[156:159], 0
    v_mfma_f32_16x16x32_bf16 v[20:23], v[68:71], v[156:159], 0
    v_mfma_f32_16x16x32_bf16 v[24:27], v[72:75], v[156:159], 0
    buffer_load_dwordx4 v[204:207], v29, s[8:11], s80 offen offset:0 sc1
    s_waitcnt vmcnt(11)
    v_mfma_f32_16x16x32_bf16 v[8:11], v[76:79], v[160:163], v[8:11]
    v_mfma_f32_16x16x32_bf16 v[12:15], v[80:83], v[160:163], v[12:15]
    v_mfma_f32_16x16x32_bf16 v[16:19], v[84:87], v[160:163], v[16:19]
    v_mfma_f32_16x16x32_bf16 v[20:23], v[88:91], v[160:163], v[20:23]
    v_mfma_f32_16x16x32_bf16 v[24:27], v[92:95], v[160:163], v[24:27]
    ds_read_b64_tr_b16 v[76:77], v37 offset:12800
    ds_read_b64_tr_b16 v[78:79], v38 offset:12800
    ds_read_b64_tr_b16 v[80:81], v37 offset:12832
    ds_read_b64_tr_b16 v[82:83], v38 offset:12832
    ds_read_b64_tr_b16 v[84:85], v37 offset:12864
    ds_read_b64_tr_b16 v[86:87], v38 offset:12864
    ds_read_b64_tr_b16 v[88:89], v37 offset:12896
    ds_read_b64_tr_b16 v[90:91], v38 offset:12896
    ds_read_b64_tr_b16 v[92:93], v37 offset:12928
    ds_read_b64_tr_b16 v[94:95], v38 offset:12928
    buffer_load_dwordx4 v[216:219], v29, s[8:11], s81 offen offset:0 sc1
    s_waitcnt vmcnt(11)
    v_mfma_f32_16x16x32_bf16 v[8:11], v[96:99], v[164:167], v[8:11]
    v_mfma_f32_16x16x32_bf16 v[12:15], v[100:103], v[164:167], v[12:15]
    v_mfma_f32_16x16x32_bf16 v[16:19], v[104:107], v[164:167], v[16:19]
    v_mfma_f32_16x16x32_bf16 v[20:23], v[108:111], v[164:167], v[20:23]
    v_mfma_f32_16x16x32_bf16 v[24:27], v[112:115], v[164:167], v[24:27]
    buffer_load_dwordx2 v[196:197], v253, s[4:7], s30 offen offset:0
    s_waitcnt vmcnt(11)
    v_mfma_f32_16x16x32_bf16 v[8:11], v[116:119], v[168:171], v[8:11]
    v_mfma_f32_16x16x32_bf16 v[12:15], v[120:123], v[168:171], v[12:15]
    v_mfma_f32_16x16x32_bf16 v[16:19], v[124:127], v[168:171], v[16:19]
    v_mfma_f32_16x16x32_bf16 v[20:23], v[128:131], v[168:171], v[20:23]
    v_mfma_f32_16x16x32_bf16 v[24:27], v[132:135], v[168:171], v[24:27]
    buffer_load_dwordx4 v[228:231], v29, s[8:11], s82 offen offset:0 sc1
    s_waitcnt vmcnt(11)
    v_mfma_f32_16x16x32_bf16 v[8:11], v[136:139], v[172:175], v[8:11]
    v_mfma_f32_16x16x32_bf16 v[12:15], v[140:143], v[172:175], v[12:15]
    v_mfma_f32_16x16x32_bf16 v[16:19], v[144:147], v[172:175], v[16:19]
    v_mfma_f32_16x16x32_bf16 v[20:23], v[148:151], v[172:175], v[20:23]
    v_mfma_f32_16x16x32_bf16 v[24:27], v[152:155], v[172:175], v[24:27]
    ds_read_b64_tr_b16 v[56:57], v33 offset:25600
    ds_read_b64_tr_b16 v[58:59], v34 offset:25600
    ds_read_b64_tr_b16 v[60:61], v33 offset:25632
    ds_read_b64_tr_b16 v[62:63], v34 offset:25632
    ds_read_b64_tr_b16 v[64:65], v33 offset:25664
    ds_read_b64_tr_b16 v[66:67], v34 offset:25664
    ds_read_b64_tr_b16 v[68:69], v33 offset:25696
    ds_read_b64_tr_b16 v[70:71], v34 offset:25696
    ds_read_b64_tr_b16 v[72:73], v33 offset:25728
    ds_read_b64_tr_b16 v[74:75], v34 offset:25728
    buffer_load_dwordx4 v[208:211], v29, s[8:11], s80 offen offset:64 sc1
    s_waitcnt vmcnt(11) lgkmcnt(10)
    v_mfma_f32_16x16x32_bf16 v[8:11], v[76:79], v[176:179], v[8:11]
    v_mfma_f32_16x16x32_bf16 v[12:15], v[80:83], v[176:179], v[12:15]
    v_mfma_f32_16x16x32_bf16 v[16:19], v[84:87], v[176:179], v[16:19]
    v_mfma_f32_16x16x32_bf16 v[20:23], v[88:91], v[176:179], v[20:23]
    v_mfma_f32_16x16x32_bf16 v[24:27], v[92:95], v[176:179], v[24:27]
    ds_read_b64_tr_b16 v[76:77], v35 offset:25600
    ds_read_b64_tr_b16 v[78:79], v36 offset:25600
    ds_read_b64_tr_b16 v[80:81], v35 offset:25632
    ds_read_b64_tr_b16 v[82:83], v36 offset:25632
    ds_read_b64_tr_b16 v[84:85], v35 offset:25664
    ds_read_b64_tr_b16 v[86:87], v36 offset:25664
    ds_read_b64_tr_b16 v[88:89], v35 offset:25696
    ds_read_b64_tr_b16 v[90:91], v36 offset:25696
    ds_read_b64_tr_b16 v[92:93], v35 offset:25728
    ds_read_b64_tr_b16 v[94:95], v36 offset:25728
    buffer_load_dwordx4 v[220:223], v29, s[8:11], s81 offen offset:64 sc1
    s_waitcnt vmcnt(11) lgkmcnt(10)
    v_mfma_f32_16x16x32_bf16 v[8:11], v[56:59], v[180:183], v[8:11]
    v_mfma_f32_16x16x32_bf16 v[12:15], v[60:63], v[180:183], v[12:15]
    v_mfma_f32_16x16x32_bf16 v[16:19], v[64:67], v[180:183], v[16:19]
    v_mfma_f32_16x16x32_bf16 v[20:23], v[68:71], v[180:183], v[20:23]
    v_mfma_f32_16x16x32_bf16 v[24:27], v[72:75], v[180:183], v[24:27]
    ds_read_b64_tr_b16 v[56:57], v37 offset:25600
    ds_read_b64_tr_b16 v[58:59], v38 offset:25600
    ds_read_b64_tr_b16 v[60:61], v37 offset:25632
    ds_read_b64_tr_b16 v[62:63], v38 offset:25632
    ds_read_b64_tr_b16 v[64:65], v37 offset:25664
    ds_read_b64_tr_b16 v[66:67], v38 offset:25664
    ds_read_b64_tr_b16 v[68:69], v37 offset:25696
    ds_read_b64_tr_b16 v[70:71], v38 offset:25696
    ds_read_b64_tr_b16 v[72:73], v37 offset:25728
    ds_read_b64_tr_b16 v[74:75], v38 offset:25728
    buffer_load_dwordx2 v[198:199], v253, s[4:7], s30 offen offset:32
    s_waitcnt vmcnt(11) lgkmcnt(10)
    v_mfma_f32_16x16x32_bf16 v[8:11], v[76:79], v[184:187], v[8:11]
    v_mfma_f32_16x16x32_bf16 v[12:15], v[80:83], v[184:187], v[12:15]
    v_mfma_f32_16x16x32_bf16 v[16:19], v[84:87], v[184:187], v[16:19]
    v_mfma_f32_16x16x32_bf16 v[20:23], v[88:91], v[184:187], v[20:23]
    v_mfma_f32_16x16x32_bf16 v[24:27], v[92:95], v[184:187], v[24:27]
    ds_read_b64_tr_b16 v[76:77], v33 offset:38400
    ds_read_b64_tr_b16 v[78:79], v34 offset:38400
    ds_read_b64_tr_b16 v[80:81], v33 offset:38432
    ds_read_b64_tr_b16 v[82:83], v34 offset:38432
    ds_read_b64_tr_b16 v[84:85], v33 offset:38464
    ds_read_b64_tr_b16 v[86:87], v34 offset:38464
    ds_read_b64_tr_b16 v[88:89], v33 offset:38496
    ds_read_b64_tr_b16 v[90:91], v34 offset:38496
    ds_read_b64_tr_b16 v[92:93], v33 offset:38528
    ds_read_b64_tr_b16 v[94:95], v34 offset:38528
    buffer_load_dwordx4 v[232:235], v29, s[8:11], s82 offen offset:64 sc1
    s_waitcnt vmcnt(11) lgkmcnt(10)
    v_mfma_f32_16x16x32_bf16 v[8:11], v[56:59], v[188:191], v[8:11]
    v_mfma_f32_16x16x32_bf16 v[12:15], v[60:63], v[188:191], v[12:15]
    v_mfma_f32_16x16x32_bf16 v[16:19], v[64:67], v[188:191], v[16:19]
    v_mfma_f32_16x16x32_bf16 v[20:23], v[68:71], v[188:191], v[20:23]
    v_mfma_f32_16x16x32_bf16 v[24:27], v[72:75], v[188:191], v[24:27]
    ds_read_b64_tr_b16 v[56:57], v35 offset:38400
    ds_read_b64_tr_b16 v[58:59], v36 offset:38400
    ds_read_b64_tr_b16 v[60:61], v35 offset:38432
    ds_read_b64_tr_b16 v[62:63], v36 offset:38432
    ds_read_b64_tr_b16 v[64:65], v35 offset:38464
    ds_read_b64_tr_b16 v[66:67], v36 offset:38464
    ds_read_b64_tr_b16 v[68:69], v35 offset:38496
    ds_read_b64_tr_b16 v[70:71], v36 offset:38496
    ds_read_b64_tr_b16 v[72:73], v35 offset:38528
    ds_read_b64_tr_b16 v[74:75], v36 offset:38528
    buffer_load_dwordx4 v[212:215], v29, s[8:11], s80 offen offset:128 sc1
    s_waitcnt vmcnt(11) lgkmcnt(10)
    v_mfma_f32_16x16x32_bf16 v[8:11], v[76:79], v[192:195], v[8:11]
    v_mfma_f32_16x16x32_bf16 v[12:15], v[80:83], v[192:195], v[12:15]
    v_mfma_f32_16x16x32_bf16 v[16:19], v[84:87], v[192:195], v[16:19]
    v_mfma_f32_16x16x32_bf16 v[20:23], v[88:91], v[192:195], v[20:23]
    v_mfma_f32_16x16x32_bf16 v[24:27], v[92:95], v[192:195], v[24:27]
    ds_read_b64_tr_b16 v[76:77], v37 offset:38400
    ds_read_b64_tr_b16 v[78:79], v38 offset:38400
    ds_read_b64_tr_b16 v[80:81], v37 offset:38432
    ds_read_b64_tr_b16 v[82:83], v38 offset:38432
    ds_read_b64_tr_b16 v[84:85], v37 offset:38464
    ds_read_b64_tr_b16 v[86:87], v38 offset:38464
    ds_read_b64_tr_b16 v[88:89], v37 offset:38496
    ds_read_b64_tr_b16 v[90:91], v38 offset:38496
    ds_read_b64_tr_b16 v[92:93], v37 offset:38528
    ds_read_b64_tr_b16 v[94:95], v38 offset:38528
    buffer_load_dwordx4 v[224:227], v29, s[8:11], s81 offen offset:128 sc1
    s_waitcnt vmcnt(11) lgkmcnt(10)
    v_mfma_f32_16x16x32_bf16 v[8:11], v[56:59], v[240:243], v[8:11]
    v_mfma_f32_16x16x32_bf16 v[12:15], v[60:63], v[240:243], v[12:15]
    v_mfma_f32_16x16x32_bf16 v[16:19], v[64:67], v[240:243], v[16:19]
    v_mfma_f32_16x16x32_bf16 v[20:23], v[68:71], v[240:243], v[20:23]
    v_mfma_f32_16x16x32_bf16 v[24:27], v[72:75], v[240:243], v[24:27]
    buffer_load_dwordx2 v[200:201], v253, s[4:7], s30 offen offset:64
    s_waitcnt vmcnt(11) lgkmcnt(0)
    v_mfma_f32_16x16x32_bf16 v[8:11], v[76:79], v[244:247], v[8:11]
    v_mfma_f32_16x16x32_bf16 v[12:15], v[80:83], v[244:247], v[12:15]
    v_mfma_f32_16x16x32_bf16 v[16:19], v[84:87], v[244:247], v[16:19]
    v_mfma_f32_16x16x32_bf16 v[20:23], v[88:91], v[244:247], v[20:23]
    v_mfma_f32_16x16x32_bf16 v[24:27], v[92:95], v[244:247], v[24:27]
    buffer_load_dwordx4 v[236:239], v29, s[8:11], s82 offen offset:128 sc1
    s_cmp_eq_u32 s65, 7
    s_cbranch_scc1 Lw0_107
    s_mov_b32 m0, s85
    s_nop 0
    buffer_load_dwordx4 v2, s[8:11], s84 offen sc1 lds
    buffer_load_dwordx4 v2, s[8:11], s84 offen offset:1024 sc1 lds
    s_add_u32 m0, s85, 14336
    s_add_u32 s75, s84, 143360
    buffer_load_dwordx4 v2, s[8:11], s75 offen sc1 lds
    buffer_load_dwordx4 v2, s[8:11], s75 offen offset:1024 sc1 lds
Lw0_107:
    s_add_u32 s84, s84, 14336
    s_mul_i32 s70, s69, 5120
    s_add_u32 s70, s70, 0
    v_add_u32 v40, s70, v2
    s_cmp_lg_u32 s97, 0
    s_cbranch_scc1 Lex_108
    ds_write_b128 v40, v[20:23] offset:3072
    ds_write_b128 v40, v[24:27] offset:4096
    s_waitcnt lgkmcnt(0)
    s_barrier
    ds_read_b128 v[44:47], v40 offset:0
    ds_read_b128 v[48:51], v40 offset:1024
    ds_read_b128 v[52:55], v40 offset:2048
    s_waitcnt lgkmcnt(0)
    v_add_f32 v8, v8, v44
    v_add_f32 v9, v9, v45
    v_add_f32 v10, v10, v46
    v_add_f32 v11, v11, v47
    v_add_f32 v12, v12, v48
    v_add_f32 v13, v13, v49
    v_add_f32 v14, v14, v50
    v_add_f32 v15, v15, v51
    v_add_f32 v16, v16, v52
    v_add_f32 v17, v17, v53
    v_add_f32 v18, v18, v54
    v_add_f32 v19, v19, v55
    s_branch Lex_109
Lex_108:
    ds_write_b128 v40, v[8:11] offset:0
    ds_write_b128 v40, v[12:15] offset:1024
    ds_write_b128 v40, v[16:19] offset:2048
    s_waitcnt lgkmcnt(0)
    s_barrier
    ds_read_b128 v[56:59], v40 offset:3072
    ds_read_b128 v[60:63], v40 offset:4096
    s_waitcnt lgkmcnt(0)
    v_add_f32 v20, v20, v56
    v_add_f32 v21, v21, v57
    v_add_f32 v22, v22, v58
    v_add_f32 v23, v23, v59
    v_add_f32 v24, v24, v60
    v_add_f32 v25, v25, v61
    v_add_f32 v26, v26, v62
    v_add_f32 v27, v27, v63
Lex_109:
    s_cmp_eq_u32 s65, 7
    s_cbranch_scc1 Lop_110
    s_waitcnt vmcnt(4)
    s_branch Lop_111
Lop_110:
    s_waitcnt vmcnt(0)
Lop_111:
    s_cmp_lg_u32 s97, 0
    s_cbranch_scc1 Lp3e_112
    s_mul_i32 s71, s28, 20480
    s_mul_i32 s72, s64, 2560
    s_add_u32 s71, s71, s72
    s_add_u32 s71, s71, 4194304
    v_lshlrev_b32 v240, 16, v196
    v_and_b32 v241, 0xffff0000, v196
    v_lshlrev_b32 v242, 16, v197
    v_and_b32 v243, 0xffff0000, v197
    v_fmac_f32 v240, v204, v8
    v_fmac_f32 v241, v205, v9
    v_fmac_f32 v242, v206, v10
    v_fmac_f32 v243, v207, v11
    v_mul_f32 v40, v240, v216
    v_mul_f32 v41, v241, v217
    v_mul_f32 v42, v242, v218
    v_mul_f32 v43, v243, v219
    v_cvt_pk_bf16_f32 v44, v40, v41
    v_cvt_pk_bf16_f32 v45, v42, v43
    v_lshlrev_b32 v244, 16, v198
    v_and_b32 v245, 0xffff0000, v198
    v_lshlrev_b32 v246, 16, v199
    v_and_b32 v247, 0xffff0000, v199
    v_fmac_f32 v244, v208, v12
    v_fmac_f32 v245, v209, v13
    v_fmac_f32 v246, v210, v14
    v_fmac_f32 v247, v211, v15
    v_mul_f32 v40, v244, v220
    v_mul_f32 v41, v245, v221
    v_mul_f32 v42, v246, v222
    v_mul_f32 v43, v247, v223
    v_cvt_pk_bf16_f32 v46, v40, v41
    v_cvt_pk_bf16_f32 v47, v42, v43
    v_lshlrev_b32 v248, 16, v200
    v_and_b32 v249, 0xffff0000, v200
    v_lshlrev_b32 v250, 16, v201
    v_and_b32 v251, 0xffff0000, v201
    v_fmac_f32 v248, v212, v16
    v_fmac_f32 v249, v213, v17
    v_fmac_f32 v250, v214, v18
    v_fmac_f32 v251, v215, v19
    v_mul_f32 v40, v248, v224
    v_mul_f32 v41, v249, v225
    v_mul_f32 v42, v250, v226
    v_mul_f32 v43, v251, v227
    v_cvt_pk_bf16_f32 v48, v40, v41
    v_cvt_pk_bf16_f32 v49, v42, v43
    v_permlane32_swap_b32 v44, v46
    v_permlane32_swap_b32 v45, v47
    buffer_store_dwordx4 v[44:47], v2, s[8:11], s71 offen offset:0 sc1
    v_mov_b32 v50, v48
    v_mov_b32 v51, v49
    s_nop 0
    v_permlane32_swap_b32 v48, v50
    v_permlane32_swap_b32 v49, v51
    s_mov_b32 exec_hi, 0
    buffer_store_dwordx4 v[48:51], v2, s[8:11], s71 offen offset:1024 sc1
    s_mov_b64 exec, -1
    v_mov_b32 v36, v240
    v_mul_f32 v37, v240, v240
    v_add_f32 v36, v36, v241
    v_fmac_f32 v37, v241, v241
    v_add_f32 v36, v36, v242
    v_fmac_f32 v37, v242, v242
    v_add_f32 v36, v36, v243
    v_fmac_f32 v37, v243, v243
    v_add_f32 v36, v36, v244
    v_fmac_f32 v37, v244, v244
    v_add_f32 v36, v36, v245
    v_fmac_f32 v37, v245, v245
    v_add_f32 v36, v36, v246
    v_fmac_f32 v37, v246, v246
    v_add_f32 v36, v36, v247
    v_fmac_f32 v37, v247, v247
    v_add_f32 v36, v36, v248
    v_fmac_f32 v37, v248, v248
    v_add_f32 v36, v36, v249
    v_fmac_f32 v37, v249, v249
    v_add_f32 v36, v36, v250
    v_fmac_f32 v37, v250, v250
    v_add_f32 v36, v36, v251
    v_fmac_f32 v37, v251, v251
    v_mov_b32 v38, v36
    s_nop 1
    v_permlane32_swap_b32 v36, v38
    v_add_f32 v36, v36, v38
    v_mov_b32 v38, v36
    s_nop 1
    v_permlane16_swap_b32 v36, v38
    v_add_f32 v36, v36, v38
    v_mov_b32 v39, v37
    s_nop 1
    v_permlane32_swap_b32 v37, v39
    v_add_f32 v37, v37, v39
    v_mov_b32 v39, v37
    s_nop 1
    v_permlane16_swap_b32 v37, v39
    v_add_f32 v37, v37, v39
    s_lshl_b32 s72, s60, 3
    s_add_u32 s72, s72, s65
    s_lshl_b32 s72, s72, 7
    s_add_u32 s72, s72, 393216
    v_lshlrev_b32 v38, 3, v1
    s_mov_b32 exec_lo, 0xffff
    s_mov_b32 exec_hi, 0
    buffer_store_dwordx2 v[36:37], v38, s[8:11], s72 offen sc1
    s_mov_b64 exec, -1
    s_branch Lp3e_113
Lp3e_112:
    s_mul_i32 s71, s28, 20480
    s_mul_i32 s72, s64, 2560
    s_add_u32 s71, s71, s72
    s_add_u32 s71, s71, 4195840
    v_lshlrev_b32 v240, 16, v196
    v_and_b32 v241, 0xffff0000, v196
    v_lshlrev_b32 v242, 16, v197
    v_and_b32 v243, 0xffff0000, v197
    v_fmac_f32 v240, v204, v20
    v_fmac_f32 v241, v205, v21
    v_fmac_f32 v242, v206, v22
    v_fmac_f32 v243, v207, v23
    v_mul_f32 v40, v240, v216
    v_mul_f32 v41, v241, v217
    v_mul_f32 v42, v242, v218
    v_mul_f32 v43, v243, v219
    v_cvt_pk_bf16_f32 v44, v40, v41
    v_cvt_pk_bf16_f32 v45, v42, v43
    v_lshlrev_b32 v244, 16, v198
    v_and_b32 v245, 0xffff0000, v198
    v_lshlrev_b32 v246, 16, v199
    v_and_b32 v247, 0xffff0000, v199
    v_fmac_f32 v244, v208, v24
    v_fmac_f32 v245, v209, v25
    v_fmac_f32 v246, v210, v26
    v_fmac_f32 v247, v211, v27
    v_mul_f32 v40, v244, v220
    v_mul_f32 v41, v245, v221
    v_mul_f32 v42, v246, v222
    v_mul_f32 v43, v247, v223
    v_cvt_pk_bf16_f32 v46, v40, v41
    v_cvt_pk_bf16_f32 v47, v42, v43
    s_nop 0
    v_permlane32_swap_b32 v44, v46
    v_permlane32_swap_b32 v45, v47
    buffer_store_dwordx4 v[44:47], v2, s[8:11], s71 offen offset:0 sc1
    v_mov_b32 v36, v240
    v_mul_f32 v37, v240, v240
    v_add_f32 v36, v36, v241
    v_fmac_f32 v37, v241, v241
    v_add_f32 v36, v36, v242
    v_fmac_f32 v37, v242, v242
    v_add_f32 v36, v36, v243
    v_fmac_f32 v37, v243, v243
    v_add_f32 v36, v36, v244
    v_fmac_f32 v37, v244, v244
    v_add_f32 v36, v36, v245
    v_fmac_f32 v37, v245, v245
    v_add_f32 v36, v36, v246
    v_fmac_f32 v37, v246, v246
    v_add_f32 v36, v36, v247
    v_fmac_f32 v37, v247, v247
    v_mov_b32 v38, v36
    s_nop 1
    v_permlane32_swap_b32 v36, v38
    v_add_f32 v36, v36, v38
    v_mov_b32 v38, v36
    s_nop 1
    v_permlane16_swap_b32 v36, v38
    v_add_f32 v36, v36, v38
    v_mov_b32 v39, v37
    s_nop 1
    v_permlane32_swap_b32 v37, v39
    v_add_f32 v37, v37, v39
    v_mov_b32 v39, v37
    s_nop 1
    v_permlane16_swap_b32 v37, v39
    v_add_f32 v37, v37, v39
    s_lshl_b32 s72, s60, 3
    s_add_u32 s72, s72, s65
    s_lshl_b32 s72, s72, 7
    s_add_u32 s72, s72, 393216
    v_lshlrev_b32 v38, 3, v1
    s_mov_b32 exec_lo, 0xffff
    s_mov_b32 exec_hi, 0
    buffer_store_dwordx2 v[36:37], v38, s[8:11], s72 offen sc1
    s_mov_b64 exec, -1
Lp3e_113:
    s_lshl_b32 s70, s60, 2
    s_add_u32 s70, s70, 20480
    v_mov_b32 v255, s66
    s_waitcnt vmcnt(0)
    s_barrier
    s_cmp_lg_u32 s65, 0
    s_cbranch_scc1 Lwf_114
    s_mov_b64 exec, 1
    buffer_store_dword v255, v1, s[8:11], s70 offen sc1
    s_mov_b64 exec, -1
Lwf_114:
    s_cmp_lg_u32 s65, 7
    s_cbranch_scc1 Lutf_115
    s_cmp_ge_u32 s60, 216
    s_cbranch_scc1 Lutf_115
    s_lshl_b32 s73, s60, 2
    s_add_u32 s73, s73, 36864
    s_mov_b64 exec, 1
    buffer_store_dword v255, v1, s[8:11], s73 offen sc1
    s_mov_b64 exec, -1
Lutf_115:
    s_cmp_eq_u32 s65, 7
    s_cbranch_scc1 Lw1_116
    s_add_u32 s73, s85, 45056
    s_mov_b32 m0, s73
    s_nop 0
    buffer_load_dwordx4 v2, s[8:11], s84 offen sc1 lds
    buffer_load_dwordx4 v2, s[8:11], s84 offen offset:1024 sc1 lds
    s_add_u32 m0, s73, 14336
    s_add_u32 s75, s84, 143360
    buffer_load_dwordx4 v2, s[8:11], s75 offen sc1 lds
    buffer_load_dwordx4 v2, s[8:11], s75 offen offset:1024 sc1 lds
Lw1_116:
    s_add_u32 s84, s84, 14336
    s_lshl_b32 s86, s61, 3
    s_add_u32 s86, s86, s65
    s_mul_i32 s86, s86, 20480
    s_add_u32 s86, s86, 4194304
    s_add_u32 s87, s85, 28672
    v_lshlrev_b32 v35, 3, v1
    s_and_b32 s72, s65, 1
    s_lshl_b32 s73, s61, 1
    s_add_u32 s72, s72, s73
    s_lshl_b32 s72, s72, 3
    s_lshr_b32 s73, s65, 1
    s_lshl_b32 s74, s73, 1
    s_add_u32 s72, s72, s74
    s_lshl_b32 s72, s72, 10
    s_add_u32 s72, s72, 393216
    s_lshl_b32 s73, s73, 10
    s_and_b32 s74, s65, 1
    s_lshl_b32 s74, s74, 9
    s_add_u32 s73, s73, s74
    s_add_u32 s73, s73, 158720
    v_add_u32 v41, s73, v35
    s_lshl_b32 s83, s61, 4
    s_cmp_lg_u32 s65, 7
    s_cbranch_scc1 Lwp_117
    s_lshl_b32 s71, s83, 2
    s_add_u32 s71, s71, 20480
    v_lshlrev_b32 v200, 2, v1
    s_mov_b32 exec_lo, 65535
    s_mov_b32 exec_hi, 0
    s_mov_b32 s90, 0
    buffer_load_dword v201, v200, s[8:11], s71 offen sc1
Lpoll_118:
    buffer_load_dword v202, v200, s[8:11], s71 offen sc1
    s_waitcnt vmcnt(1)
    v_cmp_ne_u32 vcc, s66, v201
    s_nop 4
    s_cbranch_vccz Lpdone_119
    buffer_load_dword v201, v200, s[8:11], s71 offen sc1
    s_waitcnt vmcnt(1)
    v_cmp_ne_u32 vcc, s66, v202
    s_nop 4
    s_cbranch_vccz Lpdone_119
    s_add_u32 s90, s90, 1
    s_cmp_lt_u32 s90, 400000
    s_cbranch_scc1 Lpoll_118
    v_mov_b32 v254, 6
    v_mov_b32 v255, 0
    s_mov_b32 s20, s56
    s_mov_b32 s21, s57
    s_mov_b32 s22, 256
    s_mov_b32 s23, 0x20000
    buffer_store_dword v254, v255, s[20:23], 0 offen
Lpdone_119:
    s_mov_b64 exec, -1
Lwp_117:
    s_barrier
    s_add_u32 s73, s87, 0
    s_mov_b32 m0, s73
    s_nop 0
    buffer_load_dwordx4 v2, s[8:11], s86 offen sc1 lds
    buffer_load_dwordx4 v2, s[8:11], s86 offen offset:1024 sc1 lds
    s_add_u32 s86, s86, 2048
    s_add_u32 s73, s87, 45056
    s_mov_b32 m0, s73
    s_nop 0
    buffer_load_dwordx4 v2, s[8:11], s86 offen sc1 lds
    buffer_load_dwordx4 v2, s[8:11], s86 offen offset:1024 sc1 lds
    s_add_u32 s86, s86, 2048
    s_cmp_eq_u32 s65, 7
    s_cbranch_scc1 Lw2_120
    s_add_u32 s73, s85, 90112
    s_mov_b32 m0, s73
    s_nop 0
    buffer_load_dwordx4 v2, s[8:11], s84 offen sc1 lds
    buffer_load_dwordx4 v2, s[8:11], s84 offen offset:1024 sc1 lds
    s_add_u32 m0, s73, 14336
    s_add_u32 s75, s84, 143360
    buffer_load_dwordx4 v2, s[8:11], s75 offen sc1 lds
    buffer_load_dwordx4 v2, s[8:11], s75 offen offset:1024 sc1 lds
Lw2_120:
    s_add_u32 s84, s84, 14336
    s_add_u32 s73, s87, 90112
    s_mov_b32 m0, s73
    s_nop 0
    buffer_load_dwordx4 v2, s[8:11], s86 offen sc1 lds
    buffer_load_dwordx4 v2, s[8:11], s86 offen offset:1024 sc1 lds
    s_add_u32 s86, s86, 2048
    s_mov_b32 s83, s72
    s_cmp_ge_u32 s65, 4
    s_cbranch_scc1 Lp4b_121
    s_and_b32 s81, s65, 1
    s_lshl_b32 s81, s81, 2
    s_and_b32 s82, s65, 2
    s_lshl_b32 s71, s81, 11
    s_add_u32 s71, s71, 49152
    v_add_u32 v8, s71, v2
    v_lshrrev_b32 v14, 5, v1
    v_bfe_u32 v15, v1, 4, 1
    v_lshlrev_b32 v14, 4, v14
    v_lshl_add_u32 v14, v15, 2, v14
    v_bfe_u32 v15, v1, 2, 2
    v_add_u32 v14, v14, v15
    v_mul_u32_u24 v14, 224, v14
    v_and_b32 v15, 3, v1
    v_lshl_add_u32 v14, v15, 3, v14
    s_lshl_b32 s71, s82, 5
    s_add_u32 s71, s71, 20480
    v_add_u32 v11, s71, v14
    v_add_u32 v9, 45056, v8
    v_add_u32 v12, 45056, v11
    v_add_u32 v10, 90112, v8
    v_add_u32 v13, 90112, v11
    v_mov_b32 v52, 0
    v_mov_b32 v53, 0
    v_mov_b32 v54, 0
    v_mov_b32 v55, 0
    v_mov_b32 v56, 0
    v_mov_b32 v57, 0
    v_mov_b32 v58, 0
    v_mov_b32 v59, 0
    v_mov_b32 v60, 0
    v_mov_b32 v61, 0
    v_mov_b32 v62, 0
    v_mov_b32 v63, 0
    v_mov_b32 v64, 0
    v_mov_b32 v65, 0
    v_mov_b32 v66, 0
    v_mov_b32 v67, 0
    v_mov_b32 v68, 0
    v_mov_b32 v69, 0
    v_mov_b32 v70, 0
    v_mov_b32 v71, 0
    v_mov_b32 v72, 0
    v_mov_b32 v73, 0
    v_mov_b32 v74, 0
    v_mov_b32 v75, 0
    v_mov_b32 v76, 0
    v_mov_b32 v77, 0
    v_mov_b32 v78, 0
    v_mov_b32 v79, 0
    v_mov_b32 v80, 0
    v_mov_b32 v81, 0
    v_mov_b32 v82, 0
    v_mov_b32 v83, 0
    v_mov_b32 v84, 0
    v_mov_b32 v85, 0
    v_mov_b32 v86, 0
    v_mov_b32 v87, 0
    v_mov_b32 v88, 0
    v_mov_b32 v89, 0
    v_mov_b32 v90, 0
    v_mov_b32 v91, 0
    v_mov_b32 v92, 0
    v_mov_b32 v93, 0
    v_mov_b32 v94, 0
    v_mov_b32 v95, 0
    v_mov_b32 v96, 0
    v_mov_b32 v97, 0
    v_mov_b32 v98, 0
    v_mov_b32 v99, 0
    v_mov_b32 v100, 0
    v_mov_b32 v101, 0
    v_mov_b32 v102, 0
    v_mov_b32 v103, 0
    v_mov_b32 v104, 0
    v_mov_b32 v105, 0
    v_mov_b32 v106, 0
    v_mov_b32 v107, 0
    v_mov_b32 v108, 0
    v_mov_b32 v109, 0
    v_mov_b32 v110, 0
    v_mov_b32 v111, 0
    v_mov_b32 v112, 0
    v_mov_b32 v113, 0
    v_mov_b32 v114, 0
    v_mov_b32 v115, 0
    s_cmp_eq_u32 s65, 7
    s_cselect_b64 vcc, -1, 0
    s_waitcnt vmcnt(8)
    s_barrier
    s_mul_i32 s76, s97, 27
    s_add_u32 s76, s76, s69
    s_mul_i32 s76, s76, 5120
    s_mul_i32 s74, s64, 278528
    s_add_u32 s76, s76, s74
    s_add_u32 s76, s76, 17596416
    s_mul_i32 s77, s65, 5120
    ds_read_b128 v[116:119], v8 offset:0
    ds_read_b128 v[120:123], v8 offset:2048
    ds_read_b128 v[124:127], v8 offset:4096
    ds_read_b128 v[128:131], v8 offset:6144
    ds_read_b64_tr_b16 v[132:133], v11 offset:0
    ds_read_b64_tr_b16 v[134:135], v11 offset:1792
    ds_read_b64_tr_b16 v[136:137], v11 offset:14336
    ds_read_b64_tr_b16 v[138:139], v11 offset:16128
    ds_read_b64_tr_b16 v[140:141], v11 offset:32
    ds_read_b64_tr_b16 v[142:143], v11 offset:1824
    ds_read_b64_tr_b16 v[144:145], v11 offset:14368
    ds_read_b64_tr_b16 v[146:147], v11 offset:16160
    s_waitcnt lgkmcnt(0)
    v_mfma_f32_16x16x32_bf16 v[52:55], v[132:135], v[116:119], v[52:55]
    ds_read_b128 v[148:151], v8 offset:1024
    ds_read_b128 v[152:155], v8 offset:3072
    v_mfma_f32_16x16x32_bf16 v[68:71], v[132:135], v[120:123], v[68:71]
    ds_read_b128 v[156:159], v8 offset:5120
    ds_read_b128 v[160:163], v8 offset:7168
    v_mfma_f32_16x16x32_bf16 v[84:87], v[132:135], v[124:127], v[84:87]
    ds_read_b64_tr_b16 v[164:165], v11 offset:7168
    ds_read_b64_tr_b16 v[166:167], v11 offset:8960
    v_mfma_f32_16x16x32_bf16 v[100:103], v[132:135], v[128:131], v[100:103]
    ds_read_b64_tr_b16 v[168:169], v11 offset:21504
    ds_read_b64_tr_b16 v[170:171], v11 offset:23296
    v_mfma_f32_16x16x32_bf16 v[56:59], v[136:139], v[116:119], v[56:59]
    ds_read_b64_tr_b16 v[172:173], v11 offset:7200
    ds_read_b64_tr_b16 v[174:175], v11 offset:8992
    v_mfma_f32_16x16x32_bf16 v[72:75], v[136:139], v[120:123], v[72:75]
    ds_read_b64_tr_b16 v[176:177], v11 offset:21536
    ds_read_b64_tr_b16 v[178:179], v11 offset:23328
    v_mfma_f32_16x16x32_bf16 v[88:91], v[136:139], v[124:127], v[88:91]
    v_mfma_f32_16x16x32_bf16 v[104:107], v[136:139], v[128:131], v[104:107]
    v_mfma_f32_16x16x32_bf16 v[60:63], v[140:143], v[116:119], v[60:63]
    v_mfma_f32_16x16x32_bf16 v[76:79], v[140:143], v[120:123], v[76:79]
    v_mfma_f32_16x16x32_bf16 v[92:95], v[140:143], v[124:127], v[92:95]
    v_mfma_f32_16x16x32_bf16 v[108:111], v[140:143], v[128:131], v[108:111]
    v_mfma_f32_16x16x32_bf16 v[64:67], v[144:147], v[116:119], v[64:67]
    v_mfma_f32_16x16x32_bf16 v[80:83], v[144:147], v[120:123], v[80:83]
    v_mfma_f32_16x16x32_bf16 v[96:99], v[144:147], v[124:127], v[96:99]
    v_mfma_f32_16x16x32_bf16 v[112:115], v[144:147], v[128:131], v[112:115]
    s_waitcnt vmcnt(6) lgkmcnt(0)
    s_barrier
    v_mfma_f32_16x16x32_bf16 v[52:55], v[164:167], v[148:151], v[52:55]
    ds_read_b128 v[116:119], v9 offset:0
    ds_read_b128 v[120:123], v9 offset:2048
    v_mfma_f32_16x16x32_bf16 v[68:71], v[164:167], v[152:155], v[68:71]
    ds_read_b128 v[124:127], v9 offset:4096
    ds_read_b128 v[128:131], v9 offset:6144
    v_mfma_f32_16x16x32_bf16 v[84:87], v[164:167], v[156:159], v[84:87]
    ds_read_b64_tr_b16 v[132:133], v12 offset:0
    ds_read_b64_tr_b16 v[134:135], v12 offset:1792
    v_mfma_f32_16x16x32_bf16 v[100:103], v[164:167], v[160:163], v[100:103]
    ds_read_b64_tr_b16 v[136:137], v12 offset:14336
    ds_read_b64_tr_b16 v[138:139], v12 offset:16128
    v_mfma_f32_16x16x32_bf16 v[56:59], v[168:171], v[148:151], v[56:59]
    ds_read_b64_tr_b16 v[140:141], v12 offset:32
    ds_read_b64_tr_b16 v[142:143], v12 offset:1824
    v_mfma_f32_16x16x32_bf16 v[72:75], v[168:171], v[152:155], v[72:75]
    ds_read_b64_tr_b16 v[144:145], v12 offset:14368
    ds_read_b64_tr_b16 v[146:147], v12 offset:16160
    v_mfma_f32_16x16x32_bf16 v[88:91], v[168:171], v[156:159], v[88:91]
    s_add_u32 m0, s85, 0
    s_nop 0
    buffer_load_dwordx4 v2, s[8:11], s84 offen sc1 lds
    v_mfma_f32_16x16x32_bf16 v[104:107], v[168:171], v[160:163], v[104:107]
    v_mfma_f32_16x16x32_bf16 v[60:63], v[172:175], v[148:151], v[60:63]
    buffer_load_dwordx4 v2, s[8:11], s84 offen offset:1024 sc1 lds
    v_mfma_f32_16x16x32_bf16 v[76:79], v[172:175], v[152:155], v[76:79]
    v_mfma_f32_16x16x32_bf16 v[92:95], v[172:175], v[156:159], v[92:95]
    s_add_u32 m0, s85, 14336
    s_add_u32 s75, s84, 143360
    buffer_load_dwordx4 v2, s[8:11], s75 offen sc1 lds
    v_mfma_f32_16x16x32_bf16 v[108:111], v[172:175], v[160:163], v[108:111]
    v_mfma_f32_16x16x32_bf16 v[64:67], v[176:179], v[148:151], v[64:67]
    buffer_load_dwordx4 v2, s[8:11], s75 offen offset:1024 sc1 lds
    s_add_u32 s84, s84, 14336
    v_mfma_f32_16x16x32_bf16 v[80:83], v[176:179], v[152:155], v[80:83]
    v_mfma_f32_16x16x32_bf16 v[96:99], v[176:179], v[156:159], v[96:99]
    v_mfma_f32_16x16x32_bf16 v[112:115], v[176:179], v[160:163], v[112:115]
    s_waitcnt lgkmcnt(0)
    v_mfma_f32_16x16x32_bf16 v[52:55], v[132:135], v[116:119], v[52:55]
    ds_read_b128 v[148:151], v9 offset:1024
    ds_read_b128 v[152:155], v9 offset:3072
    v_mfma_f32_16x16x32_bf16 v[68:71], v[132:135], v[120:123], v[68:71]
    ds_read_b128 v[156:159], v9 offset:5120
    ds_read_b128 v[160:163], v9 offset:7168
    v_mfma_f32_16x16x32_bf16 v[84:87], v[132:135], v[124:127], v[84:87]
    ds_read_b64_tr_b16 v[164:165], v12 offset:7168
    ds_read_b64_tr_b16 v[166:167], v12 offset:8960
    v_mfma_f32_16x16x32_bf16 v[100:103], v[132:135], v[128:131], v[100:103]
    ds_read_b64_tr_b16 v[168:169], v12 offset:21504
    ds_read_b64_tr_b16 v[170:171], v12 offset:23296
    v_mfma_f32_16x16x32_bf16 v[56:59], v[136:139], v[116:119], v[56:59]
    ds_read_b64_tr_b16 v[172:173], v12 offset:7200
    ds_read_b64_tr_b16 v[174:175], v12 offset:8992
    v_mfma_f32_16x16x32_bf16 v[72:75], v[136:139], v[120:123], v[72:75]
    ds_read_b64_tr_b16 v[176:177], v12 offset:21536
    ds_read_b64_tr_b16 v[178:179], v12 offset:23328
    v_mfma_f32_16x16x32_bf16 v[88:91], v[136:139], v[124:127], v[88:91]
    s_add_u32 m0, s87, 0
    s_nop 0
    buffer_load_dwordx4 v2, s[8:11], s86 offen sc1 lds
    v_mfma_f32_16x16x32_bf16 v[104:107], v[136:139], v[128:131], v[104:107]
    v_mfma_f32_16x16x32_bf16 v[60:63], v[140:143], v[116:119], v[60:63]
    v_mfma_f32_16x16x32_bf16 v[76:79], v[140:143], v[120:123], v[76:79]
    v_mfma_f32_16x16x32_bf16 v[92:95], v[140:143], v[124:127], v[92:95]
    buffer_load_dwordx4 v2, s[8:11], s86 offen offset:1024 sc1 lds
    s_add_u32 s86, s86, 2048
    v_mfma_f32_16x16x32_bf16 v[108:111], v[140:143], v[128:131], v[108:111]
    v_mfma_f32_16x16x32_bf16 v[64:67], v[144:147], v[116:119], v[64:67]
    v_mfma_f32_16x16x32_bf16 v[80:83], v[144:147], v[120:123], v[80:83]
    v_mfma_f32_16x16x32_bf16 v[96:99], v[144:147], v[124:127], v[96:99]
    v_mfma_f32_16x16x32_bf16 v[112:115], v[144:147], v[128:131], v[112:115]
    s_waitcnt vmcnt(6) lgkmcnt(0)
    s_barrier
    v_mfma_f32_16x16x32_bf16 v[52:55], v[164:167], v[148:151], v[52:55]
    ds_read_b128 v[116:119], v10 offset:0
    ds_read_b128 v[120:123], v10 offset:2048
    v_mfma_f32_16x16x32_bf16 v[68:71], v[164:167], v[152:155], v[68:71]
    ds_read_b128 v[124:127], v10 offset:4096
    ds_read_b128 v[128:131], v10 offset:6144
    v_mfma_f32_16x16x32_bf16 v[84:87], v[164:167], v[156:159], v[84:87]
    ds_read_b64_tr_b16 v[132:133], v13 offset:0
    ds_read_b64_tr_b16 v[134:135], v13 offset:1792
    v_mfma_f32_16x16x32_bf16 v[100:103], v[164:167], v[160:163], v[100:103]
    ds_read_b64_tr_b16 v[136:137], v13 offset:14336
    ds_read_b64_tr_b16 v[138:139], v13 offset:16128
    v_mfma_f32_16x16x32_bf16 v[56:59], v[168:171], v[148:151], v[56:59]
    ds_read_b64_tr_b16 v[140:141], v13 offset:32
    ds_read_b64_tr_b16 v[142:143], v13 offset:1824
    v_mfma_f32_16x16x32_bf16 v[72:75], v[168:171], v[152:155], v[72:75]
    ds_read_b64_tr_b16 v[144:145], v13 offset:14368
    ds_read_b64_tr_b16 v[146:147], v13 offset:16160
    v_mfma_f32_16x16x32_bf16 v[88:91], v[168:171], v[156:159], v[88:91]
    s_add_u32 m0, s85, 45056
    s_nop 0
    buffer_load_dwordx4 v2, s[8:11], s84 offen sc1 lds
    v_mfma_f32_16x16x32_bf16 v[104:107], v[168:171], v[160:163], v[104:107]
    v_mfma_f32_16x16x32_bf16 v[60:63], v[172:175], v[148:151], v[60:63]
    buffer_load_dwordx4 v2, s[8:11], s84 offen offset:1024 sc1 lds
    v_mfma_f32_16x16x32_bf16 v[76:79], v[172:175], v[152:155], v[76:79]
    v_mfma_f32_16x16x32_bf16 v[92:95], v[172:175], v[156:159], v[92:95]
    s_add_u32 m0, s85, 59392
    s_add_u32 s75, s84, 143360
    buffer_load_dwordx4 v2, s[8:11], s75 offen sc1 lds
    v_mfma_f32_16x16x32_bf16 v[108:111], v[172:175], v[160:163], v[108:111]
    v_mfma_f32_16x16x32_bf16 v[64:67], v[176:179], v[148:151], v[64:67]
    buffer_load_dwordx4 v2, s[8:11], s75 offen offset:1024 sc1 lds
    s_add_u32 s84, s84, 14336
    v_mfma_f32_16x16x32_bf16 v[80:83], v[176:179], v[152:155], v[80:83]
    v_mfma_f32_16x16x32_bf16 v[96:99], v[176:179], v[156:159], v[96:99]
    v_mfma_f32_16x16x32_bf16 v[112:115], v[176:179], v[160:163], v[112:115]
    s_waitcnt lgkmcnt(0)
    v_mfma_f32_16x16x32_bf16 v[52:55], v[132:135], v[116:119], v[52:55]
    ds_read_b128 v[148:151], v10 offset:1024
    ds_read_b128 v[152:155], v10 offset:3072
    v_mfma_f32_16x16x32_bf16 v[68:71], v[132:135], v[120:123], v[68:71]
    ds_read_b128 v[156:159], v10 offset:5120
    ds_read_b128 v[160:163], v10 offset:7168
    v_mfma_f32_16x16x32_bf16 v[84:87], v[132:135], v[124:127], v[84:87]
    ds_read_b64_tr_b16 v[164:165], v13 offset:7168
    ds_read_b64_tr_b16 v[166:167], v13 offset:8960
    v_mfma_f32_16x16x32_bf16 v[100:103], v[132:135], v[128:131], v[100:103]
    ds_read_b64_tr_b16 v[168:169], v13 offset:21504
    ds_read_b64_tr_b16 v[170:171], v13 offset:23296
    v_mfma_f32_16x16x32_bf16 v[56:59], v[136:139], v[116:119], v[56:59]
    ds_read_b64_tr_b16 v[172:173], v13 offset:7200
    ds_read_b64_tr_b16 v[174:175], v13 offset:8992
    v_mfma_f32_16x16x32_bf16 v[72:75], v[136:139], v[120:123], v[72:75]
    ds_read_b64_tr_b16 v[176:177], v13 offset:21536
    ds_read_b64_tr_b16 v[178:179], v13 offset:23328
    v_mfma_f32_16x16x32_bf16 v[88:91], v[136:139], v[124:127], v[88:91]
    s_add_u32 m0, s87, 45056
    s_nop 0
    buffer_load_dwordx4 v2, s[8:11], s86 offen sc1 lds
    v_mfma_f32_16x16x32_bf16 v[104:107], v[136:139], v[128:131], v[104:107]
    buffer_load_dwordx4 v2, s[8:11], s86 offen offset:1024 sc1 lds
    s_add_u32 s86, s86, 2048
    v_mfma_f32_16x16x32_bf16 v[60:63], v[140:143], v[116:119], v[60:63]
    v_mfma_f32_16x16x32_bf16 v[76:79], v[140:143], v[120:123], v[76:79]
    buffer_load_dwordx2 v[16:17], v35, s[8:11], s83 offen offset:0 sc1
    v_mfma_f32_16x16x32_bf16 v[92:95], v[140:143], v[124:127], v[92:95]
    buffer_load_dwordx2 v[18:19], v35, s[8:11], s83 offen offset:512 sc1
    v_mfma_f32_16x16x32_bf16 v[108:111], v[140:143], v[128:131], v[108:111]
    v_mfma_f32_16x16x32_bf16 v[64:67], v[144:147], v[116:119], v[64:67]
    buffer_load_dwordx2 v[20:21], v35, s[8:11], s83 offen offset:1024 sc1
    v_mfma_f32_16x16x32_bf16 v[80:83], v[144:147], v[120:123], v[80:83]
    buffer_load_dwordx2 v[22:23], v35, s[8:11], s83 offen offset:1536 sc1
    v_mfma_f32_16x16x32_bf16 v[96:99], v[144:147], v[124:127], v[96:99]
    v_mfma_f32_16x16x32_bf16 v[112:115], v[144:147], v[128:131], v[112:115]
    s_waitcnt vmcnt(10) lgkmcnt(0)
    s_barrier
    v_mfma_f32_16x16x32_bf16 v[52:55], v[164:167], v[148:151], v[52:55]
    ds_read_b128 v[116:119], v8 offset:0
    ds_read_b128 v[120:123], v8 offset:2048
    v_mfma_f32_16x16x32_bf16 v[68:71], v[164:167], v[152:155], v[68:71]
    ds_read_b128 v[124:127], v8 offset:4096
    ds_read_b128 v[128:131], v8 offset:6144
    v_mfma_f32_16x16x32_bf16 v[84:87], v[164:167], v[156:159], v[84:87]
    ds_read_b64_tr_b16 v[132:133], v11 offset:0
    ds_read_b64_tr_b16 v[134:135], v11 offset:1792
    v_mfma_f32_16x16x32_bf16 v[100:103], v[164:167], v[160:163], v[100:103]
    ds_read_b64_tr_b16 v[136:137], v11 offset:14336
    ds_read_b64_tr_b16 v[138:139], v11 offset:16128
    v_mfma_f32_16x16x32_bf16 v[56:59], v[168:171], v[148:151], v[56:59]
    ds_read_b64_tr_b16 v[140:141], v11 offset:32
    ds_read_b64_tr_b16 v[142:143], v11 offset:1824
    v_mfma_f32_16x16x32_bf16 v[72:75], v[168:171], v[152:155], v[72:75]
    ds_read_b64_tr_b16 v[144:145], v11 offset:14368
    ds_read_b64_tr_b16 v[146:147], v11 offset:16160
    v_mfma_f32_16x16x32_bf16 v[88:91], v[168:171], v[156:159], v[88:91]
    s_add_u32 m0, s85, 90112
    s_nop 0
    buffer_load_dwordx4 v2, s[8:11], s84 offen sc1 lds
    v_mfma_f32_16x16x32_bf16 v[104:107], v[168:171], v[160:163], v[104:107]
    v_mfma_f32_16x16x32_bf16 v[60:63], v[172:175], v[148:151], v[60:63]
    buffer_load_dwordx4 v2, s[8:11], s84 offen offset:1024 sc1 lds
    v_mfma_f32_16x16x32_bf16 v[76:79], v[172:175], v[152:155], v[76:79]
    v_mfma_f32_16x16x32_bf16 v[92:95], v[172:175], v[156:159], v[92:95]
    s_add_u32 m0, s85, 104448
    s_add_u32 s75, s84, 143360
    buffer_load_dwordx4 v2, s[8:11], s75 offen sc1 lds
    v_mfma_f32_16x16x32_bf16 v[108:111], v[172:175], v[160:163], v[108:111]
    v_mfma_f32_16x16x32_bf16 v[64:67], v[176:179], v[148:151], v[64:67]
    buffer_load_dwordx4 v2, s[8:11], s75 offen offset:1024 sc1 lds
    s_add_u32 s84, s84, 14336
    v_mfma_f32_16x16x32_bf16 v[80:83], v[176:179], v[152:155], v[80:83]
    v_mfma_f32_16x16x32_bf16 v[96:99], v[176:179], v[156:159], v[96:99]
    v_mfma_f32_16x16x32_bf16 v[112:115], v[176:179], v[160:163], v[112:115]
    s_waitcnt lgkmcnt(0)
    v_mfma_f32_16x16x32_bf16 v[52:55], v[132:135], v[116:119], v[52:55]
    ds_read_b128 v[148:151], v8 offset:1024
    ds_read_b128 v[152:155], v8 offset:3072
    v_mfma_f32_16x16x32_bf16 v[68:71], v[132:135], v[120:123], v[68:71]
    ds_read_b128 v[156:159], v8 offset:5120
    ds_read_b128 v[160:163], v8 offset:7168
    v_mfma_f32_16x16x32_bf16 v[84:87], v[132:135], v[124:127], v[84:87]
    ds_read_b64_tr_b16 v[164:165], v11 offset:7168
    ds_read_b64_tr_b16 v[166:167], v11 offset:8960
    v_mfma_f32_16x16x32_bf16 v[100:103], v[132:135], v[128:131], v[100:103]
    ds_read_b64_tr_b16 v[168:169], v11 offset:21504
    ds_read_b64_tr_b16 v[170:171], v11 offset:23296
    v_mfma_f32_16x16x32_bf16 v[56:59], v[136:139], v[116:119], v[56:59]
    ds_read_b64_tr_b16 v[172:173], v11 offset:7200
    ds_read_b64_tr_b16 v[174:175], v11 offset:8992
    v_mfma_f32_16x16x32_bf16 v[72:75], v[136:139], v[120:123], v[72:75]
    ds_read_b64_tr_b16 v[176:177], v11 offset:21536
    ds_read_b64_tr_b16 v[178:179], v11 offset:23328
    v_mfma_f32_16x16x32_bf16 v[88:91], v[136:139], v[124:127], v[88:91]
    s_add_u32 m0, s87, 90112
    s_nop 0
    buffer_load_dwordx4 v2, s[8:11], s86 offen sc1 lds
    v_mfma_f32_16x16x32_bf16 v[104:107], v[136:139], v[128:131], v[104:107]
    v_mfma_f32_16x16x32_bf16 v[60:63], v[140:143], v[116:119], v[60:63]
    v_mfma_f32_16x16x32_bf16 v[76:79], v[140:143], v[120:123], v[76:79]
    v_mfma_f32_16x16x32_bf16 v[92:95], v[140:143], v[124:127], v[92:95]
    buffer_load_dwordx4 v2, s[8:11], s86 offen offset:1024 sc1 lds
    s_add_u32 s86, s86, 2048
    v_mfma_f32_16x16x32_bf16 v[108:111], v[140:143], v[128:131], v[108:111]
    v_mfma_f32_16x16x32_bf16 v[64:67], v[144:147], v[116:119], v[64:67]
    v_mfma_f32_16x16x32_bf16 v[80:83], v[144:147], v[120:123], v[80:83]
    v_mfma_f32_16x16x32_bf16 v[96:99], v[144:147], v[124:127], v[96:99]
    v_mfma_f32_16x16x32_bf16 v[112:115], v[144:147], v[128:131], v[112:115]
    s_waitcnt vmcnt(6) lgkmcnt(0)
    s_barrier
    v_mfma_f32_16x16x32_bf16 v[52:55], v[164:167], v[148:151], v[52:55]
    ds_read_b128 v[116:119], v9 offset:0
    ds_read_b128 v[120:123], v9 offset:2048
    v_mfma_f32_16x16x32_bf16 v[68:71], v[164:167], v[152:155], v[68:71]
    ds_read_b128 v[124:127], v9 offset:4096
    ds_read_b128 v[128:131], v9 offset:6144
    v_mfma_f32_16x16x32_bf16 v[84:87], v[164:167], v[156:159], v[84:87]
    ds_read_b64_tr_b16 v[132:133], v12 offset:0
    ds_read_b64_tr_b16 v[134:135], v12 offset:1792
    v_mfma_f32_16x16x32_bf16 v[100:103], v[164:167], v[160:163], v[100:103]
    ds_read_b64_tr_b16 v[136:137], v12 offset:14336
    ds_read_b64_tr_b16 v[138:139], v12 offset:16128
    v_mfma_f32_16x16x32_bf16 v[56:59], v[168:171], v[148:151], v[56:59]
    ds_read_b64_tr_b16 v[140:141], v12 offset:32
    ds_read_b64_tr_b16 v[142:143], v12 offset:1824
    v_mfma_f32_16x16x32_bf16 v[72:75], v[168:171], v[152:155], v[72:75]
    ds_read_b64_tr_b16 v[144:145], v12 offset:14368
    ds_read_b64_tr_b16 v[146:147], v12 offset:16160
    v_mfma_f32_16x16x32_bf16 v[88:91], v[168:171], v[156:159], v[88:91]
    s_add_u32 m0, s85, 0
    s_nop 0
    buffer_load_dwordx4 v2, s[8:11], s84 offen sc1 lds
    v_mfma_f32_16x16x32_bf16 v[104:107], v[168:171], v[160:163], v[104:107]
    v_mfma_f32_16x16x32_bf16 v[60:63], v[172:175], v[148:151], v[60:63]
    buffer_load_dwordx4 v2, s[8:11], s84 offen offset:1024 sc1 lds
    v_mfma_f32_16x16x32_bf16 v[76:79], v[172:175], v[152:155], v[76:79]
    v_mfma_f32_16x16x32_bf16 v[92:95], v[172:175], v[156:159], v[92:95]
    s_add_u32 m0, s85, 14336
    s_add_u32 s75, s84, 143360
    buffer_load_dwordx4 v2, s[8:11], s75 offen sc1 lds
    v_mfma_f32_16x16x32_bf16 v[108:111], v[172:175], v[160:163], v[108:111]
    v_mfma_f32_16x16x32_bf16 v[64:67], v[176:179], v[148:151], v[64:67]
    buffer_load_dwordx4 v2, s[8:11], s75 offen offset:1024 sc1 lds
    s_add_u32 s84, s84, 14336
    v_mfma_f32_16x16x32_bf16 v[80:83], v[176:179], v[152:155], v[80:83]
    v_mfma_f32_16x16x32_bf16 v[96:99], v[176:179], v[156:159], v[96:99]
    v_mfma_f32_16x16x32_bf16 v[112:115], v[176:179], v[160:163], v[112:115]
    s_waitcnt lgkmcnt(0)
    v_mfma_f32_16x16x32_bf16 v[52:55], v[132:135], v[116:119], v[52:55]
    ds_read_b128 v[148:151], v9 offset:1024
    ds_read_b128 v[152:155], v9 offset:3072
    v_mfma_f32_16x16x32_bf16 v[68:71], v[132:135], v[120:123], v[68:71]
    ds_read_b128 v[156:159], v9 offset:5120
    ds_read_b128 v[160:163], v9 offset:7168
    v_mfma_f32_16x16x32_bf16 v[84:87], v[132:135], v[124:127], v[84:87]
    ds_read_b64_tr_b16 v[164:165], v12 offset:7168
    ds_read_b64_tr_b16 v[166:167], v12 offset:8960
    v_mfma_f32_16x16x32_bf16 v[100:103], v[132:135], v[128:131], v[100:103]
    ds_read_b64_tr_b16 v[168:169], v12 offset:21504
    ds_read_b64_tr_b16 v[170:171], v12 offset:23296
    v_mfma_f32_16x16x32_bf16 v[56:59], v[136:139], v[116:119], v[56:59]
    ds_read_b64_tr_b16 v[172:173], v12 offset:7200
    ds_read_b64_tr_b16 v[174:175], v12 offset:8992
    v_mfma_f32_16x16x32_bf16 v[72:75], v[136:139], v[120:123], v[72:75]
    ds_read_b64_tr_b16 v[176:177], v12 offset:21536
    ds_read_b64_tr_b16 v[178:179], v12 offset:23328
    v_mfma_f32_16x16x32_bf16 v[88:91], v[136:139], v[124:127], v[88:91]
    s_add_u32 m0, s87, 0
    s_nop 0
    buffer_load_dwordx4 v2, s[8:11], s86 offen sc1 lds
    v_mfma_f32_16x16x32_bf16 v[104:107], v[136:139], v[128:131], v[104:107]
    v_mfma_f32_16x16x32_bf16 v[60:63], v[140:143], v[116:119], v[60:63]
    v_mfma_f32_16x16x32_bf16 v[76:79], v[140:143], v[120:123], v[76:79]
    buffer_load_dwordx4 v2, s[8:11], s86 offen offset:1024 sc1 lds
    s_add_u32 s86, s86, 2048
    v_mfma_f32_16x16x32_bf16 v[92:95], v[140:143], v[124:127], v[92:95]
    v_mfma_f32_16x16x32_bf16 v[108:111], v[140:143], v[128:131], v[108:111]
    v_mfma_f32_16x16x32_bf16 v[64:67], v[144:147], v[116:119], v[64:67]
    v_add_f32 v16, v16, v18
    v_add_f32 v17, v17, v19
    v_add_f32 v20, v20, v22
    v_add_f32 v21, v21, v23
    v_add_f32 v16, v16, v20
    v_add_f32 v17, v17, v21
    ds_write_b64 v41, v[16:17]
    v_mfma_f32_16x16x32_bf16 v[80:83], v[144:147], v[120:123], v[80:83]
    v_mfma_f32_16x16x32_bf16 v[96:99], v[144:147], v[124:127], v[96:99]
    v_mfma_f32_16x16x32_bf16 v[112:115], v[144:147], v[128:131], v[112:115]
    s_waitcnt vmcnt(6) lgkmcnt(0)
    s_barrier
    v_mfma_f32_16x16x32_bf16 v[52:55], v[164:167], v[148:151], v[52:55]
    ds_read_b128 v[116:119], v10 offset:0
    ds_read_b128 v[120:123], v10 offset:2048
    v_mfma_f32_16x16x32_bf16 v[68:71], v[164:167], v[152:155], v[68:71]
    ds_read_b128 v[124:127], v10 offset:4096
    ds_read_b128 v[128:131], v10 offset:6144
    v_mfma_f32_16x16x32_bf16 v[84:87], v[164:167], v[156:159], v[84:87]
    ds_read_b64_tr_b16 v[132:133], v13 offset:0
    ds_read_b64_tr_b16 v[134:135], v13 offset:1792
    v_mfma_f32_16x16x32_bf16 v[100:103], v[164:167], v[160:163], v[100:103]
    ds_read_b64_tr_b16 v[136:137], v13 offset:14336
    ds_read_b64_tr_b16 v[138:139], v13 offset:16128
    v_mfma_f32_16x16x32_bf16 v[56:59], v[168:171], v[148:151], v[56:59]
    ds_read_b64_tr_b16 v[140:141], v13 offset:32
    ds_read_b64_tr_b16 v[142:143], v13 offset:1824
    v_mfma_f32_16x16x32_bf16 v[72:75], v[168:171], v[152:155], v[72:75]
    ds_read_b64_tr_b16 v[144:145], v13 offset:14368
    ds_read_b64_tr_b16 v[146:147], v13 offset:16160
    v_mfma_f32_16x16x32_bf16 v[88:91], v[168:171], v[156:159], v[88:91]
    s_add_u32 m0, s85, 45056
    s_nop 0
    buffer_load_dwordx4 v2, s[8:11], s84 offen sc1 lds
    v_mfma_f32_16x16x32_bf16 v[104:107], v[168:171], v[160:163], v[104:107]
    v_mfma_f32_16x16x32_bf16 v[60:63], v[172:175], v[148:151], v[60:63]
    buffer_load_dwordx4 v2, s[8:11], s84 offen offset:1024 sc1 lds
    v_mfma_f32_16x16x32_bf16 v[76:79], v[172:175], v[152:155], v[76:79]
    v_mfma_f32_16x16x32_bf16 v[92:95], v[172:175], v[156:159], v[92:95]
    s_add_u32 m0, s85, 59392
    s_add_u32 s75, s84, 143360
    buffer_load_dwordx4 v2, s[8:11], s75 offen sc1 lds
    v_mfma_f32_16x16x32_bf16 v[108:111], v[172:175], v[160:163], v[108:111]
    v_mfma_f32_16x16x32_bf16 v[64:67], v[176:179], v[148:151], v[64:67]
    buffer_load_dwordx4 v2, s[8:11], s75 offen offset:1024 sc1 lds
    s_add_u32 s84, s84, 14336
    v_mfma_f32_16x16x32_bf16 v[80:83], v[176:179], v[152:155], v[80:83]
    v_mfma_f32_16x16x32_bf16 v[96:99], v[176:179], v[156:159], v[96:99]
    v_mfma_f32_16x16x32_bf16 v[112:115], v[176:179], v[160:163], v[112:115]
    s_waitcnt lgkmcnt(0)
    v_mfma_f32_16x16x32_bf16 v[52:55], v[132:135], v[116:119], v[52:55]
    ds_read_b128 v[148:151], v10 offset:1024
    ds_read_b128 v[152:155], v10 offset:3072
    v_mfma_f32_16x16x32_bf16 v[68:71], v[132:135], v[120:123], v[68:71]
    ds_read_b128 v[156:159], v10 offset:5120
    ds_read_b128 v[160:163], v10 offset:7168
    v_mfma_f32_16x16x32_bf16 v[84:87], v[132:135], v[124:127], v[84:87]
    ds_read_b64_tr_b16 v[164:165], v13 offset:7168
    ds_read_b64_tr_b16 v[166:167], v13 offset:8960
    v_mfma_f32_16x16x32_bf16 v[100:103], v[132:135], v[128:131], v[100:103]
    ds_read_b64_tr_b16 v[168:169], v13 offset:21504
    ds_read_b64_tr_b16 v[170:171], v13 offset:23296
    v_mfma_f32_16x16x32_bf16 v[56:59], v[136:139], v[116:119], v[56:59]
    ds_read_b64_tr_b16 v[172:173], v13 offset:7200
    ds_read_b64_tr_b16 v[174:175], v13 offset:8992
    v_mfma_f32_16x16x32_bf16 v[72:75], v[136:139], v[120:123], v[72:75]
    ds_read_b64_tr_b16 v[176:177], v13 offset:21536
    ds_read_b64_tr_b16 v[178:179], v13 offset:23328
    v_mfma_f32_16x16x32_bf16 v[88:91], v[136:139], v[124:127], v[88:91]
    s_add_u32 m0, s87, 45056
    s_nop 0
    buffer_load_dwordx4 v2, s[8:11], s86 offen sc1 lds
    v_mfma_f32_16x16x32_bf16 v[104:107], v[136:139], v[128:131], v[104:107]
    v_mfma_f32_16x16x32_bf16 v[60:63], v[140:143], v[116:119], v[60:63]
    v_mfma_f32_16x16x32_bf16 v[76:79], v[140:143], v[120:123], v[76:79]
    v_mfma_f32_16x16x32_bf16 v[92:95], v[140:143], v[124:127], v[92:95]
    buffer_load_dwordx4 v2, s[8:11], s86 offen offset:1024 sc1 lds
    s_add_u32 s86, s86, 2048
    v_mfma_f32_16x16x32_bf16 v[108:111], v[140:143], v[128:131], v[108:111]
    v_mfma_f32_16x16x32_bf16 v[64:67], v[144:147], v[116:119], v[64:67]
    v_mfma_f32_16x16x32_bf16 v[80:83], v[144:147], v[120:123], v[80:83]
    v_mfma_f32_16x16x32_bf16 v[96:99], v[144:147], v[124:127], v[96:99]
    v_mfma_f32_16x16x32_bf16 v[112:115], v[144:147], v[128:131], v[112:115]
    s_waitcnt vmcnt(6) lgkmcnt(0)
    s_barrier
    v_mfma_f32_16x16x32_bf16 v[52:55], v[164:167], v[148:151], v[52:55]
    ds_read_b128 v[116:119], v8 offset:0
    ds_read_b128 v[120:123], v8 offset:2048
    v_mfma_f32_16x16x32_bf16 v[68:71], v[164:167], v[152:155], v[68:71]
    ds_read_b128 v[124:127], v8 offset:4096
    ds_read_b128 v[128:131], v8 offset:6144
    v_mfma_f32_16x16x32_bf16 v[84:87], v[164:167], v[156:159], v[84:87]
    ds_read_b64_tr_b16 v[132:133], v11 offset:0
    ds_read_b64_tr_b16 v[134:135], v11 offset:1792
    v_mfma_f32_16x16x32_bf16 v[100:103], v[164:167], v[160:163], v[100:103]
    ds_read_b64_tr_b16 v[136:137], v11 offset:14336
    ds_read_b64_tr_b16 v[138:139], v11 offset:16128
    v_mfma_f32_16x16x32_bf16 v[56:59], v[168:171], v[148:151], v[56:59]
    ds_read_b64_tr_b16 v[140:141], v11 offset:32
    ds_read_b64_tr_b16 v[142:143], v11 offset:1824
    v_mfma_f32_16x16x32_bf16 v[72:75], v[168:171], v[152:155], v[72:75]
    ds_read_b64_tr_b16 v[144:145], v11 offset:14368
    ds_read_b64_tr_b16 v[146:147], v11 offset:16160
    v_mfma_f32_16x16x32_bf16 v[88:91], v[168:171], v[156:159], v[88:91]
    s_add_u32 m0, s85, 90112
    s_nop 0
    buffer_load_dwordx4 v2, s[8:11], s84 offen sc1 lds
    v_mfma_f32_16x16x32_bf16 v[104:107], v[168:171], v[160:163], v[104:107]
    v_mfma_f32_16x16x32_bf16 v[60:63], v[172:175], v[148:151], v[60:63]
    buffer_load_dwordx4 v2, s[8:11], s84 offen offset:1024 sc1 lds
    v_mfma_f32_16x16x32_bf16 v[76:79], v[172:175], v[152:155], v[76:79]
    v_mfma_f32_16x16x32_bf16 v[92:95], v[172:175], v[156:159], v[92:95]
    s_add_u32 m0, s85, 104448
    s_add_u32 s75, s84, 143360
    buffer_load_dwordx4 v2, s[8:11], s75 offen sc1 lds
    v_mfma_f32_16x16x32_bf16 v[108:111], v[172:175], v[160:163], v[108:111]
    v_mfma_f32_16x16x32_bf16 v[64:67], v[176:179], v[148:151], v[64:67]
    buffer_load_dwordx4 v2, s[8:11], s75 offen offset:1024 sc1 lds
    s_add_u32 s84, s84, 14336
    v_mfma_f32_16x16x32_bf16 v[80:83], v[176:179], v[152:155], v[80:83]
    v_mfma_f32_16x16x32_bf16 v[96:99], v[176:179], v[156:159], v[96:99]
    v_mfma_f32_16x16x32_bf16 v[112:115], v[176:179], v[160:163], v[112:115]
    s_waitcnt lgkmcnt(0)
    v_mfma_f32_16x16x32_bf16 v[52:55], v[132:135], v[116:119], v[52:55]
    ds_read_b128 v[148:151], v8 offset:1024
    ds_read_b128 v[152:155], v8 offset:3072
    v_mfma_f32_16x16x32_bf16 v[68:71], v[132:135], v[120:123], v[68:71]
    ds_read_b128 v[156:159], v8 offset:5120
    ds_read_b128 v[160:163], v8 offset:7168
    v_mfma_f32_16x16x32_bf16 v[84:87], v[132:135], v[124:127], v[84:87]
    ds_read_b64_tr_b16 v[164:165], v11 offset:7168
    ds_read_b64_tr_b16 v[166:167], v11 offset:8960
    v_mfma_f32_16x16x32_bf16 v[100:103], v[132:135], v[128:131], v[100:103]
    ds_read_b64_tr_b16 v[168:169], v11 offset:21504
    ds_read_b64_tr_b16 v[170:171], v11 offset:23296
    v_mfma_f32_16x16x32_bf16 v[56:59], v[136:139], v[116:119], v[56:59]
    ds_read_b64_tr_b16 v[172:173], v11 offset:7200
    ds_read_b64_tr_b16 v[174:175], v11 offset:8992
    v_mfma_f32_16x16x32_bf16 v[72:75], v[136:139], v[120:123], v[72:75]
    ds_read_b64_tr_b16 v[176:177], v11 offset:21536
    ds_read_b64_tr_b16 v[178:179], v11 offset:23328
    v_mfma_f32_16x16x32_bf16 v[88:91], v[136:139], v[124:127], v[88:91]
    s_add_u32 m0, s87, 90112
    s_nop 0
    buffer_load_dwordx4 v2, s[8:11], s86 offen sc1 lds
    v_mfma_f32_16x16x32_bf16 v[104:107], v[136:139], v[128:131], v[104:107]
    v_mfma_f32_16x16x32_bf16 v[60:63], v[140:143], v[116:119], v[60:63]
    buffer_load_dwordx4 v2, s[8:11], s86 offen offset:1024 sc1 lds
    s_add_u32 s86, s86, 2048
    v_mfma_f32_16x16x32_bf16 v[76:79], v[140:143], v[120:123], v[76:79]
    v_mfma_f32_16x16x32_bf16 v[92:95], v[140:143], v[124:127], v[92:95]
    v_and_b32 v14, 15, v1
    s_lshl_b32 s71, s81, 7
    s_add_u32 s71, s71, 158720
    v_lshl_add_u32 v14, v14, 3, s71
    ds_read_b64 v[180:181], v14 offset:0
    ds_read_b64 v[182:183], v14 offset:1024
    ds_read_b64 v[184:185], v14 offset:2048
    ds_read_b64 v[186:187], v14 offset:3072
    ds_read_b64 v[188:189], v14 offset:128
    ds_read_b64 v[190:191], v14 offset:1152
    ds_read_b64 v[192:193], v14 offset:2176
    ds_read_b64 v[194:195], v14 offset:3200
    v_mfma_f32_16x16x32_bf16 v[108:111], v[140:143], v[128:131], v[108:111]
    v_mfma_f32_16x16x32_bf16 v[64:67], v[144:147], v[116:119], v[64:67]
    ds_read_b64 v[196:197], v14 offset:256
    ds_read_b64 v[198:199], v14 offset:1280
    ds_read_b64 v[200:201], v14 offset:2304
    ds_read_b64 v[202:203], v14 offset:3328
    ds_read_b64 v[204:205], v14 offset:384
    ds_read_b64 v[206:207], v14 offset:1408
    ds_read_b64 v[208:209], v14 offset:2432
    ds_read_b64 v[210:211], v14 offset:3456
    v_mfma_f32_16x16x32_bf16 v[80:83], v[144:147], v[120:123], v[80:83]
    v_mfma_f32_16x16x32_bf16 v[96:99], v[144:147], v[124:127], v[96:99]
    v_mfma_f32_16x16x32_bf16 v[112:115], v[144:147], v[128:131], v[112:115]
    s_waitcnt vmcnt(6) lgkmcnt(0)
    s_barrier
    v_mfma_f32_16x16x32_bf16 v[52:55], v[164:167], v[148:151], v[52:55]
    ds_read_b128 v[116:119], v9 offset:0
    ds_read_b128 v[120:123], v9 offset:2048
    v_mfma_f32_16x16x32_bf16 v[68:71], v[164:167], v[152:155], v[68:71]
    ds_read_b128 v[124:127], v9 offset:4096
    ds_read_b128 v[128:131], v9 offset:6144
    v_mfma_f32_16x16x32_bf16 v[84:87], v[164:167], v[156:159], v[84:87]
    ds_read_b64_tr_b16 v[132:133], v12 offset:0
    ds_read_b64_tr_b16 v[134:135], v12 offset:1792
    v_mfma_f32_16x16x32_bf16 v[100:103], v[164:167], v[160:163], v[100:103]
    ds_read_b64_tr_b16 v[136:137], v12 offset:14336
    ds_read_b64_tr_b16 v[138:139], v12 offset:16128
    v_mfma_f32_16x16x32_bf16 v[56:59], v[168:171], v[148:151], v[56:59]
    ds_read_b64_tr_b16 v[140:141], v12 offset:32
    ds_read_b64_tr_b16 v[142:143], v12 offset:1824
    v_mfma_f32_16x16x32_bf16 v[72:75], v[168:171], v[152:155], v[72:75]
    ds_read_b64_tr_b16 v[144:145], v12 offset:14368
    ds_read_b64_tr_b16 v[146:147], v12 offset:16160
    v_mfma_f32_16x16x32_bf16 v[88:91], v[168:171], v[156:159], v[88:91]
    s_add_u32 m0, s85, 0
    s_nop 0
    buffer_load_dwordx4 v2, s[8:11], s84 offen sc1 lds
    v_mfma_f32_16x16x32_bf16 v[104:107], v[168:171], v[160:163], v[104:107]
    v_mfma_f32_16x16x32_bf16 v[60:63], v[172:175], v[148:151], v[60:63]
    buffer_load_dwordx4 v2, s[8:11], s84 offen offset:1024 sc1 lds
    v_mfma_f32_16x16x32_bf16 v[76:79], v[172:175], v[152:155], v[76:79]
    v_mfma_f32_16x16x32_bf16 v[92:95], v[172:175], v[156:159], v[92:95]
    s_add_u32 m0, s85, 14336
    s_add_u32 s75, s84, 143360
    buffer_load_dwordx4 v2, s[8:11], s75 offen sc1 lds
    v_mfma_f32_16x16x32_bf16 v[108:111], v[172:175], v[160:163], v[108:111]
    v_mfma_f32_16x16x32_bf16 v[64:67], v[176:179], v[148:151], v[64:67]
    buffer_load_dwordx4 v2, s[8:11], s75 offen offset:1024 sc1 lds
    s_add_u32 s84, s84, 14336
    v_mfma_f32_16x16x32_bf16 v[80:83], v[176:179], v[152:155], v[80:83]
    v_mfma_f32_16x16x32_bf16 v[96:99], v[176:179], v[156:159], v[96:99]
    v_mfma_f32_16x16x32_bf16 v[112:115], v[176:179], v[160:163], v[112:115]
    s_waitcnt lgkmcnt(0)
    v_mfma_f32_16x16x32_bf16 v[52:55], v[132:135], v[116:119], v[52:55]
    ds_read_b128 v[148:151], v9 offset:1024
    ds_read_b128 v[152:155], v9 offset:3072
    v_mfma_f32_16x16x32_bf16 v[68:71], v[132:135], v[120:123], v[68:71]
    ds_read_b128 v[156:159], v9 offset:5120
    ds_read_b128 v[160:163], v9 offset:7168
    v_mfma_f32_16x16x32_bf16 v[84:87], v[132:135], v[124:127], v[84:87]
    ds_read_b64_tr_b16 v[164:165], v12 offset:7168
    ds_read_b64_tr_b16 v[166:167], v12 offset:8960
    v_mfma_f32_16x16x32_bf16 v[100:103], v[132:135], v[128:131], v[100:103]
    ds_read_b64_tr_b16 v[168:169], v12 offset:21504
    ds_read_b64_tr_b16 v[170:171], v12 offset:23296
    v_mfma_f32_16x16x32_bf16 v[56:59], v[136:139], v[116:119], v[56:59]
    ds_read_b64_tr_b16 v[172:173], v12 offset:7200
    ds_read_b64_tr_b16 v[174:175], v12 offset:8992
    v_mfma_f32_16x16x32_bf16 v[72:75], v[136:139], v[120:123], v[72:75]
    ds_read_b64_tr_b16 v[176:177], v12 offset:21536
    ds_read_b64_tr_b16 v[178:179], v12 offset:23328
    v_mfma_f32_16x16x32_bf16 v[88:91], v[136:139], v[124:127], v[88:91]
    s_add_u32 m0, s87, 0
    s_nop 0
    buffer_load_dwordx4 v2, s[8:11], s86 offen sc1 lds
    v_mfma_f32_16x16x32_bf16 v[104:107], v[136:139], v[128:131], v[104:107]
    buffer_load_dwordx4 v2, s[8:11], s86 offen offset:1024 sc1 lds
    s_add_u32 s86, s86, 2048
    v_mfma_f32_16x16x32_bf16 v[60:63], v[140:143], v[116:119], v[60:63]
    s_mov_b32 s74, 0x3acccccd
    v_mfma_f32_16x16x32_bf16 v[76:79], v[140:143], v[120:123], v[76:79]
    v_add_f32 v180, v180, v182
    v_add_f32 v181, v181, v183
    v_add_f32 v184, v184, v186
    v_add_f32 v185, v185, v187
    v_add_f32 v180, v180, v184
    v_add_f32 v181, v181, v185
    v_mul_f32 v180, s74, v180
    v_mul_f32 v181, s74, v181
    v_fma_f32 v181, -v180, v180, v181
    v_max_f32 v181, 0, v181
    v_add_f32 v181, 0x3727c5ac, v181
    v_rsq_f32 v16, v181
    s_nop 0
    v_mov_b32 v17, v16
    v_mul_f32 v18, -v16, v180
    v_mul_f32 v19, -v16, v180
    v_mfma_f32_16x16x32_bf16 v[92:95], v[140:143], v[124:127], v[92:95]
    v_mfma_f32_16x16x32_bf16 v[108:111], v[140:143], v[128:131], v[108:111]
    v_add_f32 v188, v188, v190
    v_add_f32 v189, v189, v191
    v_add_f32 v192, v192, v194
    v_add_f32 v193, v193, v195
    v_add_f32 v188, v188, v192
    v_add_f32 v189, v189, v193
    v_mul_f32 v188, s74, v188
    v_mul_f32 v189, s74, v189
    v_fma_f32 v189, -v188, v188, v189
    v_max_f32 v189, 0, v189
    v_add_f32 v189, 0x3727c5ac, v189
    v_rsq_f32 v20, v189
    s_nop 0
    v_mov_b32 v21, v20
    v_mul_f32 v22, -v20, v188
    v_mul_f32 v23, -v20, v188
    v_mfma_f32_16x16x32_bf16 v[64:67], v[144:147], v[116:119], v[64:67]
    v_add_f32 v196, v196, v198
    v_add_f32 v197, v197, v199
    v_add_f32 v200, v200, v202
    v_add_f32 v201, v201, v203
    v_add_f32 v196, v196, v200
    v_add_f32 v197, v197, v201
    v_mul_f32 v196, s74, v196
    v_mul_f32 v197, s74, v197
    v_fma_f32 v197, -v196, v196, v197
    v_max_f32 v197, 0, v197
    v_add_f32 v197, 0x3727c5ac, v197
    v_rsq_f32 v24, v197
    s_nop 0
    v_mov_b32 v25, v24
    v_mul_f32 v26, -v24, v196
    v_mul_f32 v27, -v24, v196
    v_mfma_f32_16x16x32_bf16 v[80:83], v[144:147], v[120:123], v[80:83]
    v_add_f32 v204, v204, v206
    v_add_f32 v205, v205, v207
    v_add_f32 v208, v208, v210
    v_add_f32 v209, v209, v211
    v_add_f32 v204, v204, v208
    v_add_f32 v205, v205, v209
    v_mul_f32 v204, s74, v204
    v_mul_f32 v205, s74, v205
    v_fma_f32 v205, -v204, v204, v205
    v_max_f32 v205, 0, v205
    v_add_f32 v205, 0x3727c5ac, v205
    v_rsq_f32 v28, v205
    s_nop 0
    v_mov_b32 v29, v28
    v_mul_f32 v30, -v28, v204
    v_mul_f32 v31, -v28, v204
    v_mfma_f32_16x16x32_bf16 v[96:99], v[144:147], v[124:127], v[96:99]
    v_mfma_f32_16x16x32_bf16 v[112:115], v[144:147], v[128:131], v[112:115]
    s_waitcnt vmcnt(6) lgkmcnt(0)
    s_barrier
    v_mfma_f32_16x16x32_bf16 v[52:55], v[164:167], v[148:151], v[52:55]
    ds_read_b128 v[116:119], v10 offset:0
    ds_read_b128 v[120:123], v10 offset:2048
    v_mfma_f32_16x16x32_bf16 v[68:71], v[164:167], v[152:155], v[68:71]
    ds_read_b128 v[124:127], v10 offset:4096
    ds_read_b128 v[128:131], v10 offset:6144
    v_mfma_f32_16x16x32_bf16 v[84:87], v[164:167], v[156:159], v[84:87]
    ds_read_b64_tr_b16 v[132:133], v13 offset:0
    ds_read_b64_tr_b16 v[134:135], v13 offset:1792
    v_mfma_f32_16x16x32_bf16 v[100:103], v[164:167], v[160:163], v[100:103]
    ds_read_b64_tr_b16 v[136:137], v13 offset:14336
    ds_read_b64_tr_b16 v[138:139], v13 offset:16128
    v_mfma_f32_16x16x32_bf16 v[56:59], v[168:171], v[148:151], v[56:59]
    ds_read_b64_tr_b16 v[140:141], v13 offset:32
    ds_read_b64_tr_b16 v[142:143], v13 offset:1824
    v_mfma_f32_16x16x32_bf16 v[72:75], v[168:171], v[152:155], v[72:75]
    ds_read_b64_tr_b16 v[144:145], v13 offset:14368
    ds_read_b64_tr_b16 v[146:147], v13 offset:16160
    v_mfma_f32_16x16x32_bf16 v[88:91], v[168:171], v[156:159], v[88:91]
    s_add_u32 s73, s76, 0
    s_add_u32 m0, s77, 65536
    s_nop 0
    buffer_load_dwordx4 v2, s[8:11], s73 offen offset:0 sc1 lds
    v_mfma_f32_16x16x32_bf16 v[104:107], v[168:171], v[160:163], v[104:107]
    buffer_load_dwordx4 v2, s[8:11], s73 offen offset:1024 sc1 lds
    v_mfma_f32_16x16x32_bf16 v[60:63], v[172:175], v[148:151], v[60:63]
    v_mfma_f32_16x16x32_bf16 v[76:79], v[172:175], v[152:155], v[76:79]
    buffer_load_dwordx4 v2, s[8:11], s73 offen offset:2048 sc1 lds
    v_mfma_f32_16x16x32_bf16 v[92:95], v[172:175], v[156:159], v[92:95]
    v_mfma_f32_16x16x32_bf16 v[108:111], v[172:175], v[160:163], v[108:111]
    buffer_load_dwordx4 v2, s[8:11], s73 offen offset:3072 sc1 lds
    v_mfma_f32_16x16x32_bf16 v[64:67], v[176:179], v[148:151], v[64:67]
    v_mfma_f32_16x16x32_bf16 v[80:83], v[176:179], v[152:155], v[80:83]
    s_add_u32 s73, s73, 4096
    s_add_u32 m0, s77, 69632
    s_nop 0
    buffer_load_dwordx4 v2, s[8:11], s73 offen sc1 lds
    v_mfma_f32_16x16x32_bf16 v[96:99], v[176:179], v[156:159], v[96:99]
    v_mfma_f32_16x16x32_bf16 v[112:115], v[176:179], v[160:163], v[112:115]
    s_waitcnt lgkmcnt(0)
    v_mfma_f32_16x16x32_bf16 v[52:55], v[132:135], v[116:119], v[52:55]
    ds_read_b128 v[148:151], v10 offset:1024
    ds_read_b128 v[152:155], v10 offset:3072
    v_mfma_f32_16x16x32_bf16 v[68:71], v[132:135], v[120:123], v[68:71]
    ds_read_b128 v[156:159], v10 offset:5120
    ds_read_b128 v[160:163], v10 offset:7168
    v_mfma_f32_16x16x32_bf16 v[84:87], v[132:135], v[124:127], v[84:87]
    ds_read_b64_tr_b16 v[164:165], v13 offset:7168
    ds_read_b64_tr_b16 v[166:167], v13 offset:8960
    v_mfma_f32_16x16x32_bf16 v[100:103], v[132:135], v[128:131], v[100:103]
    ds_read_b64_tr_b16 v[168:169], v13 offset:21504
    ds_read_b64_tr_b16 v[170:171], v13 offset:23296
    v_mfma_f32_16x16x32_bf16 v[56:59], v[136:139], v[116:119], v[56:59]
    ds_read_b64_tr_b16 v[172:173], v13 offset:7200
    ds_read_b64_tr_b16 v[174:175], v13 offset:8992
    v_mfma_f32_16x16x32_bf16 v[72:75], v[136:139], v[120:123], v[72:75]
    ds_read_b64_tr_b16 v[176:177], v13 offset:21536
    ds_read_b64_tr_b16 v[178:179], v13 offset:23328
    v_mfma_f32_16x16x32_bf16 v[88:91], v[136:139], v[124:127], v[88:91]
    v_mfma_f32_16x16x32_bf16 v[104:107], v[136:139], v[128:131], v[104:107]
    v_mfma_f32_16x16x32_bf16 v[60:63], v[140:143], v[116:119], v[60:63]
    v_mfma_f32_16x16x32_bf16 v[76:79], v[140:143], v[120:123], v[76:79]
    v_mfma_f32_16x16x32_bf16 v[92:95], v[140:143], v[124:127], v[92:95]
    v_mfma_f32_16x16x32_bf16 v[108:111], v[140:143], v[128:131], v[108:111]
    v_mfma_f32_16x16x32_bf16 v[64:67], v[144:147], v[116:119], v[64:67]
    v_mfma_f32_16x16x32_bf16 v[80:83], v[144:147], v[120:123], v[80:83]
    v_mfma_f32_16x16x32_bf16 v[96:99], v[144:147], v[124:127], v[96:99]
    v_mfma_f32_16x16x32_bf16 v[112:115], v[144:147], v[128:131], v[112:115]
    s_waitcnt vmcnt(5) lgkmcnt(0)
    s_barrier
    v_mfma_f32_16x16x32_bf16 v[52:55], v[164:167], v[148:151], v[52:55]
    ds_read_b128 v[116:119], v8 offset:0
    ds_read_b128 v[120:123], v8 offset:2048
    v_mfma_f32_16x16x32_bf16 v[68:71], v[164:167], v[152:155], v[68:71]
    ds_read_b128 v[124:127], v8 offset:4096
    ds_read_b128 v[128:131], v8 offset:6144
    v_mfma_f32_16x16x32_bf16 v[84:87], v[164:167], v[156:159], v[84:87]
    ds_read_b64_tr_b16 v[132:133], v11 offset:0
    ds_read_b64_tr_b16 v[134:135], v11 offset:1792
    v_mfma_f32_16x16x32_bf16 v[100:103], v[164:167], v[160:163], v[100:103]
    ds_read_b64_tr_b16 v[136:137], v11 offset:14336
    ds_read_b64_tr_b16 v[138:139], v11 offset:16128
    v_mfma_f32_16x16x32_bf16 v[56:59], v[168:171], v[148:151], v[56:59]
    ds_read_b64_tr_b16 v[140:141], v11 offset:32
    ds_read_b64_tr_b16 v[142:143], v11 offset:1824
    v_mfma_f32_16x16x32_bf16 v[72:75], v[168:171], v[152:155], v[72:75]
    ds_read_b64_tr_b16 v[144:145], v11 offset:14368
    ds_read_b64_tr_b16 v[146:147], v11 offset:16160
    v_mfma_f32_16x16x32_bf16 v[88:91], v[168:171], v[156:159], v[88:91]
    s_add_u32 s73, s76, 20480
    s_add_u32 m0, s77, 110592
    s_nop 0
    buffer_load_dwordx4 v2, s[8:11], s73 offen offset:0 sc1 lds
    v_mfma_f32_16x16x32_bf16 v[104:107], v[168:171], v[160:163], v[104:107]
    buffer_load_dwordx4 v2, s[8:11], s73 offen offset:1024 sc1 lds
    v_mfma_f32_16x16x32_bf16 v[60:63], v[172:175], v[148:151], v[60:63]
    v_mfma_f32_16x16x32_bf16 v[76:79], v[172:175], v[152:155], v[76:79]
    buffer_load_dwordx4 v2, s[8:11], s73 offen offset:2048 sc1 lds
    v_mfma_f32_16x16x32_bf16 v[92:95], v[172:175], v[156:159], v[92:95]
    v_mfma_f32_16x16x32_bf16 v[108:111], v[172:175], v[160:163], v[108:111]
    buffer_load_dwordx4 v2, s[8:11], s73 offen offset:3072 sc1 lds
    v_mfma_f32_16x16x32_bf16 v[64:67], v[176:179], v[148:151], v[64:67]
    v_mfma_f32_16x16x32_bf16 v[80:83], v[176:179], v[152:155], v[80:83]
    s_add_u32 s73, s73, 4096
    s_add_u32 m0, s77, 114688
    s_nop 0
    buffer_load_dwordx4 v2, s[8:11], s73 offen sc1 lds
    v_mfma_f32_16x16x32_bf16 v[96:99], v[176:179], v[156:159], v[96:99]
    v_mfma_f32_16x16x32_bf16 v[112:115], v[176:179], v[160:163], v[112:115]
    s_waitcnt lgkmcnt(0)
    v_mfma_f32_16x16x32_bf16 v[52:55], v[132:135], v[116:119], v[52:55]
    ds_read_b128 v[148:151], v8 offset:1024
    ds_read_b128 v[152:155], v8 offset:3072
    v_mfma_f32_16x16x32_bf16 v[68:71], v[132:135], v[120:123], v[68:71]
    ds_read_b128 v[156:159], v8 offset:5120
    ds_read_b128 v[160:163], v8 offset:7168
    v_mfma_f32_16x16x32_bf16 v[84:87], v[132:135], v[124:127], v[84:87]
    ds_read_b64_tr_b16 v[164:165], v11 offset:7168
    ds_read_b64_tr_b16 v[166:167], v11 offset:8960
    v_mfma_f32_16x16x32_bf16 v[100:103], v[132:135], v[128:131], v[100:103]
    ds_read_b64_tr_b16 v[168:169], v11 offset:21504
    ds_read_b64_tr_b16 v[170:171], v11 offset:23296
    v_mfma_f32_16x16x32_bf16 v[56:59], v[136:139], v[116:119], v[56:59]
    ds_read_b64_tr_b16 v[172:173], v11 offset:7200
    ds_read_b64_tr_b16 v[174:175], v11 offset:8992
    v_mfma_f32_16x16x32_bf16 v[72:75], v[136:139], v[120:123], v[72:75]
    ds_read_b64_tr_b16 v[176:177], v11 offset:21536
    ds_read_b64_tr_b16 v[178:179], v11 offset:23328
    v_mfma_f32_16x16x32_bf16 v[88:91], v[136:139], v[124:127], v[88:91]
    v_lshrrev_b32 v15, 4, v1
    s_lshl_b32 s72, s82, 6
    s_add_u32 s72, s72, 155648
    v_lshl_add_u32 v15, v15, 4, s72
    ds_read_b128 v[180:183], v15 offset:0
    ds_read_b128 v[184:187], v15 offset:448
    ds_read_b128 v[188:191], v15 offset:896
    ds_read_b128 v[192:195], v15 offset:1344
    ds_read_b128 v[196:199], v15 offset:64
    ds_read_b128 v[200:203], v15 offset:512
    ds_read_b128 v[204:207], v15 offset:960
    ds_read_b128 v[208:211], v15 offset:1408
    v_mfma_f32_16x16x32_bf16 v[104:107], v[136:139], v[128:131], v[104:107]
    v_mfma_f32_16x16x32_bf16 v[60:63], v[140:143], v[116:119], v[60:63]
    v_mfma_f32_16x16x32_bf16 v[76:79], v[140:143], v[120:123], v[76:79]
    v_mfma_f32_16x16x32_bf16 v[92:95], v[140:143], v[124:127], v[92:95]
    v_mfma_f32_16x16x32_bf16 v[108:111], v[140:143], v[128:131], v[108:111]
    v_mfma_f32_16x16x32_bf16 v[64:67], v[144:147], v[116:119], v[64:67]
    v_mfma_f32_16x16x32_bf16 v[80:83], v[144:147], v[120:123], v[80:83]
    v_mfma_f32_16x16x32_bf16 v[96:99], v[144:147], v[124:127], v[96:99]
    v_mfma_f32_16x16x32_bf16 v[112:115], v[144:147], v[128:131], v[112:115]
    s_waitcnt lgkmcnt(0)
    v_mfma_f32_16x16x32_bf16 v[52:55], v[164:167], v[148:151], v[52:55]
    v_mfma_f32_16x16x32_bf16 v[68:71], v[164:167], v[152:155], v[68:71]
    v_mfma_f32_16x16x32_bf16 v[84:87], v[164:167], v[156:159], v[84:87]
    v_mfma_f32_16x16x32_bf16 v[100:103], v[164:167], v[160:163], v[100:103]
    v_mfma_f32_16x16x32_bf16 v[56:59], v[168:171], v[148:151], v[56:59]
    v_mfma_f32_16x16x32_bf16 v[72:75], v[168:171], v[152:155], v[72:75]
    v_mfma_f32_16x16x32_bf16 v[88:91], v[168:171], v[156:159], v[88:91]
    v_mfma_f32_16x16x32_bf16 v[104:107], v[168:171], v[160:163], v[104:107]
    v_mfma_f32_16x16x32_bf16 v[60:63], v[172:175], v[148:151], v[60:63]
    v_mfma_f32_16x16x32_bf16 v[76:79], v[172:175], v[152:155], v[76:79]
    v_mfma_f32_16x16x32_bf16 v[92:95], v[172:175], v[156:159], v[92:95]
    v_mfma_f32_16x16x32_bf16 v[108:111], v[172:175], v[160:163], v[108:111]
    v_mfma_f32_16x16x32_bf16 v[64:67], v[176:179], v[148:151], v[64:67]
    v_mfma_f32_16x16x32_bf16 v[80:83], v[176:179], v[152:155], v[80:83]
    v_mfma_f32_16x16x32_bf16 v[96:99], v[176:179], v[156:159], v[96:99]
    v_mfma_f32_16x16x32_bf16 v[112:115], v[176:179], v[160:163], v[112:115]
    s_setprio 0
    s_add_u32 s72, s98, s82
    s_lshl_b32 s71, s61, 3
    s_add_u32 s71, s71, s81
    s_mul_i32 s71, s71, 55296
    s_lshl_b32 s72, s72, 9
    s_add_u32 s71, s71, s72
    s_add_u32 s71, s71, 7340032
    v_mov_b32 v46, 0xbfb8aa3b
    v_mov_b32 v47, 0xbfb8aa3b
    v_mov_b32 v48, 1.0
    v_mov_b32 v49, 1.0
    s_barrier
    s_add_u32 s73, s76, 40960
    s_add_u32 m0, s77, 20480
    s_nop 0
    buffer_load_dwordx4 v2, s[8:11], s73 offen offset:0 sc1 lds
    buffer_load_dwordx4 v2, s[8:11], s73 offen offset:1024 sc1 lds
    buffer_load_dwordx4 v2, s[8:11], s73 offen offset:2048 sc1 lds
    buffer_load_dwordx4 v2, s[8:11], s73 offen offset:3072 sc1 lds
    s_add_u32 s73, s73, 4096
    s_add_u32 m0, s77, 24576
    s_nop 0
    buffer_load_dwordx4 v2, s[8:11], s73 offen sc1 lds
    v_pk_fma_f32 v[32:33], v[18:19], v[180:181], v[184:185]
    v_pk_fma_f32 v[36:37], v[18:19], v[188:189], v[192:193]
    v_pk_fma_f32 v[34:35], v[18:19], v[182:183], v[186:187]
    v_pk_fma_f32 v[38:39], v[18:19], v[190:191], v[194:195]
    v_pk_fma_f32 v[32:33], v[52:53], v[16:17], v[32:33]
    v_pk_fma_f32 v[36:37], v[56:57], v[16:17], v[36:37]
    v_pk_fma_f32 v[34:35], v[54:55], v[16:17], v[34:35]
    v_pk_fma_f32 v[38:39], v[58:59], v[16:17], v[38:39]
    v_pk_mul_f32 v[40:41], v[32:33], v[46:47]
    v_pk_mul_f32 v[42:43], v[34:35], v[46:47]
    v_exp_f32 v40, v40
    v_exp_f32 v41, v41
    v_exp_f32 v42, v42
    v_exp_f32 v43, v43
    v_pk_mul_f32 v[32:33], v[32:33], v[36:37]
    v_pk_mul_f32 v[34:35], v[34:35], v[38:39]
    v_pk_add_f32 v[40:41], v[40:41], v[48:49]
    v_pk_add_f32 v[42:43], v[42:43], v[48:49]
    v_rcp_f32 v40, v40
    v_rcp_f32 v41, v41
    v_rcp_f32 v42, v42
    v_rcp_f32 v43, v43
    s_nop 0
    v_pk_mul_f32 v[32:33], v[32:33], v[40:41]
    v_pk_mul_f32 v[34:35], v[34:35], v[42:43]
    v_cvt_pk_bf16_f32 v116, v32, v33
    v_cvt_pk_bf16_f32 v117, v34, v35
    v_pk_fma_f32 v[32:33], v[18:19], v[196:197], v[200:201]
    v_pk_fma_f32 v[36:37], v[18:19], v[204:205], v[208:209]
    v_pk_fma_f32 v[34:35], v[18:19], v[198:199], v[202:203]
    v_pk_fma_f32 v[38:39], v[18:19], v[206:207], v[210:211]
    v_pk_fma_f32 v[32:33], v[60:61], v[16:17], v[32:33]
    v_pk_fma_f32 v[36:37], v[64:65], v[16:17], v[36:37]
    v_pk_fma_f32 v[34:35], v[62:63], v[16:17], v[34:35]
    v_pk_fma_f32 v[38:39], v[66:67], v[16:17], v[38:39]
    v_pk_mul_f32 v[40:41], v[32:33], v[46:47]
    v_pk_mul_f32 v[42:43], v[34:35], v[46:47]
    v_exp_f32 v40, v40
    v_exp_f32 v41, v41
    v_exp_f32 v42, v42
    v_exp_f32 v43, v43
    v_pk_mul_f32 v[32:33], v[32:33], v[36:37]
    v_pk_mul_f32 v[34:35], v[34:35], v[38:39]
    v_pk_add_f32 v[40:41], v[40:41], v[48:49]
    v_pk_add_f32 v[42:43], v[42:43], v[48:49]
    v_rcp_f32 v40, v40
    v_rcp_f32 v41, v41
    v_rcp_f32 v42, v42
    v_rcp_f32 v43, v43
    s_nop 0
    v_pk_mul_f32 v[32:33], v[32:33], v[40:41]
    v_pk_mul_f32 v[34:35], v[34:35], v[42:43]
    v_cvt_pk_bf16_f32 v118, v32, v33
    v_cvt_pk_bf16_f32 v119, v34, v35
    s_nop 0
    v_permlane32_swap_b32 v116, v118
    v_permlane32_swap_b32 v117, v119
    buffer_store_dwordx4 v[116:119], v2, s[8:11], s71 offen offset:0 sc1
    s_add_u32 s71, s71, 55296
    v_pk_fma_f32 v[32:33], v[22:23], v[180:181], v[184:185]
    v_pk_fma_f32 v[36:37], v[22:23], v[188:189], v[192:193]
    v_pk_fma_f32 v[34:35], v[22:23], v[182:183], v[186:187]
    v_pk_fma_f32 v[38:39], v[22:23], v[190:191], v[194:195]
    v_pk_fma_f32 v[32:33], v[68:69], v[20:21], v[32:33]
    v_pk_fma_f32 v[36:37], v[72:73], v[20:21], v[36:37]
    v_pk_fma_f32 v[34:35], v[70:71], v[20:21], v[34:35]
    v_pk_fma_f32 v[38:39], v[74:75], v[20:21], v[38:39]
    v_pk_mul_f32 v[40:41], v[32:33], v[46:47]
    v_pk_mul_f32 v[42:43], v[34:35], v[46:47]
    v_exp_f32 v40, v40
    v_exp_f32 v41, v41
    v_exp_f32 v42, v42
    v_exp_f32 v43, v43
    v_pk_mul_f32 v[32:33], v[32:33], v[36:37]
    v_pk_mul_f32 v[34:35], v[34:35], v[38:39]
    v_pk_add_f32 v[40:41], v[40:41], v[48:49]
    v_pk_add_f32 v[42:43], v[42:43], v[48:49]
    v_rcp_f32 v40, v40
    v_rcp_f32 v41, v41
    v_rcp_f32 v42, v42
    v_rcp_f32 v43, v43
    s_nop 0
    v_pk_mul_f32 v[32:33], v[32:33], v[40:41]
    v_pk_mul_f32 v[34:35], v[34:35], v[42:43]
    v_cvt_pk_bf16_f32 v124, v32, v33
    v_cvt_pk_bf16_f32 v125, v34, v35
    v_pk_fma_f32 v[32:33], v[22:23], v[196:197], v[200:201]
    v_pk_fma_f32 v[36:37], v[22:23], v[204:205], v[208:209]
    v_pk_fma_f32 v[34:35], v[22:23], v[198:199], v[202:203]
    v_pk_fma_f32 v[38:39], v[22:23], v[206:207], v[210:211]
    v_pk_fma_f32 v[32:33], v[76:77], v[20:21], v[32:33]
    v_pk_fma_f32 v[36:37], v[80:81], v[20:21], v[36:37]
    v_pk_fma_f32 v[34:35], v[78:79], v[20:21], v[34:35]
    v_pk_fma_f32 v[38:39], v[82:83], v[20:21], v[38:39]
    v_pk_mul_f32 v[40:41], v[32:33], v[46:47]
    v_pk_mul_f32 v[42:43], v[34:35], v[46:47]
    v_exp_f32 v40, v40
    v_exp_f32 v41, v41
    v_exp_f32 v42, v42
    v_exp_f32 v43, v43
    v_pk_mul_f32 v[32:33], v[32:33], v[36:37]
    v_pk_mul_f32 v[34:35], v[34:35], v[38:39]
    v_pk_add_f32 v[40:41], v[40:41], v[48:49]
    v_pk_add_f32 v[42:43], v[42:43], v[48:49]
    v_rcp_f32 v40, v40
    v_rcp_f32 v41, v41
    v_rcp_f32 v42, v42
    v_rcp_f32 v43, v43
    s_nop 0
    v_pk_mul_f32 v[32:33], v[32:33], v[40:41]
    v_pk_mul_f32 v[34:35], v[34:35], v[42:43]
    v_cvt_pk_bf16_f32 v126, v32, v33
    v_cvt_pk_bf16_f32 v127, v34, v35
    s_nop 0
    v_permlane32_swap_b32 v124, v126
    v_permlane32_swap_b32 v125, v127
    buffer_store_dwordx4 v[124:127], v2, s[8:11], s71 offen offset:0 sc1
    s_add_u32 s71, s71, 55296
    v_pk_fma_f32 v[32:33], v[26:27], v[180:181], v[184:185]
    v_pk_fma_f32 v[36:37], v[26:27], v[188:189], v[192:193]
    v_pk_fma_f32 v[34:35], v[26:27], v[182:183], v[186:187]
    v_pk_fma_f32 v[38:39], v[26:27], v[190:191], v[194:195]
    v_pk_fma_f32 v[32:33], v[84:85], v[24:25], v[32:33]
    v_pk_fma_f32 v[36:37], v[88:89], v[24:25], v[36:37]
    v_pk_fma_f32 v[34:35], v[86:87], v[24:25], v[34:35]
    v_pk_fma_f32 v[38:39], v[90:91], v[24:25], v[38:39]
    v_pk_mul_f32 v[40:41], v[32:33], v[46:47]
    v_pk_mul_f32 v[42:43], v[34:35], v[46:47]
    v_exp_f32 v40, v40
    v_exp_f32 v41, v41
    v_exp_f32 v42, v42
    v_exp_f32 v43, v43
    v_pk_mul_f32 v[32:33], v[32:33], v[36:37]
    v_pk_mul_f32 v[34:35], v[34:35], v[38:39]
    v_pk_add_f32 v[40:41], v[40:41], v[48:49]
    v_pk_add_f32 v[42:43], v[42:43], v[48:49]
    v_rcp_f32 v40, v40
    v_rcp_f32 v41, v41
    v_rcp_f32 v42, v42
    v_rcp_f32 v43, v43
    s_nop 0
    v_pk_mul_f32 v[32:33], v[32:33], v[40:41]
    v_pk_mul_f32 v[34:35], v[34:35], v[42:43]
    v_cvt_pk_bf16_f32 v116, v32, v33
    v_cvt_pk_bf16_f32 v117, v34, v35
    v_pk_fma_f32 v[32:33], v[26:27], v[196:197], v[200:201]
    v_pk_fma_f32 v[36:37], v[26:27], v[204:205], v[208:209]
    v_pk_fma_f32 v[34:35], v[26:27], v[198:199], v[202:203]
    v_pk_fma_f32 v[38:39], v[26:27], v[206:207], v[210:211]
    v_pk_fma_f32 v[32:33], v[92:93], v[24:25], v[32:33]
    v_pk_fma_f32 v[36:37], v[96:97], v[24:25], v[36:37]
    v_pk_fma_f32 v[34:35], v[94:95], v[24:25], v[34:35]
    v_pk_fma_f32 v[38:39], v[98:99], v[24:25], v[38:39]
    v_pk_mul_f32 v[40:41], v[32:33], v[46:47]
    v_pk_mul_f32 v[42:43], v[34:35], v[46:47]
    v_exp_f32 v40, v40
    v_exp_f32 v41, v41
    v_exp_f32 v42, v42
    v_exp_f32 v43, v43
    v_pk_mul_f32 v[32:33], v[32:33], v[36:37]
    v_pk_mul_f32 v[34:35], v[34:35], v[38:39]
    v_pk_add_f32 v[40:41], v[40:41], v[48:49]
    v_pk_add_f32 v[42:43], v[42:43], v[48:49]
    v_rcp_f32 v40, v40
    v_rcp_f32 v41, v41
    v_rcp_f32 v42, v42
    v_rcp_f32 v43, v43
    s_nop 0
    v_pk_mul_f32 v[32:33], v[32:33], v[40:41]
    v_pk_mul_f32 v[34:35], v[34:35], v[42:43]
    v_cvt_pk_bf16_f32 v118, v32, v33
    v_cvt_pk_bf16_f32 v119, v34, v35
    s_nop 0
    v_permlane32_swap_b32 v116, v118
    v_permlane32_swap_b32 v117, v119
    buffer_store_dwordx4 v[116:119], v2, s[8:11], s71 offen offset:0 sc1
    s_add_u32 s71, s71, 55296
    v_pk_fma_f32 v[32:33], v[30:31], v[180:181], v[184:185]
    v_pk_fma_f32 v[36:37], v[30:31], v[188:189], v[192:193]
    v_pk_fma_f32 v[34:35], v[30:31], v[182:183], v[186:187]
    v_pk_fma_f32 v[38:39], v[30:31], v[190:191], v[194:195]
    v_pk_fma_f32 v[32:33], v[100:101], v[28:29], v[32:33]
    v_pk_fma_f32 v[36:37], v[104:105], v[28:29], v[36:37]
    v_pk_fma_f32 v[34:35], v[102:103], v[28:29], v[34:35]
    v_pk_fma_f32 v[38:39], v[106:107], v[28:29], v[38:39]
    v_pk_mul_f32 v[40:41], v[32:33], v[46:47]
    v_pk_mul_f32 v[42:43], v[34:35], v[46:47]
    v_exp_f32 v40, v40
    v_exp_f32 v41, v41
    v_exp_f32 v42, v42
    v_exp_f32 v43, v43
    v_pk_mul_f32 v[32:33], v[32:33], v[36:37]
    v_pk_mul_f32 v[34:35], v[34:35], v[38:39]
    v_pk_add_f32 v[40:41], v[40:41], v[48:49]
    v_pk_add_f32 v[42:43], v[42:43], v[48:49]
    v_rcp_f32 v40, v40
    v_rcp_f32 v41, v41
    v_rcp_f32 v42, v42
    v_rcp_f32 v43, v43
    s_nop 0
    v_pk_mul_f32 v[32:33], v[32:33], v[40:41]
    v_pk_mul_f32 v[34:35], v[34:35], v[42:43]
    v_cvt_pk_bf16_f32 v124, v32, v33
    v_cvt_pk_bf16_f32 v125, v34, v35
    v_pk_fma_f32 v[32:33], v[30:31], v[196:197], v[200:201]
    v_pk_fma_f32 v[36:37], v[30:31], v[204:205], v[208:209]
    v_pk_fma_f32 v[34:35], v[30:31], v[198:199], v[202:203]
    v_pk_fma_f32 v[38:39], v[30:31], v[206:207], v[210:211]
    v_pk_fma_f32 v[32:33], v[108:109], v[28:29], v[32:33]
    v_pk_fma_f32 v[36:37], v[112:113], v[28:29], v[36:37]
    v_pk_fma_f32 v[34:35], v[110:111], v[28:29], v[34:35]
    v_pk_fma_f32 v[38:39], v[114:115], v[28:29], v[38:39]
    v_pk_mul_f32 v[40:41], v[32:33], v[46:47]
    v_pk_mul_f32 v[42:43], v[34:35], v[46:47]
    v_exp_f32 v40, v40
    v_exp_f32 v41, v41
    v_exp_f32 v42, v42
    v_exp_f32 v43, v43
    v_pk_mul_f32 v[32:33], v[32:33], v[36:37]
    v_pk_mul_f32 v[34:35], v[34:35], v[38:39]
    v_pk_add_f32 v[40:41], v[40:41], v[48:49]
    v_pk_add_f32 v[42:43], v[42:43], v[48:49]
    v_rcp_f32 v40, v40
    v_rcp_f32 v41, v41
    v_rcp_f32 v42, v42
    v_rcp_f32 v43, v43
    s_nop 0
    v_pk_mul_f32 v[32:33], v[32:33], v[40:41]
    v_pk_mul_f32 v[34:35], v[34:35], v[42:43]
    v_cvt_pk_bf16_f32 v126, v32, v33
    v_cvt_pk_bf16_f32 v127, v34, v35
    s_nop 0
    v_permlane32_swap_b32 v124, v126
    v_permlane32_swap_b32 v125, v127
    buffer_store_dwordx4 v[124:127], v2, s[8:11], s71 offen offset:0 sc1
    s_lshl_b32 s70, s60, 2
    s_add_u32 s70, s70, 28672
    v_mov_b32 v255, s66
    s_waitcnt vmcnt(0)
    s_barrier
    s_cmp_lg_u32 s65, 0
    s_cbranch_scc1 Lwf_123
    s_mov_b64 exec, 1
    buffer_store_dword v255, v1, s[8:11], s70 offen sc1
    s_mov_b64 exec, -1
Lwf_123:
    s_branch Lp4e_122
Lp4b_121:
    s_lshl_b32 s81, s69, 1
    s_mov_b32 s82, 4
    s_lshl_b32 s71, s81, 11
    s_add_u32 s71, s71, 49152
    v_add_u32 v8, s71, v2
    v_lshrrev_b32 v14, 5, v1
    v_bfe_u32 v15, v1, 4, 1
    v_lshlrev_b32 v14, 4, v14
    v_lshl_add_u32 v14, v15, 2, v14
    v_bfe_u32 v15, v1, 2, 2
    v_add_u32 v14, v14, v15
    v_mul_u32_u24 v14, 224, v14
    v_and_b32 v15, 3, v1
    v_lshl_add_u32 v14, v15, 3, v14
    s_lshl_b32 s71, s82, 5
    s_add_u32 s71, s71, 20480
    v_add_u32 v11, s71, v14
    v_add_u32 v9, 45056, v8
    v_add_u32 v12, 45056, v11
    v_add_u32 v10, 90112, v8
    v_add_u32 v13, 90112, v11
    v_mov_b32 v52, 0
    v_mov_b32 v53, 0
    v_mov_b32 v54, 0
    v_mov_b32 v55, 0
    v_mov_b32 v56, 0
    v_mov_b32 v57, 0
    v_mov_b32 v58, 0
    v_mov_b32 v59, 0
    v_mov_b32 v60, 0
    v_mov_b32 v61, 0
    v_mov_b32 v62, 0
    v_mov_b32 v63, 0
    v_mov_b32 v64, 0
    v_mov_b32 v65, 0
    v_mov_b32 v66, 0
    v_mov_b32 v67, 0
    v_mov_b32 v68, 0
    v_mov_b32 v69, 0
    v_mov_b32 v70, 0
    v_mov_b32 v71, 0
    v_mov_b32 v72, 0
    v_mov_b32 v73, 0
    v_mov_b32 v74, 0
    v_mov_b32 v75, 0
    v_mov_b32 v76, 0
    v_mov_b32 v77, 0
    v_mov_b32 v78, 0
    v_mov_b32 v79, 0
    v_mov_b32 v80, 0
    v_mov_b32 v81, 0
    v_mov_b32 v82, 0
    v_mov_b32 v83, 0
    v_mov_b32 v84, 0
    v_mov_b32 v85, 0
    v_mov_b32 v86, 0
    v_mov_b32 v87, 0
    v_mov_b32 v88, 0
    v_mov_b32 v89, 0
    v_mov_b32 v90, 0
    v_mov_b32 v91, 0
    v_mov_b32 v92, 0
    v_mov_b32 v93, 0
    v_mov_b32 v94, 0
    v_mov_b32 v95, 0
    v_mov_b32 v96, 0
    v_mov_b32 v97, 0
    v_mov_b32 v98, 0
    v_mov_b32 v99, 0
    s_cmp_eq_u32 s65, 7
    s_cselect_b64 vcc, -1, 0
    s_cbranch_vccnz Lv_124
    s_waitcnt vmcnt(8)
    s_branch Lv_125
Lv_124:
    s_waitcnt vmcnt(4)
Lv_125:
    s_barrier
    s_mul_i32 s76, s97, 27
    s_add_u32 s76, s76, s69
    s_mul_i32 s76, s76, 5120
    s_mul_i32 s74, s64, 278528
    s_add_u32 s76, s76, s74
    s_add_u32 s76, s76, 17596416
    s_mul_i32 s77, s65, 5120
    ds_read_b128 v[116:119], v8 offset:0
    ds_read_b128 v[120:123], v8 offset:2048
    ds_read_b64_tr_b16 v[124:125], v11 offset:0
    ds_read_b64_tr_b16 v[126:127], v11 offset:1792
    ds_read_b64_tr_b16 v[128:129], v11 offset:14336
    ds_read_b64_tr_b16 v[130:131], v11 offset:16128
    ds_read_b64_tr_b16 v[132:133], v11 offset:32
    ds_read_b64_tr_b16 v[134:135], v11 offset:1824
    ds_read_b64_tr_b16 v[136:137], v11 offset:14368
    ds_read_b64_tr_b16 v[138:139], v11 offset:16160
    ds_read_b64_tr_b16 v[140:141], v11 offset:64
    ds_read_b64_tr_b16 v[142:143], v11 offset:1856
    ds_read_b64_tr_b16 v[144:145], v11 offset:14400
    ds_read_b64_tr_b16 v[146:147], v11 offset:16192
    s_setprio 1
    s_waitcnt lgkmcnt(0)
    v_mfma_f32_16x16x32_bf16 v[52:55], v[124:127], v[116:119], v[52:55]
    ds_read_b128 v[148:151], v8 offset:1024
    ds_read_b128 v[152:155], v8 offset:3072
    v_mfma_f32_16x16x32_bf16 v[76:79], v[124:127], v[120:123], v[76:79]
    ds_read_b64_tr_b16 v[156:157], v11 offset:7168
    ds_read_b64_tr_b16 v[158:159], v11 offset:8960
    v_mfma_f32_16x16x32_bf16 v[56:59], v[128:131], v[116:119], v[56:59]
    ds_read_b64_tr_b16 v[160:161], v11 offset:21504
    ds_read_b64_tr_b16 v[162:163], v11 offset:23296
    v_mfma_f32_16x16x32_bf16 v[80:83], v[128:131], v[120:123], v[80:83]
    ds_read_b64_tr_b16 v[164:165], v11 offset:7200
    ds_read_b64_tr_b16 v[166:167], v11 offset:8992
    v_mfma_f32_16x16x32_bf16 v[60:63], v[132:135], v[116:119], v[60:63]
    ds_read_b64_tr_b16 v[168:169], v11 offset:21536
    ds_read_b64_tr_b16 v[170:171], v11 offset:23328
    v_mfma_f32_16x16x32_bf16 v[84:87], v[132:135], v[120:123], v[84:87]
    ds_read_b64_tr_b16 v[172:173], v11 offset:7232
    ds_read_b64_tr_b16 v[174:175], v11 offset:9024
    v_mfma_f32_16x16x32_bf16 v[64:67], v[136:139], v[116:119], v[64:67]
    ds_read_b64_tr_b16 v[176:177], v11 offset:21568
    ds_read_b64_tr_b16 v[178:179], v11 offset:23360
    v_mfma_f32_16x16x32_bf16 v[88:91], v[136:139], v[120:123], v[88:91]
    v_mfma_f32_16x16x32_bf16 v[68:71], v[140:143], v[116:119], v[68:71]
    v_mfma_f32_16x16x32_bf16 v[92:95], v[140:143], v[120:123], v[92:95]
    v_mfma_f32_16x16x32_bf16 v[72:75], v[144:147], v[116:119], v[72:75]
    v_mfma_f32_16x16x32_bf16 v[96:99], v[144:147], v[120:123], v[96:99]
    s_cbranch_vccnz Lv_126
    s_waitcnt vmcnt(6) lgkmcnt(0)
    s_branch Lv_127
Lv_126:
    s_waitcnt vmcnt(2) lgkmcnt(0)
Lv_127:
    s_barrier
    v_mfma_f32_16x16x32_bf16 v[52:55], v[156:159], v[148:151], v[52:55]
    ds_read_b128 v[116:119], v9 offset:0
    ds_read_b128 v[120:123], v9 offset:2048
    v_mfma_f32_16x16x32_bf16 v[76:79], v[156:159], v[152:155], v[76:79]
    ds_read_b64_tr_b16 v[124:125], v12 offset:0
    ds_read_b64_tr_b16 v[126:127], v12 offset:1792
    v_mfma_f32_16x16x32_bf16 v[56:59], v[160:163], v[148:151], v[56:59]
    ds_read_b64_tr_b16 v[128:129], v12 offset:14336
    ds_read_b64_tr_b16 v[130:131], v12 offset:16128
    v_mfma_f32_16x16x32_bf16 v[80:83], v[160:163], v[152:155], v[80:83]
    ds_read_b64_tr_b16 v[132:133], v12 offset:32
    ds_read_b64_tr_b16 v[134:135], v12 offset:1824
    v_mfma_f32_16x16x32_bf16 v[60:63], v[164:167], v[148:151], v[60:63]
    ds_read_b64_tr_b16 v[136:137], v12 offset:14368
    ds_read_b64_tr_b16 v[138:139], v12 offset:16160
    v_mfma_f32_16x16x32_bf16 v[84:87], v[164:167], v[152:155], v[84:87]
    ds_read_b64_tr_b16 v[140:141], v12 offset:64
    ds_read_b64_tr_b16 v[142:143], v12 offset:1856
    v_mfma_f32_16x16x32_bf16 v[64:67], v[168:171], v[148:151], v[64:67]
    ds_read_b64_tr_b16 v[144:145], v12 offset:14400
    ds_read_b64_tr_b16 v[146:147], v12 offset:16192
    v_mfma_f32_16x16x32_bf16 v[88:91], v[168:171], v[152:155], v[88:91]
    s_cbranch_vccnz Lw7_128
    s_add_u32 m0, s85, 0
    s_nop 0
    buffer_load_dwordx4 v2, s[8:11], s84 offen sc1 lds
Lw7_128:
    v_mfma_f32_16x16x32_bf16 v[68:71], v[172:175], v[148:151], v[68:71]
    s_cbranch_vccnz Lw7_129
    buffer_load_dwordx4 v2, s[8:11], s84 offen offset:1024 sc1 lds
Lw7_129:
    v_mfma_f32_16x16x32_bf16 v[92:95], v[172:175], v[152:155], v[92:95]
    s_cbranch_vccnz Lw7_130
    s_add_u32 m0, s85, 14336
    s_add_u32 s75, s84, 143360
    buffer_load_dwordx4 v2, s[8:11], s75 offen sc1 lds
Lw7_130:
    v_mfma_f32_16x16x32_bf16 v[72:75], v[176:179], v[148:151], v[72:75]
    s_cbranch_vccnz Lw7_131
    buffer_load_dwordx4 v2, s[8:11], s75 offen offset:1024 sc1 lds
    s_add_u32 s84, s84, 14336
Lw7_131:
    v_mfma_f32_16x16x32_bf16 v[96:99], v[176:179], v[152:155], v[96:99]
    s_waitcnt lgkmcnt(0)
    v_mfma_f32_16x16x32_bf16 v[52:55], v[124:127], v[116:119], v[52:55]
    ds_read_b128 v[148:151], v9 offset:1024
    ds_read_b128 v[152:155], v9 offset:3072
    v_mfma_f32_16x16x32_bf16 v[76:79], v[124:127], v[120:123], v[76:79]
    ds_read_b64_tr_b16 v[156:157], v12 offset:7168
    ds_read_b64_tr_b16 v[158:159], v12 offset:8960
    v_mfma_f32_16x16x32_bf16 v[56:59], v[128:131], v[116:119], v[56:59]
    ds_read_b64_tr_b16 v[160:161], v12 offset:21504
    ds_read_b64_tr_b16 v[162:163], v12 offset:23296
    v_mfma_f32_16x16x32_bf16 v[80:83], v[128:131], v[120:123], v[80:83]
    ds_read_b64_tr_b16 v[164:165], v12 offset:7200
    ds_read_b64_tr_b16 v[166:167], v12 offset:8992
    v_mfma_f32_16x16x32_bf16 v[60:63], v[132:135], v[116:119], v[60:63]
    ds_read_b64_tr_b16 v[168:169], v12 offset:21536
    ds_read_b64_tr_b16 v[170:171], v12 offset:23328
    v_mfma_f32_16x16x32_bf16 v[84:87], v[132:135], v[120:123], v[84:87]
    ds_read_b64_tr_b16 v[172:173], v12 offset:7232
    ds_read_b64_tr_b16 v[174:175], v12 offset:9024
    v_mfma_f32_16x16x32_bf16 v[64:67], v[136:139], v[116:119], v[64:67]
    ds_read_b64_tr_b16 v[176:177], v12 offset:21568
    ds_read_b64_tr_b16 v[178:179], v12 offset:23360
    v_mfma_f32_16x16x32_bf16 v[88:91], v[136:139], v[120:123], v[88:91]
    s_add_u32 m0, s87, 0
    s_nop 0
    buffer_load_dwordx4 v2, s[8:11], s86 offen sc1 lds
    v_mfma_f32_16x16x32_bf16 v[68:71], v[140:143], v[116:119], v[68:71]
    v_mfma_f32_16x16x32_bf16 v[92:95], v[140:143], v[120:123], v[92:95]
    buffer_load_dwordx4 v2, s[8:11], s86 offen offset:1024 sc1 lds
    s_add_u32 s86, s86, 2048
    v_mfma_f32_16x16x32_bf16 v[72:75], v[144:147], v[116:119], v[72:75]
    v_mfma_f32_16x16x32_bf16 v[96:99], v[144:147], v[120:123], v[96:99]
    s_cbranch_vccnz Lv_132
    s_waitcnt vmcnt(6) lgkmcnt(0)
    s_branch Lv_133
Lv_132:
    s_waitcnt vmcnt(2) lgkmcnt(0)
Lv_133:
    s_barrier
    v_mfma_f32_16x16x32_bf16 v[52:55], v[156:159], v[148:151], v[52:55]
    ds_read_b128 v[116:119], v10 offset:0
    ds_read_b128 v[120:123], v10 offset:2048
    v_mfma_f32_16x16x32_bf16 v[76:79], v[156:159], v[152:155], v[76:79]
    ds_read_b64_tr_b16 v[124:125], v13 offset:0
    ds_read_b64_tr_b16 v[126:127], v13 offset:1792
    v_mfma_f32_16x16x32_bf16 v[56:59], v[160:163], v[148:151], v[56:59]
    ds_read_b64_tr_b16 v[128:129], v13 offset:14336
    ds_read_b64_tr_b16 v[130:131], v13 offset:16128
    v_mfma_f32_16x16x32_bf16 v[80:83], v[160:163], v[152:155], v[80:83]
    ds_read_b64_tr_b16 v[132:133], v13 offset:32
    ds_read_b64_tr_b16 v[134:135], v13 offset:1824
    v_mfma_f32_16x16x32_bf16 v[60:63], v[164:167], v[148:151], v[60:63]
    ds_read_b64_tr_b16 v[136:137], v13 offset:14368
    ds_read_b64_tr_b16 v[138:139], v13 offset:16160
    v_mfma_f32_16x16x32_bf16 v[84:87], v[164:167], v[152:155], v[84:87]
    ds_read_b64_tr_b16 v[140:141], v13 offset:64
    ds_read_b64_tr_b16 v[142:143], v13 offset:1856
    v_mfma_f32_16x16x32_bf16 v[64:67], v[168:171], v[148:151], v[64:67]
    ds_read_b64_tr_b16 v[144:145], v13 offset:14400
    ds_read_b64_tr_b16 v[146:147], v13 offset:16192
    v_mfma_f32_16x16x32_bf16 v[88:91], v[168:171], v[152:155], v[88:91]
    s_cbranch_vccnz Lw7_134
    s_add_u32 m0, s85, 45056
    s_nop 0
    buffer_load_dwordx4 v2, s[8:11], s84 offen sc1 lds
Lw7_134:
    v_mfma_f32_16x16x32_bf16 v[68:71], v[172:175], v[148:151], v[68:71]
    s_cbranch_vccnz Lw7_135
    buffer_load_dwordx4 v2, s[8:11], s84 offen offset:1024 sc1 lds
Lw7_135:
    v_mfma_f32_16x16x32_bf16 v[92:95], v[172:175], v[152:155], v[92:95]
    s_cbranch_vccnz Lw7_136
    s_add_u32 m0, s85, 59392
    s_add_u32 s75, s84, 143360
    buffer_load_dwordx4 v2, s[8:11], s75 offen sc1 lds
Lw7_136:
    v_mfma_f32_16x16x32_bf16 v[72:75], v[176:179], v[148:151], v[72:75]
    s_cbranch_vccnz Lw7_137
    buffer_load_dwordx4 v2, s[8:11], s75 offen offset:1024 sc1 lds
    s_add_u32 s84, s84, 14336
Lw7_137:
    v_mfma_f32_16x16x32_bf16 v[96:99], v[176:179], v[152:155], v[96:99]
    s_waitcnt lgkmcnt(0)
    v_mfma_f32_16x16x32_bf16 v[52:55], v[124:127], v[116:119], v[52:55]
    ds_read_b128 v[148:151], v10 offset:1024
    ds_read_b128 v[152:155], v10 offset:3072
    v_mfma_f32_16x16x32_bf16 v[76:79], v[124:127], v[120:123], v[76:79]
    ds_read_b64_tr_b16 v[156:157], v13 offset:7168
    ds_read_b64_tr_b16 v[158:159], v13 offset:8960
    v_mfma_f32_16x16x32_bf16 v[56:59], v[128:131], v[116:119], v[56:59]
    ds_read_b64_tr_b16 v[160:161], v13 offset:21504
    ds_read_b64_tr_b16 v[162:163], v13 offset:23296
    v_mfma_f32_16x16x32_bf16 v[80:83], v[128:131], v[120:123], v[80:83]
    ds_read_b64_tr_b16 v[164:165], v13 offset:7200
    ds_read_b64_tr_b16 v[166:167], v13 offset:8992
    v_mfma_f32_16x16x32_bf16 v[60:63], v[132:135], v[116:119], v[60:63]
    ds_read_b64_tr_b16 v[168:169], v13 offset:21536
    ds_read_b64_tr_b16 v[170:171], v13 offset:23328
    v_mfma_f32_16x16x32_bf16 v[84:87], v[132:135], v[120:123], v[84:87]
    ds_read_b64_tr_b16 v[172:173], v13 offset:7232
    ds_read_b64_tr_b16 v[174:175], v13 offset:9024
    v_mfma_f32_16x16x32_bf16 v[64:67], v[136:139], v[116:119], v[64:67]
    ds_read_b64_tr_b16 v[176:177], v13 offset:21568
    ds_read_b64_tr_b16 v[178:179], v13 offset:23360
    v_mfma_f32_16x16x32_bf16 v[88:91], v[136:139], v[120:123], v[88:91]
    s_add_u32 m0, s87, 45056
    s_nop 0
    buffer_load_dwordx4 v2, s[8:11], s86 offen sc1 lds
    buffer_load_dwordx4 v2, s[8:11], s86 offen offset:1024 sc1 lds
    s_add_u32 s86, s86, 2048
    v_mfma_f32_16x16x32_bf16 v[68:71], v[140:143], v[116:119], v[68:71]
    buffer_load_dwordx2 v[16:17], v35, s[8:11], s83 offen offset:0 sc1
    v_mfma_f32_16x16x32_bf16 v[92:95], v[140:143], v[120:123], v[92:95]
    buffer_load_dwordx2 v[18:19], v35, s[8:11], s83 offen offset:512 sc1
    buffer_load_dwordx2 v[20:21], v35, s[8:11], s83 offen offset:1024 sc1
    v_mfma_f32_16x16x32_bf16 v[72:75], v[144:147], v[116:119], v[72:75]
    buffer_load_dwordx2 v[22:23], v35, s[8:11], s83 offen offset:1536 sc1
    v_mfma_f32_16x16x32_bf16 v[96:99], v[144:147], v[120:123], v[96:99]
    s_cbranch_vccnz Lv_138
    s_waitcnt vmcnt(10) lgkmcnt(0)
    s_branch Lv_139
Lv_138:
    s_waitcnt vmcnt(6) lgkmcnt(0)
Lv_139:
    s_barrier
    v_mfma_f32_16x16x32_bf16 v[52:55], v[156:159], v[148:151], v[52:55]
    ds_read_b128 v[116:119], v8 offset:0
    ds_read_b128 v[120:123], v8 offset:2048
    v_mfma_f32_16x16x32_bf16 v[76:79], v[156:159], v[152:155], v[76:79]
    ds_read_b64_tr_b16 v[124:125], v11 offset:0
    ds_read_b64_tr_b16 v[126:127], v11 offset:1792
    v_mfma_f32_16x16x32_bf16 v[56:59], v[160:163], v[148:151], v[56:59]
    ds_read_b64_tr_b16 v[128:129], v11 offset:14336
    ds_read_b64_tr_b16 v[130:131], v11 offset:16128
    v_mfma_f32_16x16x32_bf16 v[80:83], v[160:163], v[152:155], v[80:83]
    ds_read_b64_tr_b16 v[132:133], v11 offset:32
    ds_read_b64_tr_b16 v[134:135], v11 offset:1824
    v_mfma_f32_16x16x32_bf16 v[60:63], v[164:167], v[148:151], v[60:63]
    ds_read_b64_tr_b16 v[136:137], v11 offset:14368
    ds_read_b64_tr_b16 v[138:139], v11 offset:16160
    v_mfma_f32_16x16x32_bf16 v[84:87], v[164:167], v[152:155], v[84:87]
    ds_read_b64_tr_b16 v[140:141], v11 offset:64
    ds_read_b64_tr_b16 v[142:143], v11 offset:1856
    v_mfma_f32_16x16x32_bf16 v[64:67], v[168:171], v[148:151], v[64:67]
    ds_read_b64_tr_b16 v[144:145], v11 offset:14400
    ds_read_b64_tr_b16 v[146:147], v11 offset:16192
    v_mfma_f32_16x16x32_bf16 v[88:91], v[168:171], v[152:155], v[88:91]
    s_cbranch_vccnz Lw7_140
    s_add_u32 m0, s85, 90112
    s_nop 0
    buffer_load_dwordx4 v2, s[8:11], s84 offen sc1 lds
Lw7_140:
    v_mfma_f32_16x16x32_bf16 v[68:71], v[172:175], v[148:151], v[68:71]
    s_cbranch_vccnz Lw7_141
    buffer_load_dwordx4 v2, s[8:11], s84 offen offset:1024 sc1 lds
Lw7_141:
    v_mfma_f32_16x16x32_bf16 v[92:95], v[172:175], v[152:155], v[92:95]
    s_cbranch_vccnz Lw7_142
    s_add_u32 m0, s85, 104448
    s_add_u32 s75, s84, 143360
    buffer_load_dwordx4 v2, s[8:11], s75 offen sc1 lds
Lw7_142:
    v_mfma_f32_16x16x32_bf16 v[72:75], v[176:179], v[148:151], v[72:75]
    s_cbranch_vccnz Lw7_143
    buffer_load_dwordx4 v2, s[8:11], s75 offen offset:1024 sc1 lds
    s_add_u32 s84, s84, 14336
Lw7_143:
    v_mfma_f32_16x16x32_bf16 v[96:99], v[176:179], v[152:155], v[96:99]
    s_waitcnt lgkmcnt(0)
    v_mfma_f32_16x16x32_bf16 v[52:55], v[124:127], v[116:119], v[52:55]
    ds_read_b128 v[148:151], v8 offset:1024
    ds_read_b128 v[152:155], v8 offset:3072
    v_mfma_f32_16x16x32_bf16 v[76:79], v[124:127], v[120:123], v[76:79]
    ds_read_b64_tr_b16 v[156:157], v11 offset:7168
    ds_read_b64_tr_b16 v[158:159], v11 offset:8960
    v_mfma_f32_16x16x32_bf16 v[56:59], v[128:131], v[116:119], v[56:59]
    ds_read_b64_tr_b16 v[160:161], v11 offset:21504
    ds_read_b64_tr_b16 v[162:163], v11 offset:23296
    v_mfma_f32_16x16x32_bf16 v[80:83], v[128:131], v[120:123], v[80:83]
    ds_read_b64_tr_b16 v[164:165], v11 offset:7200
    ds_read_b64_tr_b16 v[166:167], v11 offset:8992
    v_mfma_f32_16x16x32_bf16 v[60:63], v[132:135], v[116:119], v[60:63]
    ds_read_b64_tr_b16 v[168:169], v11 offset:21536
    ds_read_b64_tr_b16 v[170:171], v11 offset:23328
    v_mfma_f32_16x16x32_bf16 v[84:87], v[132:135], v[120:123], v[84:87]
    ds_read_b64_tr_b16 v[172:173], v11 offset:7232
    ds_read_b64_tr_b16 v[174:175], v11 offset:9024
    v_mfma_f32_16x16x32_bf16 v[64:67], v[136:139], v[116:119], v[64:67]
    ds_read_b64_tr_b16 v[176:177], v11 offset:21568
    ds_read_b64_tr_b16 v[178:179], v11 offset:23360
    v_mfma_f32_16x16x32_bf16 v[88:91], v[136:139], v[120:123], v[88:91]
    s_add_u32 m0, s87, 90112
    s_nop 0
    buffer_load_dwordx4 v2, s[8:11], s86 offen sc1 lds
    v_mfma_f32_16x16x32_bf16 v[68:71], v[140:143], v[116:119], v[68:71]
    v_mfma_f32_16x16x32_bf16 v[92:95], v[140:143], v[120:123], v[92:95]
    buffer_load_dwordx4 v2, s[8:11], s86 offen offset:1024 sc1 lds
    s_add_u32 s86, s86, 2048
    v_mfma_f32_16x16x32_bf16 v[72:75], v[144:147], v[116:119], v[72:75]
    v_mfma_f32_16x16x32_bf16 v[96:99], v[144:147], v[120:123], v[96:99]
    s_cbranch_vccnz Lv_144
    s_waitcnt vmcnt(6) lgkmcnt(0)
    s_branch Lv_145
Lv_144:
    s_waitcnt vmcnt(2) lgkmcnt(0)
Lv_145:
    s_barrier
    v_mfma_f32_16x16x32_bf16 v[52:55], v[156:159], v[148:151], v[52:55]
    ds_read_b128 v[116:119], v9 offset:0
    ds_read_b128 v[120:123], v9 offset:2048
    v_mfma_f32_16x16x32_bf16 v[76:79], v[156:159], v[152:155], v[76:79]
    ds_read_b64_tr_b16 v[124:125], v12 offset:0
    ds_read_b64_tr_b16 v[126:127], v12 offset:1792
    v_mfma_f32_16x16x32_bf16 v[56:59], v[160:163], v[148:151], v[56:59]
    ds_read_b64_tr_b16 v[128:129], v12 offset:14336
    ds_read_b64_tr_b16 v[130:131], v12 offset:16128
    v_mfma_f32_16x16x32_bf16 v[80:83], v[160:163], v[152:155], v[80:83]
    ds_read_b64_tr_b16 v[132:133], v12 offset:32
    ds_read_b64_tr_b16 v[134:135], v12 offset:1824
    v_mfma_f32_16x16x32_bf16 v[60:63], v[164:167], v[148:151], v[60:63]
    ds_read_b64_tr_b16 v[136:137], v12 offset:14368
    ds_read_b64_tr_b16 v[138:139], v12 offset:16160
    v_mfma_f32_16x16x32_bf16 v[84:87], v[164:167], v[152:155], v[84:87]
    ds_read_b64_tr_b16 v[140:141], v12 offset:64
    ds_read_b64_tr_b16 v[142:143], v12 offset:1856
    v_mfma_f32_16x16x32_bf16 v[64:67], v[168:171], v[148:151], v[64:67]
    ds_read_b64_tr_b16 v[144:145], v12 offset:14400
    ds_read_b64_tr_b16 v[146:147], v12 offset:16192
    v_mfma_f32_16x16x32_bf16 v[88:91], v[168:171], v[152:155], v[88:91]
    s_cbranch_vccnz Lw7_146
    s_add_u32 m0, s85, 0
    s_nop 0
    buffer_load_dwordx4 v2, s[8:11], s84 offen sc1 lds
Lw7_146:
    v_mfma_f32_16x16x32_bf16 v[68:71], v[172:175], v[148:151], v[68:71]
    s_cbranch_vccnz Lw7_147
    buffer_load_dwordx4 v2, s[8:11], s84 offen offset:1024 sc1 lds
Lw7_147:
    v_mfma_f32_16x16x32_bf16 v[92:95], v[172:175], v[152:155], v[92:95]
    s_cbranch_vccnz Lw7_148
    s_add_u32 m0, s85, 14336
    s_add_u32 s75, s84, 143360
    buffer_load_dwordx4 v2, s[8:11], s75 offen sc1 lds
Lw7_148:
    v_mfma_f32_16x16x32_bf16 v[72:75], v[176:179], v[148:151], v[72:75]
    s_cbranch_vccnz Lw7_149
    buffer_load_dwordx4 v2, s[8:11], s75 offen offset:1024 sc1 lds
    s_add_u32 s84, s84, 14336
Lw7_149:
    v_mfma_f32_16x16x32_bf16 v[96:99], v[176:179], v[152:155], v[96:99]
    s_waitcnt lgkmcnt(0)
    v_mfma_f32_16x16x32_bf16 v[52:55], v[124:127], v[116:119], v[52:55]
    ds_read_b128 v[148:151], v9 offset:1024
    ds_read_b128 v[152:155], v9 offset:3072
    v_mfma_f32_16x16x32_bf16 v[76:79], v[124:127], v[120:123], v[76:79]
    ds_read_b64_tr_b16 v[156:157], v12 offset:7168
    ds_read_b64_tr_b16 v[158:159], v12 offset:8960
    v_mfma_f32_16x16x32_bf16 v[56:59], v[128:131], v[116:119], v[56:59]
    ds_read_b64_tr_b16 v[160:161], v12 offset:21504
    ds_read_b64_tr_b16 v[162:163], v12 offset:23296
    v_mfma_f32_16x16x32_bf16 v[80:83], v[128:131], v[120:123], v[80:83]
    ds_read_b64_tr_b16 v[164:165], v12 offset:7200
    ds_read_b64_tr_b16 v[166:167], v12 offset:8992
    v_mfma_f32_16x16x32_bf16 v[60:63], v[132:135], v[116:119], v[60:63]
    ds_read_b64_tr_b16 v[168:169], v12 offset:21536
    ds_read_b64_tr_b16 v[170:171], v12 offset:23328
    v_mfma_f32_16x16x32_bf16 v[84:87], v[132:135], v[120:123], v[84:87]
    ds_read_b64_tr_b16 v[172:173], v12 offset:7232
    ds_read_b64_tr_b16 v[174:175], v12 offset:9024
    v_mfma_f32_16x16x32_bf16 v[64:67], v[136:139], v[116:119], v[64:67]
    ds_read_b64_tr_b16 v[176:177], v12 offset:21568
    ds_read_b64_tr_b16 v[178:179], v12 offset:23360
    v_mfma_f32_16x16x32_bf16 v[88:91], v[136:139], v[120:123], v[88:91]
    s_add_u32 m0, s87, 0
    s_nop 0
    buffer_load_dwordx4 v2, s[8:11], s86 offen sc1 lds
    v_mfma_f32_16x16x32_bf16 v[68:71], v[140:143], v[116:119], v[68:71]
    buffer_load_dwordx4 v2, s[8:11], s86 offen offset:1024 sc1 lds
    s_add_u32 s86, s86, 2048
    v_mfma_f32_16x16x32_bf16 v[92:95], v[140:143], v[120:123], v[92:95]
    v_add_f32 v16, v16, v18
    v_add_f32 v17, v17, v19
    v_add_f32 v20, v20, v22
    v_add_f32 v21, v21, v23
    v_add_f32 v16, v16, v20
    v_add_f32 v17, v17, v21
    ds_write_b64 v41, v[16:17]
    v_mfma_f32_16x16x32_bf16 v[72:75], v[144:147], v[116:119], v[72:75]
    v_mfma_f32_16x16x32_bf16 v[96:99], v[144:147], v[120:123], v[96:99]
    s_cbranch_vccnz Lv_150
    s_waitcnt vmcnt(6) lgkmcnt(0)
    s_branch Lv_151
Lv_150:
    s_waitcnt vmcnt(2) lgkmcnt(0)
Lv_151:
    s_barrier
    v_mfma_f32_16x16x32_bf16 v[52:55], v[156:159], v[148:151], v[52:55]
    ds_read_b128 v[116:119], v10 offset:0
    ds_read_b128 v[120:123], v10 offset:2048
    v_mfma_f32_16x16x32_bf16 v[76:79], v[156:159], v[152:155], v[76:79]
    ds_read_b64_tr_b16 v[124:125], v13 offset:0
    ds_read_b64_tr_b16 v[126:127], v13 offset:1792
    v_mfma_f32_16x16x32_bf16 v[56:59], v[160:163], v[148:151], v[56:59]
    ds_read_b64_tr_b16 v[128:129], v13 offset:14336
    ds_read_b64_tr_b16 v[130:131], v13 offset:16128
    v_mfma_f32_16x16x32_bf16 v[80:83], v[160:163], v[152:155], v[80:83]
    ds_read_b64_tr_b16 v[132:133], v13 offset:32
    ds_read_b64_tr_b16 v[134:135], v13 offset:1824
    v_mfma_f32_16x16x32_bf16 v[60:63], v[164:167], v[148:151], v[60:63]
    ds_read_b64_tr_b16 v[136:137], v13 offset:14368
    ds_read_b64_tr_b16 v[138:139], v13 offset:16160
    v_mfma_f32_16x16x32_bf16 v[84:87], v[164:167], v[152:155], v[84:87]
    ds_read_b64_tr_b16 v[140:141], v13 offset:64
    ds_read_b64_tr_b16 v[142:143], v13 offset:1856
    v_mfma_f32_16x16x32_bf16 v[64:67], v[168:171], v[148:151], v[64:67]
    ds_read_b64_tr_b16 v[144:145], v13 offset:14400
    ds_read_b64_tr_b16 v[146:147], v13 offset:16192
    v_mfma_f32_16x16x32_bf16 v[88:91], v[168:171], v[152:155], v[88:91]
    s_cbranch_vccnz Lw7_152
    s_add_u32 m0, s85, 45056
    s_nop 0
    buffer_load_dwordx4 v2, s[8:11], s84 offen sc1 lds
Lw7_152:
    v_mfma_f32_16x16x32_bf16 v[68:71], v[172:175], v[148:151], v[68:71]
    s_cbranch_vccnz Lw7_153
    buffer_load_dwordx4 v2, s[8:11], s84 offen offset:1024 sc1 lds
Lw7_153:
    v_mfma_f32_16x16x32_bf16 v[92:95], v[172:175], v[152:155], v[92:95]
    s_cbranch_vccnz Lw7_154
    s_add_u32 m0, s85, 59392
    s_add_u32 s75, s84, 143360
    buffer_load_dwordx4 v2, s[8:11], s75 offen sc1 lds
Lw7_154:
    v_mfma_f32_16x16x32_bf16 v[72:75], v[176:179], v[148:151], v[72:75]
    s_cbranch_vccnz Lw7_155
    buffer_load_dwordx4 v2, s[8:11], s75 offen offset:1024 sc1 lds
    s_add_u32 s84, s84, 14336
Lw7_155:
    v_mfma_f32_16x16x32_bf16 v[96:99], v[176:179], v[152:155], v[96:99]
    s_waitcnt lgkmcnt(0)
    v_mfma_f32_16x16x32_bf16 v[52:55], v[124:127], v[116:119], v[52:55]
    ds_read_b128 v[148:151], v10 offset:1024
    ds_read_b128 v[152:155], v10 offset:3072
    v_mfma_f32_16x16x32_bf16 v[76:79], v[124:127], v[120:123], v[76:79]
    ds_read_b64_tr_b16 v[156:157], v13 offset:7168
    ds_read_b64_tr_b16 v[158:159], v13 offset:8960
    v_mfma_f32_16x16x32_bf16 v[56:59], v[128:131], v[116:119], v[56:59]
    ds_read_b64_tr_b16 v[160:161], v13 offset:21504
    ds_read_b64_tr_b16 v[162:163], v13 offset:23296
    v_mfma_f32_16x16x32_bf16 v[80:83], v[128:131], v[120:123], v[80:83]
    ds_read_b64_tr_b16 v[164:165], v13 offset:7200
    ds_read_b64_tr_b16 v[166:167], v13 offset:8992
    v_mfma_f32_16x16x32_bf16 v[60:63], v[132:135], v[116:119], v[60:63]
    ds_read_b64_tr_b16 v[168:169], v13 offset:21536
    ds_read_b64_tr_b16 v[170:171], v13 offset:23328
    v_mfma_f32_16x16x32_bf16 v[84:87], v[132:135], v[120:123], v[84:87]
    ds_read_b64_tr_b16 v[172:173], v13 offset:7232
    ds_read_b64_tr_b16 v[174:175], v13 offset:9024
    v_mfma_f32_16x16x32_bf16 v[64:67], v[136:139], v[116:119], v[64:67]
    ds_read_b64_tr_b16 v[176:177], v13 offset:21568
    ds_read_b64_tr_b16 v[178:179], v13 offset:23360
    v_mfma_f32_16x16x32_bf16 v[88:91], v[136:139], v[120:123], v[88:91]
    s_add_u32 m0, s87, 45056
    s_nop 0
    buffer_load_dwordx4 v2, s[8:11], s86 offen sc1 lds
    v_mfma_f32_16x16x32_bf16 v[68:71], v[140:143], v[116:119], v[68:71]
    buffer_load_dwordx4 v2, s[8:11], s86 offen offset:1024 sc1 lds
    s_add_u32 s86, s86, 2048
    v_mfma_f32_16x16x32_bf16 v[92:95], v[140:143], v[120:123], v[92:95]
    s_cbranch_vccz Lut_156
    v_mov_b32 v14, s98
    v_add_u32 v14, v14, v1
    v_cmp_lt_u32 s[92:93], 6, v1
    v_add_u32 v15, 101, v14
    s_nop 1
    v_cndmask_b32 v14, v14, v15, s[92:93]
    v_lshlrev_b32 v14, 2, v14
    s_mov_b32 s71, 36864
    s_mov_b32 s90, 0
    s_mov_b32 exec_lo, 0x3fff
    s_mov_b32 exec_hi, 0
Lut_157:
    buffer_load_dword v15, v14, s[8:11], s71 offen sc1
    s_waitcnt vmcnt(0)
    v_cmp_ne_u32 s[92:93], s66, v15
    s_nop 4
    s_cmp_eq_u64 s[92:93], 0
    s_cbranch_scc1 Lut_158
    s_add_u32 s90, s90, 1
    s_cmp_lt_u32 s90, 400000
    s_cbranch_scc1 Lut_157
Lut_158:
    s_mov_b64 exec, -1
    s_lshl_b32 s71, s98, 6
    s_add_u32 s71, s71, 65536
    s_mov_b32 s72, 153391690
    v_mul_hi_u32 v14, v1, s72
    v_mul_u32_u24 v14, 6464, v14
    v_add_u32 v14, v14, v2
    s_mov_b32 m0, 155648
    s_nop 0
    buffer_load_dwordx4 v14, s[8:11], s71 offen sc1 lds
    v_add_u32 v14, 64, v1
    v_mul_hi_u32 v15, v14, s72
    v_mul_u32_u24 v15, 6464, v15
    v_lshl_add_u32 v14, v14, 4, v15
    s_mov_b32 m0, 156672
    s_mov_b32 exec_hi, 0xffff
    buffer_load_dwordx4 v14, s[8:11], s71 offen sc1 lds
    s_mov_b64 exec, -1
Lut_156:
    v_mfma_f32_16x16x32_bf16 v[72:75], v[144:147], v[116:119], v[72:75]
    v_mfma_f32_16x16x32_bf16 v[96:99], v[144:147], v[120:123], v[96:99]
    s_cbranch_vccnz Lv_159
    s_waitcnt vmcnt(6) lgkmcnt(0)
    s_branch Lv_160
Lv_159:
    s_waitcnt vmcnt(2) lgkmcnt(0)
Lv_160:
    s_barrier
    v_mfma_f32_16x16x32_bf16 v[52:55], v[156:159], v[148:151], v[52:55]
    ds_read_b128 v[116:119], v8 offset:0
    ds_read_b128 v[120:123], v8 offset:2048
    v_mfma_f32_16x16x32_bf16 v[76:79], v[156:159], v[152:155], v[76:79]
    ds_read_b64_tr_b16 v[124:125], v11 offset:0
    ds_read_b64_tr_b16 v[126:127], v11 offset:1792
    v_mfma_f32_16x16x32_bf16 v[56:59], v[160:163], v[148:151], v[56:59]
    ds_read_b64_tr_b16 v[128:129], v11 offset:14336
    ds_read_b64_tr_b16 v[130:131], v11 offset:16128
    v_mfma_f32_16x16x32_bf16 v[80:83], v[160:163], v[152:155], v[80:83]
    ds_read_b64_tr_b16 v[132:133], v11 offset:32
    ds_read_b64_tr_b16 v[134:135], v11 offset:1824
    v_mfma_f32_16x16x32_bf16 v[60:63], v[164:167], v[148:151], v[60:63]
    ds_read_b64_tr_b16 v[136:137], v11 offset:14368
    ds_read_b64_tr_b16 v[138:139], v11 offset:16160
    v_mfma_f32_16x16x32_bf16 v[84:87], v[164:167], v[152:155], v[84:87]
    ds_read_b64_tr_b16 v[140:141], v11 offset:64
    ds_read_b64_tr_b16 v[142:143], v11 offset:1856
    v_mfma_f32_16x16x32_bf16 v[64:67], v[168:171], v[148:151], v[64:67]
    ds_read_b64_tr_b16 v[144:145], v11 offset:14400
    ds_read_b64_tr_b16 v[146:147], v11 offset:16192
    v_mfma_f32_16x16x32_bf16 v[88:91], v[168:171], v[152:155], v[88:91]
    s_cbranch_vccnz Lw7_161
    s_add_u32 m0, s85, 90112
    s_nop 0
    buffer_load_dwordx4 v2, s[8:11], s84 offen sc1 lds
Lw7_161:
    v_mfma_f32_16x16x32_bf16 v[68:71], v[172:175], v[148:151], v[68:71]
    s_cbranch_vccnz Lw7_162
    buffer_load_dwordx4 v2, s[8:11], s84 offen offset:1024 sc1 lds
Lw7_162:
    v_mfma_f32_16x16x32_bf16 v[92:95], v[172:175], v[152:155], v[92:95]
    s_cbranch_vccnz Lw7_163
    s_add_u32 m0, s85, 104448
    s_add_u32 s75, s84, 143360
    buffer_load_dwordx4 v2, s[8:11], s75 offen sc1 lds
Lw7_163:
    v_mfma_f32_16x16x32_bf16 v[72:75], v[176:179], v[148:151], v[72:75]
    s_cbranch_vccnz Lw7_164
    buffer_load_dwordx4 v2, s[8:11], s75 offen offset:1024 sc1 lds
    s_add_u32 s84, s84, 14336
Lw7_164:
    v_mfma_f32_16x16x32_bf16 v[96:99], v[176:179], v[152:155], v[96:99]
    s_waitcnt lgkmcnt(0)
    v_mfma_f32_16x16x32_bf16 v[52:55], v[124:127], v[116:119], v[52:55]
    ds_read_b128 v[148:151], v8 offset:1024
    ds_read_b128 v[152:155], v8 offset:3072
    v_mfma_f32_16x16x32_bf16 v[76:79], v[124:127], v[120:123], v[76:79]
    ds_read_b64_tr_b16 v[156:157], v11 offset:7168
    ds_read_b64_tr_b16 v[158:159], v11 offset:8960
    v_mfma_f32_16x16x32_bf16 v[56:59], v[128:131], v[116:119], v[56:59]
    ds_read_b64_tr_b16 v[160:161], v11 offset:21504
    ds_read_b64_tr_b16 v[162:163], v11 offset:23296
    v_mfma_f32_16x16x32_bf16 v[80:83], v[128:131], v[120:123], v[80:83]
    ds_read_b64_tr_b16 v[164:165], v11 offset:7200
    ds_read_b64_tr_b16 v[166:167], v11 offset:8992
    v_mfma_f32_16x16x32_bf16 v[60:63], v[132:135], v[116:119], v[60:63]
    ds_read_b64_tr_b16 v[168:169], v11 offset:21536
    ds_read_b64_tr_b16 v[170:171], v11 offset:23328
    v_mfma_f32_16x16x32_bf16 v[84:87], v[132:135], v[120:123], v[84:87]
    ds_read_b64_tr_b16 v[172:173], v11 offset:7232
    ds_read_b64_tr_b16 v[174:175], v11 offset:9024
    v_mfma_f32_16x16x32_bf16 v[64:67], v[136:139], v[116:119], v[64:67]
    ds_read_b64_tr_b16 v[176:177], v11 offset:21568
    ds_read_b64_tr_b16 v[178:179], v11 offset:23360
    v_mfma_f32_16x16x32_bf16 v[88:91], v[136:139], v[120:123], v[88:91]
    s_add_u32 m0, s87, 90112
    s_nop 0
    buffer_load_dwordx4 v2, s[8:11], s86 offen sc1 lds
    v_mfma_f32_16x16x32_bf16 v[68:71], v[140:143], v[116:119], v[68:71]
    buffer_load_dwordx4 v2, s[8:11], s86 offen offset:1024 sc1 lds
    s_add_u32 s86, s86, 2048
    v_mfma_f32_16x16x32_bf16 v[92:95], v[140:143], v[120:123], v[92:95]
    v_and_b32 v14, 15, v1
    s_lshl_b32 s71, s81, 7
    s_add_u32 s71, s71, 158720
    v_lshl_add_u32 v14, v14, 3, s71
    ds_read_b64 v[180:181], v14 offset:0
    ds_read_b64 v[182:183], v14 offset:1024
    ds_read_b64 v[184:185], v14 offset:2048
    ds_read_b64 v[186:187], v14 offset:3072
    v_mfma_f32_16x16x32_bf16 v[72:75], v[144:147], v[116:119], v[72:75]
    ds_read_b64 v[188:189], v14 offset:128
    ds_read_b64 v[190:191], v14 offset:1152
    ds_read_b64 v[192:193], v14 offset:2176
    ds_read_b64 v[194:195], v14 offset:3200
    v_mfma_f32_16x16x32_bf16 v[96:99], v[144:147], v[120:123], v[96:99]
    s_cbranch_vccnz Lv_165
    s_waitcnt vmcnt(6) lgkmcnt(0)
    s_branch Lv_166
Lv_165:
    s_waitcnt vmcnt(2) lgkmcnt(0)
Lv_166:
    s_barrier
    v_mfma_f32_16x16x32_bf16 v[52:55], v[156:159], v[148:151], v[52:55]
    ds_read_b128 v[116:119], v9 offset:0
    ds_read_b128 v[120:123], v9 offset:2048
    v_mfma_f32_16x16x32_bf16 v[76:79], v[156:159], v[152:155], v[76:79]
    ds_read_b64_tr_b16 v[124:125], v12 offset:0
    ds_read_b64_tr_b16 v[126:127], v12 offset:1792
    v_mfma_f32_16x16x32_bf16 v[56:59], v[160:163], v[148:151], v[56:59]
    ds_read_b64_tr_b16 v[128:129], v12 offset:14336
    ds_read_b64_tr_b16 v[130:131], v12 offset:16128
    v_mfma_f32_16x16x32_bf16 v[80:83], v[160:163], v[152:155], v[80:83]
    ds_read_b64_tr_b16 v[132:133], v12 offset:32
    ds_read_b64_tr_b16 v[134:135], v12 offset:1824
    v_mfma_f32_16x16x32_bf16 v[60:63], v[164:167], v[148:151], v[60:63]
    ds_read_b64_tr_b16 v[136:137], v12 offset:14368
    ds_read_b64_tr_b16 v[138:139], v12 offset:16160
    v_mfma_f32_16x16x32_bf16 v[84:87], v[164:167], v[152:155], v[84:87]
    ds_read_b64_tr_b16 v[140:141], v12 offset:64
    ds_read_b64_tr_b16 v[142:143], v12 offset:1856
    v_mfma_f32_16x16x32_bf16 v[64:67], v[168:171], v[148:151], v[64:67]
    ds_read_b64_tr_b16 v[144:145], v12 offset:14400
    ds_read_b64_tr_b16 v[146:147], v12 offset:16192
    v_mfma_f32_16x16x32_bf16 v[88:91], v[168:171], v[152:155], v[88:91]
    s_cbranch_vccnz Lw7_167
    s_add_u32 m0, s85, 0
    s_nop 0
    buffer_load_dwordx4 v2, s[8:11], s84 offen sc1 lds
Lw7_167:
    v_mfma_f32_16x16x32_bf16 v[68:71], v[172:175], v[148:151], v[68:71]
    s_cbranch_vccnz Lw7_168
    buffer_load_dwordx4 v2, s[8:11], s84 offen offset:1024 sc1 lds
Lw7_168:
    v_mfma_f32_16x16x32_bf16 v[92:95], v[172:175], v[152:155], v[92:95]
    s_cbranch_vccnz Lw7_169
    s_add_u32 m0, s85, 14336
    s_add_u32 s75, s84, 143360
    buffer_load_dwordx4 v2, s[8:11], s75 offen sc1 lds
Lw7_169:
    v_mfma_f32_16x16x32_bf16 v[72:75], v[176:179], v[148:151], v[72:75]
    s_cbranch_vccnz Lw7_170
    buffer_load_dwordx4 v2, s[8:11], s75 offen offset:1024 sc1 lds
    s_add_u32 s84, s84, 14336
Lw7_170:
    v_mfma_f32_16x16x32_bf16 v[96:99], v[176:179], v[152:155], v[96:99]
    s_waitcnt lgkmcnt(0)
    v_mfma_f32_16x16x32_bf16 v[52:55], v[124:127], v[116:119], v[52:55]
    ds_read_b128 v[148:151], v9 offset:1024
    ds_read_b128 v[152:155], v9 offset:3072
    v_mfma_f32_16x16x32_bf16 v[76:79], v[124:127], v[120:123], v[76:79]
    ds_read_b64_tr_b16 v[156:157], v12 offset:7168
    ds_read_b64_tr_b16 v[158:159], v12 offset:8960
    v_mfma_f32_16x16x32_bf16 v[56:59], v[128:131], v[116:119], v[56:59]
    ds_read_b64_tr_b16 v[160:161], v12 offset:21504
    ds_read_b64_tr_b16 v[162:163], v12 offset:23296
    v_mfma_f32_16x16x32_bf16 v[80:83], v[128:131], v[120:123], v[80:83]
    ds_read_b64_tr_b16 v[164:165], v12 offset:7200
    ds_read_b64_tr_b16 v[166:167], v12 offset:8992
    v_mfma_f32_16x16x32_bf16 v[60:63], v[132:135], v[116:119], v[60:63]
    ds_read_b64_tr_b16 v[168:169], v12 offset:21536
    ds_read_b64_tr_b16 v[170:171], v12 offset:23328
    v_mfma_f32_16x16x32_bf16 v[84:87], v[132:135], v[120:123], v[84:87]
    ds_read_b64_tr_b16 v[172:173], v12 offset:7232
    ds_read_b64_tr_b16 v[174:175], v12 offset:9024
    v_mfma_f32_16x16x32_bf16 v[64:67], v[136:139], v[116:119], v[64:67]
    ds_read_b64_tr_b16 v[176:177], v12 offset:21568
    ds_read_b64_tr_b16 v[178:179], v12 offset:23360
    v_mfma_f32_16x16x32_bf16 v[88:91], v[136:139], v[120:123], v[88:91]
    s_add_u32 m0, s87, 0
    s_nop 0
    buffer_load_dwordx4 v2, s[8:11], s86 offen sc1 lds
    buffer_load_dwordx4 v2, s[8:11], s86 offen offset:1024 sc1 lds
    s_add_u32 s86, s86, 2048
    v_mfma_f32_16x16x32_bf16 v[68:71], v[140:143], v[116:119], v[68:71]
    s_mov_b32 s74, 0x3acccccd
    v_mfma_f32_16x16x32_bf16 v[92:95], v[140:143], v[120:123], v[92:95]
    v_add_f32 v180, v180, v182
    v_add_f32 v181, v181, v183
    v_add_f32 v184, v184, v186
    v_add_f32 v185, v185, v187
    v_add_f32 v180, v180, v184
    v_add_f32 v181, v181, v185
    v_mul_f32 v180, s74, v180
    v_mul_f32 v181, s74, v181
    v_fma_f32 v181, -v180, v180, v181
    v_max_f32 v181, 0, v181
    v_add_f32 v181, 0x3727c5ac, v181
    v_rsq_f32 v16, v181
    s_nop 0
    v_mov_b32 v17, v16
    v_mul_f32 v18, -v16, v180
    v_mul_f32 v19, -v16, v180
    v_mfma_f32_16x16x32_bf16 v[72:75], v[144:147], v[116:119], v[72:75]
    v_add_f32 v188, v188, v190
    v_add_f32 v189, v189, v191
    v_add_f32 v192, v192, v194
    v_add_f32 v193, v193, v195
    v_add_f32 v188, v188, v192
    v_add_f32 v189, v189, v193
    v_mul_f32 v188, s74, v188
    v_mul_f32 v189, s74, v189
    v_fma_f32 v189, -v188, v188, v189
    v_max_f32 v189, 0, v189
    v_add_f32 v189, 0x3727c5ac, v189
    v_rsq_f32 v20, v189
    s_nop 0
    v_mov_b32 v21, v20
    v_mul_f32 v22, -v20, v188
    v_mul_f32 v23, -v20, v188
    v_mfma_f32_16x16x32_bf16 v[96:99], v[144:147], v[120:123], v[96:99]
    s_cbranch_vccnz Lv_171
    s_waitcnt vmcnt(6) lgkmcnt(0)
    s_branch Lv_172
Lv_171:
    s_waitcnt vmcnt(2) lgkmcnt(0)
Lv_172:
    s_barrier
    v_mfma_f32_16x16x32_bf16 v[52:55], v[156:159], v[148:151], v[52:55]
    ds_read_b128 v[116:119], v10 offset:0
    ds_read_b128 v[120:123], v10 offset:2048
    v_mfma_f32_16x16x32_bf16 v[76:79], v[156:159], v[152:155], v[76:79]
    ds_read_b64_tr_b16 v[124:125], v13 offset:0
    ds_read_b64_tr_b16 v[126:127], v13 offset:1792
    v_mfma_f32_16x16x32_bf16 v[56:59], v[160:163], v[148:151], v[56:59]
    ds_read_b64_tr_b16 v[128:129], v13 offset:14336
    ds_read_b64_tr_b16 v[130:131], v13 offset:16128
    v_mfma_f32_16x16x32_bf16 v[80:83], v[160:163], v[152:155], v[80:83]
    ds_read_b64_tr_b16 v[132:133], v13 offset:32
    ds_read_b64_tr_b16 v[134:135], v13 offset:1824
    v_mfma_f32_16x16x32_bf16 v[60:63], v[164:167], v[148:151], v[60:63]
    ds_read_b64_tr_b16 v[136:137], v13 offset:14368
    ds_read_b64_tr_b16 v[138:139], v13 offset:16160
    v_mfma_f32_16x16x32_bf16 v[84:87], v[164:167], v[152:155], v[84:87]
    ds_read_b64_tr_b16 v[140:141], v13 offset:64
    ds_read_b64_tr_b16 v[142:143], v13 offset:1856
    v_mfma_f32_16x16x32_bf16 v[64:67], v[168:171], v[148:151], v[64:67]
    ds_read_b64_tr_b16 v[144:145], v13 offset:14400
    ds_read_b64_tr_b16 v[146:147], v13 offset:16192
    v_mfma_f32_16x16x32_bf16 v[88:91], v[168:171], v[152:155], v[88:91]
    s_add_u32 s73, s76, 0
    s_add_u32 m0, s77, 65536
    s_nop 0
    buffer_load_dwordx4 v2, s[8:11], s73 offen offset:0 sc1 lds
    buffer_load_dwordx4 v2, s[8:11], s73 offen offset:1024 sc1 lds
    v_mfma_f32_16x16x32_bf16 v[68:71], v[172:175], v[148:151], v[68:71]
    buffer_load_dwordx4 v2, s[8:11], s73 offen offset:2048 sc1 lds
    v_mfma_f32_16x16x32_bf16 v[92:95], v[172:175], v[152:155], v[92:95]
    buffer_load_dwordx4 v2, s[8:11], s73 offen offset:3072 sc1 lds
    v_mfma_f32_16x16x32_bf16 v[72:75], v[176:179], v[148:151], v[72:75]
    s_add_u32 s73, s73, 4096
    s_add_u32 m0, s77, 69632
    s_nop 0
    buffer_load_dwordx4 v2, s[8:11], s73 offen sc1 lds
    v_mfma_f32_16x16x32_bf16 v[96:99], v[176:179], v[152:155], v[96:99]
    s_waitcnt lgkmcnt(0)
    v_mfma_f32_16x16x32_bf16 v[52:55], v[124:127], v[116:119], v[52:55]
    ds_read_b128 v[148:151], v10 offset:1024
    ds_read_b128 v[152:155], v10 offset:3072
    v_mfma_f32_16x16x32_bf16 v[76:79], v[124:127], v[120:123], v[76:79]
    ds_read_b64_tr_b16 v[156:157], v13 offset:7168
    ds_read_b64_tr_b16 v[158:159], v13 offset:8960
    v_mfma_f32_16x16x32_bf16 v[56:59], v[128:131], v[116:119], v[56:59]
    ds_read_b64_tr_b16 v[160:161], v13 offset:21504
    ds_read_b64_tr_b16 v[162:163], v13 offset:23296
    v_mfma_f32_16x16x32_bf16 v[80:83], v[128:131], v[120:123], v[80:83]
    ds_read_b64_tr_b16 v[164:165], v13 offset:7200
    ds_read_b64_tr_b16 v[166:167], v13 offset:8992
    v_mfma_f32_16x16x32_bf16 v[60:63], v[132:135], v[116:119], v[60:63]
    ds_read_b64_tr_b16 v[168:169], v13 offset:21536
    ds_read_b64_tr_b16 v[170:171], v13 offset:23328
    v_mfma_f32_16x16x32_bf16 v[84:87], v[132:135], v[120:123], v[84:87]
    ds_read_b64_tr_b16 v[172:173], v13 offset:7232
    ds_read_b64_tr_b16 v[174:175], v13 offset:9024
    v_mfma_f32_16x16x32_bf16 v[64:67], v[136:139], v[116:119], v[64:67]
    ds_read_b64_tr_b16 v[176:177], v13 offset:21568
    ds_read_b64_tr_b16 v[178:179], v13 offset:23360
    v_mfma_f32_16x16x32_bf16 v[88:91], v[136:139], v[120:123], v[88:91]
    v_mfma_f32_16x16x32_bf16 v[68:71], v[140:143], v[116:119], v[68:71]
    v_mfma_f32_16x16x32_bf16 v[92:95], v[140:143], v[120:123], v[92:95]
    v_mfma_f32_16x16x32_bf16 v[72:75], v[144:147], v[116:119], v[72:75]
    v_mfma_f32_16x16x32_bf16 v[96:99], v[144:147], v[120:123], v[96:99]
    s_waitcnt vmcnt(5) lgkmcnt(0)
    s_barrier
    v_mfma_f32_16x16x32_bf16 v[52:55], v[156:159], v[148:151], v[52:55]
    ds_read_b128 v[116:119], v8 offset:0
    ds_read_b128 v[120:123], v8 offset:2048
    v_mfma_f32_16x16x32_bf16 v[76:79], v[156:159], v[152:155], v[76:79]
    ds_read_b64_tr_b16 v[124:125], v11 offset:0
    ds_read_b64_tr_b16 v[126:127], v11 offset:1792
    v_mfma_f32_16x16x32_bf16 v[56:59], v[160:163], v[148:151], v[56:59]
    ds_read_b64_tr_b16 v[128:129], v11 offset:14336
    ds_read_b64_tr_b16 v[130:131], v11 offset:16128
    v_mfma_f32_16x16x32_bf16 v[80:83], v[160:163], v[152:155], v[80:83]
    ds_read_b64_tr_b16 v[132:133], v11 offset:32
    ds_read_b64_tr_b16 v[134:135], v11 offset:1824
    v_mfma_f32_16x16x32_bf16 v[60:63], v[164:167], v[148:151], v[60:63]
    ds_read_b64_tr_b16 v[136:137], v11 offset:14368
    ds_read_b64_tr_b16 v[138:139], v11 offset:16160
    v_mfma_f32_16x16x32_bf16 v[84:87], v[164:167], v[152:155], v[84:87]
    ds_read_b64_tr_b16 v[140:141], v11 offset:64
    ds_read_b64_tr_b16 v[142:143], v11 offset:1856
    v_mfma_f32_16x16x32_bf16 v[64:67], v[168:171], v[148:151], v[64:67]
    ds_read_b64_tr_b16 v[144:145], v11 offset:14400
    ds_read_b64_tr_b16 v[146:147], v11 offset:16192
    v_mfma_f32_16x16x32_bf16 v[88:91], v[168:171], v[152:155], v[88:91]
    s_add_u32 s73, s76, 20480
    s_add_u32 m0, s77, 110592
    s_nop 0
    buffer_load_dwordx4 v2, s[8:11], s73 offen offset:0 sc1 lds
    buffer_load_dwordx4 v2, s[8:11], s73 offen offset:1024 sc1 lds
    v_mfma_f32_16x16x32_bf16 v[68:71], v[172:175], v[148:151], v[68:71]
    buffer_load_dwordx4 v2, s[8:11], s73 offen offset:2048 sc1 lds
    v_mfma_f32_16x16x32_bf16 v[92:95], v[172:175], v[152:155], v[92:95]
    buffer_load_dwordx4 v2, s[8:11], s73 offen offset:3072 sc1 lds
    v_mfma_f32_16x16x32_bf16 v[72:75], v[176:179], v[148:151], v[72:75]
    s_add_u32 s73, s73, 4096
    s_add_u32 m0, s77, 114688
    s_nop 0
    buffer_load_dwordx4 v2, s[8:11], s73 offen sc1 lds
    v_mfma_f32_16x16x32_bf16 v[96:99], v[176:179], v[152:155], v[96:99]
    s_waitcnt lgkmcnt(0)
    v_mfma_f32_16x16x32_bf16 v[52:55], v[124:127], v[116:119], v[52:55]
    ds_read_b128 v[148:151], v8 offset:1024
    ds_read_b128 v[152:155], v8 offset:3072
    v_mfma_f32_16x16x32_bf16 v[76:79], v[124:127], v[120:123], v[76:79]
    ds_read_b64_tr_b16 v[156:157], v11 offset:7168
    ds_read_b64_tr_b16 v[158:159], v11 offset:8960
    v_mfma_f32_16x16x32_bf16 v[56:59], v[128:131], v[116:119], v[56:59]
    ds_read_b64_tr_b16 v[160:161], v11 offset:21504
    ds_read_b64_tr_b16 v[162:163], v11 offset:23296
    v_mfma_f32_16x16x32_bf16 v[80:83], v[128:131], v[120:123], v[80:83]
    ds_read_b64_tr_b16 v[164:165], v11 offset:7200
    ds_read_b64_tr_b16 v[166:167], v11 offset:8992
    v_mfma_f32_16x16x32_bf16 v[60:63], v[132:135], v[116:119], v[60:63]
    ds_read_b64_tr_b16 v[168:169], v11 offset:21536
    ds_read_b64_tr_b16 v[170:171], v11 offset:23328
    v_mfma_f32_16x16x32_bf16 v[84:87], v[132:135], v[120:123], v[84:87]
    ds_read_b64_tr_b16 v[172:173], v11 offset:7232
    ds_read_b64_tr_b16 v[174:175], v11 offset:9024
    v_mfma_f32_16x16x32_bf16 v[64:67], v[136:139], v[116:119], v[64:67]
    ds_read_b64_tr_b16 v[176:177], v11 offset:21568
    ds_read_b64_tr_b16 v[178:179], v11 offset:23360
    v_mfma_f32_16x16x32_bf16 v[88:91], v[136:139], v[120:123], v[88:91]
    v_lshrrev_b32 v15, 4, v1
    s_lshl_b32 s72, s82, 6
    s_add_u32 s72, s72, 155648
    v_lshl_add_u32 v15, v15, 4, s72
    ds_read_b128 v[180:183], v15 offset:0
    ds_read_b128 v[184:187], v15 offset:448
    ds_read_b128 v[188:191], v15 offset:896
    ds_read_b128 v[192:195], v15 offset:1344
    ds_read_b128 v[196:199], v15 offset:64
    ds_read_b128 v[200:203], v15 offset:512
    ds_read_b128 v[204:207], v15 offset:960
    ds_read_b128 v[208:211], v15 offset:1408
    ds_read_b128 v[212:215], v15 offset:128
    ds_read_b128 v[216:219], v15 offset:576
    ds_read_b128 v[220:223], v15 offset:1024
    ds_read_b128 v[224:227], v15 offset:1472
    v_mfma_f32_16x16x32_bf16 v[68:71], v[140:143], v[116:119], v[68:71]
    v_mfma_f32_16x16x32_bf16 v[92:95], v[140:143], v[120:123], v[92:95]
    v_mfma_f32_16x16x32_bf16 v[72:75], v[144:147], v[116:119], v[72:75]
    v_mfma_f32_16x16x32_bf16 v[96:99], v[144:147], v[120:123], v[96:99]
    s_waitcnt lgkmcnt(0)
    v_mfma_f32_16x16x32_bf16 v[52:55], v[156:159], v[148:151], v[52:55]
    v_mfma_f32_16x16x32_bf16 v[76:79], v[156:159], v[152:155], v[76:79]
    v_mfma_f32_16x16x32_bf16 v[56:59], v[160:163], v[148:151], v[56:59]
    v_mfma_f32_16x16x32_bf16 v[80:83], v[160:163], v[152:155], v[80:83]
    v_mfma_f32_16x16x32_bf16 v[60:63], v[164:167], v[148:151], v[60:63]
    v_mfma_f32_16x16x32_bf16 v[84:87], v[164:167], v[152:155], v[84:87]
    v_mfma_f32_16x16x32_bf16 v[64:67], v[168:171], v[148:151], v[64:67]
    v_mfma_f32_16x16x32_bf16 v[88:91], v[168:171], v[152:155], v[88:91]
    v_mfma_f32_16x16x32_bf16 v[68:71], v[172:175], v[148:151], v[68:71]
    v_mfma_f32_16x16x32_bf16 v[92:95], v[172:175], v[152:155], v[92:95]
    v_mfma_f32_16x16x32_bf16 v[72:75], v[176:179], v[148:151], v[72:75]
    v_mfma_f32_16x16x32_bf16 v[96:99], v[176:179], v[152:155], v[96:99]
    s_setprio 0
    s_add_u32 s72, s98, s82
    s_lshl_b32 s71, s61, 3
    s_add_u32 s71, s71, s81
    s_mul_i32 s71, s71, 55296
    s_lshl_b32 s72, s72, 9
    s_add_u32 s71, s71, s72
    s_add_u32 s71, s71, 7340032
    v_mov_b32 v46, 0xbfb8aa3b
    v_mov_b32 v47, 0xbfb8aa3b
    v_mov_b32 v48, 1.0
    v_mov_b32 v49, 1.0
    s_barrier
    s_add_u32 s73, s76, 40960
    s_add_u32 m0, s77, 20480
    s_nop 0
    buffer_load_dwordx4 v2, s[8:11], s73 offen offset:0 sc1 lds
    buffer_load_dwordx4 v2, s[8:11], s73 offen offset:1024 sc1 lds
    buffer_load_dwordx4 v2, s[8:11], s73 offen offset:2048 sc1 lds
    buffer_load_dwordx4 v2, s[8:11], s73 offen offset:3072 sc1 lds
    s_add_u32 s73, s73, 4096
    s_add_u32 m0, s77, 24576
    s_nop 0
    buffer_load_dwordx4 v2, s[8:11], s73 offen sc1 lds
    v_pk_fma_f32 v[32:33], v[18:19], v[180:181], v[184:185]
    v_pk_fma_f32 v[36:37], v[18:19], v[188:189], v[192:193]
    v_pk_fma_f32 v[34:35], v[18:19], v[182:183], v[186:187]
    v_pk_fma_f32 v[38:39], v[18:19], v[190:191], v[194:195]
    v_pk_fma_f32 v[32:33], v[52:53], v[16:17], v[32:33]
    v_pk_fma_f32 v[36:37], v[56:57], v[16:17], v[36:37]
    v_pk_fma_f32 v[34:35], v[54:55], v[16:17], v[34:35]
    v_pk_fma_f32 v[38:39], v[58:59], v[16:17], v[38:39]
    v_pk_mul_f32 v[40:41], v[32:33], v[46:47]
    v_pk_mul_f32 v[42:43], v[34:35], v[46:47]
    v_exp_f32 v40, v40
    v_exp_f32 v41, v41
    v_exp_f32 v42, v42
    v_exp_f32 v43, v43
    v_pk_mul_f32 v[32:33], v[32:33], v[36:37]
    v_pk_mul_f32 v[34:35], v[34:35], v[38:39]
    v_pk_add_f32 v[40:41], v[40:41], v[48:49]
    v_pk_add_f32 v[42:43], v[42:43], v[48:49]
    v_rcp_f32 v40, v40
    v_rcp_f32 v41, v41
    v_rcp_f32 v42, v42
    v_rcp_f32 v43, v43
    s_nop 0
    v_pk_mul_f32 v[32:33], v[32:33], v[40:41]
    v_pk_mul_f32 v[34:35], v[34:35], v[42:43]
    v_cvt_pk_bf16_f32 v116, v32, v33
    v_cvt_pk_bf16_f32 v117, v34, v35
    v_pk_fma_f32 v[32:33], v[18:19], v[196:197], v[200:201]
    v_pk_fma_f32 v[36:37], v[18:19], v[204:205], v[208:209]
    v_pk_fma_f32 v[34:35], v[18:19], v[198:199], v[202:203]
    v_pk_fma_f32 v[38:39], v[18:19], v[206:207], v[210:211]
    v_pk_fma_f32 v[32:33], v[60:61], v[16:17], v[32:33]
    v_pk_fma_f32 v[36:37], v[64:65], v[16:17], v[36:37]
    v_pk_fma_f32 v[34:35], v[62:63], v[16:17], v[34:35]
    v_pk_fma_f32 v[38:39], v[66:67], v[16:17], v[38:39]
    v_pk_mul_f32 v[40:41], v[32:33], v[46:47]
    v_pk_mul_f32 v[42:43], v[34:35], v[46:47]
    v_exp_f32 v40, v40
    v_exp_f32 v41, v41
    v_exp_f32 v42, v42
    v_exp_f32 v43, v43
    v_pk_mul_f32 v[32:33], v[32:33], v[36:37]
    v_pk_mul_f32 v[34:35], v[34:35], v[38:39]
    v_pk_add_f32 v[40:41], v[40:41], v[48:49]
    v_pk_add_f32 v[42:43], v[42:43], v[48:49]
    v_rcp_f32 v40, v40
    v_rcp_f32 v41, v41
    v_rcp_f32 v42, v42
    v_rcp_f32 v43, v43
    s_nop 0
    v_pk_mul_f32 v[32:33], v[32:33], v[40:41]
    v_pk_mul_f32 v[34:35], v[34:35], v[42:43]
    v_cvt_pk_bf16_f32 v118, v32, v33
    v_cvt_pk_bf16_f32 v119, v34, v35
    v_pk_fma_f32 v[32:33], v[18:19], v[212:213], v[216:217]
    v_pk_fma_f32 v[36:37], v[18:19], v[220:221], v[224:225]
    v_pk_fma_f32 v[34:35], v[18:19], v[214:215], v[218:219]
    v_pk_fma_f32 v[38:39], v[18:19], v[222:223], v[226:227]
    v_pk_fma_f32 v[32:33], v[68:69], v[16:17], v[32:33]
    v_pk_fma_f32 v[36:37], v[72:73], v[16:17], v[36:37]
    v_pk_fma_f32 v[34:35], v[70:71], v[16:17], v[34:35]
    v_pk_fma_f32 v[38:39], v[74:75], v[16:17], v[38:39]
    v_pk_mul_f32 v[40:41], v[32:33], v[46:47]
    v_pk_mul_f32 v[42:43], v[34:35], v[46:47]
    v_exp_f32 v40, v40
    v_exp_f32 v41, v41
    v_exp_f32 v42, v42
    v_exp_f32 v43, v43
    v_pk_mul_f32 v[32:33], v[32:33], v[36:37]
    v_pk_mul_f32 v[34:35], v[34:35], v[38:39]
    v_pk_add_f32 v[40:41], v[40:41], v[48:49]
    v_pk_add_f32 v[42:43], v[42:43], v[48:49]
    v_rcp_f32 v40, v40
    v_rcp_f32 v41, v41
    v_rcp_f32 v42, v42
    v_rcp_f32 v43, v43
    s_nop 0
    v_pk_mul_f32 v[32:33], v[32:33], v[40:41]
    v_pk_mul_f32 v[34:35], v[34:35], v[42:43]
    v_cvt_pk_bf16_f32 v120, v32, v33
    v_cvt_pk_bf16_f32 v121, v34, v35
    v_permlane32_swap_b32 v116, v118
    v_permlane32_swap_b32 v117, v119
    buffer_store_dwordx4 v[116:119], v2, s[8:11], s71 offen offset:0 sc1
    v_mov_b32 v122, v120
    v_mov_b32 v123, v121
    s_nop 0
    v_permlane32_swap_b32 v120, v122
    v_permlane32_swap_b32 v121, v123
    s_mov_b32 exec_hi, 0
    buffer_store_dwordx4 v[120:123], v2, s[8:11], s71 offen offset:1024 sc1
    s_mov_b64 exec, -1
    s_add_u32 s71, s71, 55296
    v_pk_fma_f32 v[32:33], v[22:23], v[180:181], v[184:185]
    v_pk_fma_f32 v[36:37], v[22:23], v[188:189], v[192:193]
    v_pk_fma_f32 v[34:35], v[22:23], v[182:183], v[186:187]
    v_pk_fma_f32 v[38:39], v[22:23], v[190:191], v[194:195]
    v_pk_fma_f32 v[32:33], v[76:77], v[20:21], v[32:33]
    v_pk_fma_f32 v[36:37], v[80:81], v[20:21], v[36:37]
    v_pk_fma_f32 v[34:35], v[78:79], v[20:21], v[34:35]
    v_pk_fma_f32 v[38:39], v[82:83], v[20:21], v[38:39]
    v_pk_mul_f32 v[40:41], v[32:33], v[46:47]
    v_pk_mul_f32 v[42:43], v[34:35], v[46:47]
    v_exp_f32 v40, v40
    v_exp_f32 v41, v41
    v_exp_f32 v42, v42
    v_exp_f32 v43, v43
    v_pk_mul_f32 v[32:33], v[32:33], v[36:37]
    v_pk_mul_f32 v[34:35], v[34:35], v[38:39]
    v_pk_add_f32 v[40:41], v[40:41], v[48:49]
    v_pk_add_f32 v[42:43], v[42:43], v[48:49]
    v_rcp_f32 v40, v40
    v_rcp_f32 v41, v41
    v_rcp_f32 v42, v42
    v_rcp_f32 v43, v43
    s_nop 0
    v_pk_mul_f32 v[32:33], v[32:33], v[40:41]
    v_pk_mul_f32 v[34:35], v[34:35], v[42:43]
    v_cvt_pk_bf16_f32 v124, v32, v33
    v_cvt_pk_bf16_f32 v125, v34, v35
    v_pk_fma_f32 v[32:33], v[22:23], v[196:197], v[200:201]
    v_pk_fma_f32 v[36:37], v[22:23], v[204:205], v[208:209]
    v_pk_fma_f32 v[34:35], v[22:23], v[198:199], v[202:203]
    v_pk_fma_f32 v[38:39], v[22:23], v[206:207], v[210:211]
    v_pk_fma_f32 v[32:33], v[84:85], v[20:21], v[32:33]
    v_pk_fma_f32 v[36:37], v[88:89], v[20:21], v[36:37]
    v_pk_fma_f32 v[34:35], v[86:87], v[20:21], v[34:35]
    v_pk_fma_f32 v[38:39], v[90:91], v[20:21], v[38:39]
    v_pk_mul_f32 v[40:41], v[32:33], v[46:47]
    v_pk_mul_f32 v[42:43], v[34:35], v[46:47]
    v_exp_f32 v40, v40
    v_exp_f32 v41, v41
    v_exp_f32 v42, v42
    v_exp_f32 v43, v43
    v_pk_mul_f32 v[32:33], v[32:33], v[36:37]
    v_pk_mul_f32 v[34:35], v[34:35], v[38:39]
    v_pk_add_f32 v[40:41], v[40:41], v[48:49]
    v_pk_add_f32 v[42:43], v[42:43], v[48:49]
    v_rcp_f32 v40, v40
    v_rcp_f32 v41, v41
    v_rcp_f32 v42, v42
    v_rcp_f32 v43, v43
    s_nop 0
    v_pk_mul_f32 v[32:33], v[32:33], v[40:41]
    v_pk_mul_f32 v[34:35], v[34:35], v[42:43]
    v_cvt_pk_bf16_f32 v126, v32, v33
    v_cvt_pk_bf16_f32 v127, v34, v35
    v_pk_fma_f32 v[32:33], v[22:23], v[212:213], v[216:217]
    v_pk_fma_f32 v[36:37], v[22:23], v[220:221], v[224:225]
    v_pk_fma_f32 v[34:35], v[22:23], v[214:215], v[218:219]
    v_pk_fma_f32 v[38:39], v[22:23], v[222:223], v[226:227]
    v_pk_fma_f32 v[32:33], v[92:93], v[20:21], v[32:33]
    v_pk_fma_f32 v[36:37], v[96:97], v[20:21], v[36:37]
    v_pk_fma_f32 v[34:35], v[94:95], v[20:21], v[34:35]
    v_pk_fma_f32 v[38:39], v[98:99], v[20:21], v[38:39]
    v_pk_mul_f32 v[40:41], v[32:33], v[46:47]
    v_pk_mul_f32 v[42:43], v[34:35], v[46:47]
    v_exp_f32 v40, v40
    v_exp_f32 v41, v41
    v_exp_f32 v42, v42
    v_exp_f32 v43, v43
    v_pk_mul_f32 v[32:33], v[32:33], v[36:37]
    v_pk_mul_f32 v[34:35], v[34:35], v[38:39]
    v_pk_add_f32 v[40:41], v[40:41], v[48:49]
    v_pk_add_f32 v[42:43], v[42:43], v[48:49]
    v_rcp_f32 v40, v40
    v_rcp_f32 v41, v41
    v_rcp_f32 v42, v42
    v_rcp_f32 v43, v43
    s_nop 0
    v_pk_mul_f32 v[32:33], v[32:33], v[40:41]
    v_pk_mul_f32 v[34:35], v[34:35], v[42:43]
    v_cvt_pk_bf16_f32 v128, v32, v33
    v_cvt_pk_bf16_f32 v129, v34, v35
    v_permlane32_swap_b32 v124, v126
    v_permlane32_swap_b32 v125, v127
    buffer_store_dwordx4 v[124:127], v2, s[8:11], s71 offen offset:0 sc1
    v_mov_b32 v130, v128
    v_mov_b32 v131, v129
    s_nop 0
    v_permlane32_swap_b32 v128, v130
    v_permlane32_swap_b32 v129, v131
    s_mov_b32 exec_hi, 0
    buffer_store_dwordx4 v[128:131], v2, s[8:11], s71 offen offset:1024 sc1
    s_mov_b64 exec, -1
    s_lshl_b32 s70, s60, 2
    s_add_u32 s70, s70, 28672
    v_mov_b32 v255, s66
    s_waitcnt vmcnt(0)
    s_barrier
    s_cmp_lg_u32 s65, 0
    s_cbranch_scc1 Lwf_173
    s_mov_b64 exec, 1
    buffer_store_dword v255, v1, s[8:11], s70 offen sc1
    s_mov_b64 exec, -1
Lwf_173:
Lp4e_122:
    s_mul_i32 s80, s28, 54
    s_mul_i32 s72, s97, 27
    s_add_u32 s80, s80, s72
    s_lshl_b32 s80, s80, 10
    s_add_u32 s80, s80, 7340032
    s_mul_i32 s72, s97, 20480
    v_lshrrev_b32 v33, 5, v1
    v_bfe_u32 v34, v1, 4, 1
    v_lshlrev_b32 v33, 4, v33
    v_lshl_add_u32 v33, v34, 2, v33
    v_bfe_u32 v34, v1, 2, 2
    v_add_u32 v33, v33, v34
    v_mul_u32_u24 v33, 160, v33
    v_and_b32 v34, 3, v1
    v_lshl_add_u32 v33, v34, 3, v33
    v_add_u32 v33, s72, v33
    s_lshl_b32 s83, s61, 4
    s_cmp_lg_u32 s65, 7
    s_cbranch_scc1 Lwp_174
    s_lshl_b32 s71, s83, 2
    s_add_u32 s71, s71, 28672
    v_lshlrev_b32 v40, 2, v1
    s_mov_b32 exec_lo, 65535
    s_mov_b32 exec_hi, 0
    s_mov_b32 s90, 0
    buffer_load_dword v41, v40, s[8:11], s71 offen sc1
Lpoll_175:
    buffer_load_dword v42, v40, s[8:11], s71 offen sc1
    s_waitcnt vmcnt(1)
    v_cmp_ne_u32 vcc, s66, v41
    s_nop 4
    s_cbranch_vccz Lpdone_176
    buffer_load_dword v41, v40, s[8:11], s71 offen sc1
    s_waitcnt vmcnt(1)
    v_cmp_ne_u32 vcc, s66, v42
    s_nop 4
    s_cbranch_vccz Lpdone_176
    s_add_u32 s90, s90, 1
    s_cmp_lt_u32 s90, 400000
    s_cbranch_scc1 Lpoll_175
    v_mov_b32 v254, 8
    v_mov_b32 v255, 0
    s_mov_b32 s20, s56
    s_mov_b32 s21, s57
    s_mov_b32 s22, 256
    s_mov_b32 s23, 0x20000
    buffer_store_dword v254, v255, s[20:23], 0 offen
Lpdone_176:
    s_mov_b64 exec, -1
Lwp_174:
    s_barrier
    s_add_u32 s71, s80, 0
    buffer_load_dwordx4 v[128:131], v2, s[8:11], s71 offen offset:0 sc1
    buffer_load_dwordx4 v[132:135], v2, s[8:11], s71 offen offset:1024 sc1
    buffer_load_dwordx4 v[136:139], v2, s[8:11], s71 offen offset:2048 sc1
    buffer_load_dwordx4 v[140:143], v2, s[8:11], s71 offen offset:3072 sc1
    s_add_u32 s71, s80, 4096
    buffer_load_dwordx4 v[144:147], v2, s[8:11], s71 offen offset:0 sc1
    buffer_load_dwordx4 v[148:151], v2, s[8:11], s71 offen offset:1024 sc1
    buffer_load_dwordx4 v[152:155], v2, s[8:11], s71 offen offset:2048 sc1
    buffer_load_dwordx4 v[156:159], v2, s[8:11], s71 offen offset:3072 sc1
    s_add_u32 s71, s80, 8192
    buffer_load_dwordx4 v[160:163], v2, s[8:11], s71 offen offset:0 sc1
    buffer_load_dwordx4 v[164:167], v2, s[8:11], s71 offen offset:1024 sc1
    buffer_load_dwordx4 v[168:171], v2, s[8:11], s71 offen offset:2048 sc1
    buffer_load_dwordx4 v[172:175], v2, s[8:11], s71 offen offset:3072 sc1
    s_waitcnt vmcnt(8)
    s_barrier
    v_add_u32 v34, 65536, v33
    ds_read_b64_tr_b16 v[64:65], v34 offset:0
    ds_read_b64_tr_b16 v[66:67], v34 offset:1280
    ds_read_b64_tr_b16 v[68:69], v34 offset:32
    ds_read_b64_tr_b16 v[70:71], v34 offset:1312
    ds_read_b64_tr_b16 v[72:73], v34 offset:64
    ds_read_b64_tr_b16 v[74:75], v34 offset:1344
    ds_read_b64_tr_b16 v[76:77], v34 offset:96
    ds_read_b64_tr_b16 v[78:79], v34 offset:1376
    ds_read_b64_tr_b16 v[80:81], v34 offset:128
    ds_read_b64_tr_b16 v[82:83], v34 offset:1408
    s_waitcnt lgkmcnt(0)
    v_mfma_f32_16x16x32_bf16 v[8:11], v[64:67], v[128:131], 0
    ds_read_b64_tr_b16 v[84:85], v34 offset:5120
    ds_read_b64_tr_b16 v[86:87], v34 offset:6400
    v_mfma_f32_16x16x32_bf16 v[12:15], v[68:71], v[128:131], 0
    ds_read_b64_tr_b16 v[88:89], v34 offset:5152
    ds_read_b64_tr_b16 v[90:91], v34 offset:6432
    v_mfma_f32_16x16x32_bf16 v[16:19], v[72:75], v[128:131], 0
    ds_read_b64_tr_b16 v[92:93], v34 offset:5184
    ds_read_b64_tr_b16 v[94:95], v34 offset:6464
    v_mfma_f32_16x16x32_bf16 v[20:23], v[76:79], v[128:131], 0
    ds_read_b64_tr_b16 v[96:97], v34 offset:5216
    ds_read_b64_tr_b16 v[98:99], v34 offset:6496
    v_mfma_f32_16x16x32_bf16 v[24:27], v[80:83], v[128:131], 0
    ds_read_b64_tr_b16 v[100:101], v34 offset:5248
    ds_read_b64_tr_b16 v[102:103], v34 offset:6528
    s_waitcnt lgkmcnt(0)
    v_mfma_f32_16x16x32_bf16 v[8:11], v[84:87], v[132:135], v[8:11]
    ds_read_b64_tr_b16 v[64:65], v34 offset:10240
    ds_read_b64_tr_b16 v[66:67], v34 offset:11520
    v_mfma_f32_16x16x32_bf16 v[12:15], v[88:91], v[132:135], v[12:15]
    ds_read_b64_tr_b16 v[68:69], v34 offset:10272
    ds_read_b64_tr_b16 v[70:71], v34 offset:11552
    v_mfma_f32_16x16x32_bf16 v[16:19], v[92:95], v[132:135], v[16:19]
    ds_read_b64_tr_b16 v[72:73], v34 offset:10304
    ds_read_b64_tr_b16 v[74:75], v34 offset:11584
    v_mfma_f32_16x16x32_bf16 v[20:23], v[96:99], v[132:135], v[20:23]
    ds_read_b64_tr_b16 v[76:77], v34 offset:10336
    ds_read_b64_tr_b16 v[78:79], v34 offset:11616
    v_mfma_f32_16x16x32_bf16 v[24:27], v[100:103], v[132:135], v[24:27]
    ds_read_b64_tr_b16 v[80:81], v34 offset:10368
    ds_read_b64_tr_b16 v[82:83], v34 offset:11648
    s_waitcnt lgkmcnt(0)
    v_mfma_f32_16x16x32_bf16 v[8:11], v[64:67], v[136:139], v[8:11]
    ds_read_b64_tr_b16 v[84:85], v34 offset:15360
    ds_read_b64_tr_b16 v[86:87], v34 offset:16640
    v_mfma_f32_16x16x32_bf16 v[12:15], v[68:71], v[136:139], v[12:15]
    ds_read_b64_tr_b16 v[88:89], v34 offset:15392
    ds_read_b64_tr_b16 v[90:91], v34 offset:16672
    v_mfma_f32_16x16x32_bf16 v[16:19], v[72:75], v[136:139], v[16:19]
    ds_read_b64_tr_b16 v[92:93], v34 offset:15424
    ds_read_b64_tr_b16 v[94:95], v34 offset:16704
    v_mfma_f32_16x16x32_bf16 v[20:23], v[76:79], v[136:139], v[20:23]
    ds_read_b64_tr_b16 v[96:97], v34 offset:15456
    ds_read_b64_tr_b16 v[98:99], v34 offset:16736
    v_mfma_f32_16x16x32_bf16 v[24:27], v[80:83], v[136:139], v[24:27]
    ds_read_b64_tr_b16 v[100:101], v34 offset:15488
    ds_read_b64_tr_b16 v[102:103], v34 offset:16768
    s_waitcnt lgkmcnt(0)
    v_mfma_f32_16x16x32_bf16 v[8:11], v[84:87], v[140:143], v[8:11]
    s_add_u32 s71, s80, 12288
    v_mfma_f32_16x16x32_bf16 v[12:15], v[88:91], v[140:143], v[12:15]
    buffer_load_dwordx4 v[128:131], v2, s[8:11], s71 offen offset:0 sc1
    v_mfma_f32_16x16x32_bf16 v[16:19], v[92:95], v[140:143], v[16:19]
    buffer_load_dwordx4 v[132:135], v2, s[8:11], s71 offen offset:1024 sc1
    v_mfma_f32_16x16x32_bf16 v[20:23], v[96:99], v[140:143], v[20:23]
    buffer_load_dwordx4 v[136:139], v2, s[8:11], s71 offen offset:2048 sc1
    v_mfma_f32_16x16x32_bf16 v[24:27], v[100:103], v[140:143], v[24:27]
    buffer_load_dwordx4 v[140:143], v2, s[8:11], s71 offen offset:3072 sc1
    s_waitcnt vmcnt(8)
    s_barrier
    v_add_u32 v34, 110592, v33
    ds_read_b64_tr_b16 v[64:65], v34 offset:0
    ds_read_b64_tr_b16 v[66:67], v34 offset:1280
    ds_read_b64_tr_b16 v[68:69], v34 offset:32
    ds_read_b64_tr_b16 v[70:71], v34 offset:1312
    ds_read_b64_tr_b16 v[72:73], v34 offset:64
    ds_read_b64_tr_b16 v[74:75], v34 offset:1344
    ds_read_b64_tr_b16 v[76:77], v34 offset:96
    ds_read_b64_tr_b16 v[78:79], v34 offset:1376
    ds_read_b64_tr_b16 v[80:81], v34 offset:128
    ds_read_b64_tr_b16 v[82:83], v34 offset:1408
    s_waitcnt lgkmcnt(0)
    v_mfma_f32_16x16x32_bf16 v[8:11], v[64:67], v[144:147], v[8:11]
    ds_read_b64_tr_b16 v[84:85], v34 offset:5120
    ds_read_b64_tr_b16 v[86:87], v34 offset:6400
    ds_read_b64_tr_b16 v[88:89], v34 offset:5152
    v_mfma_f32_16x16x32_bf16 v[12:15], v[68:71], v[144:147], v[12:15]
    ds_read_b64_tr_b16 v[90:91], v34 offset:6432
    ds_read_b64_tr_b16 v[92:93], v34 offset:5184
    ds_read_b64_tr_b16 v[94:95], v34 offset:6464
    ds_read_b64_tr_b16 v[96:97], v34 offset:5216
    v_mfma_f32_16x16x32_bf16 v[16:19], v[72:75], v[144:147], v[16:19]
    ds_read_b64_tr_b16 v[98:99], v34 offset:6496
    ds_read_b64_tr_b16 v[100:101], v34 offset:5248
    ds_read_b64_tr_b16 v[102:103], v34 offset:6528
    s_add_u32 s73, s76, 61440
    v_mfma_f32_16x16x32_bf16 v[20:23], v[76:79], v[144:147], v[20:23]
    s_add_u32 m0, s77, 65536
    s_nop 0
    buffer_load_dwordx4 v2, s[8:11], s73 offen offset:0 sc1 lds
    buffer_load_dwordx4 v2, s[8:11], s73 offen offset:1024 sc1 lds
    buffer_load_dwordx4 v2, s[8:11], s73 offen offset:2048 sc1 lds
    v_mfma_f32_16x16x32_bf16 v[24:27], v[80:83], v[144:147], v[24:27]
    buffer_load_dwordx4 v2, s[8:11], s73 offen offset:3072 sc1 lds
    s_add_u32 s73, s73, 4096
    s_add_u32 m0, s77, 69632
    s_nop 0
    buffer_load_dwordx4 v2, s[8:11], s73 offen sc1 lds
    s_waitcnt lgkmcnt(0)
    v_mfma_f32_16x16x32_bf16 v[8:11], v[84:87], v[148:151], v[8:11]
    ds_read_b64_tr_b16 v[64:65], v34 offset:10240
    ds_read_b64_tr_b16 v[66:67], v34 offset:11520
    v_mfma_f32_16x16x32_bf16 v[12:15], v[88:91], v[148:151], v[12:15]
    ds_read_b64_tr_b16 v[68:69], v34 offset:10272
    ds_read_b64_tr_b16 v[70:71], v34 offset:11552
    v_mfma_f32_16x16x32_bf16 v[16:19], v[92:95], v[148:151], v[16:19]
    ds_read_b64_tr_b16 v[72:73], v34 offset:10304
    ds_read_b64_tr_b16 v[74:75], v34 offset:11584
    v_mfma_f32_16x16x32_bf16 v[20:23], v[96:99], v[148:151], v[20:23]
    ds_read_b64_tr_b16 v[76:77], v34 offset:10336
    ds_read_b64_tr_b16 v[78:79], v34 offset:11616
    v_mfma_f32_16x16x32_bf16 v[24:27], v[100:103], v[148:151], v[24:27]
    ds_read_b64_tr_b16 v[80:81], v34 offset:10368
    ds_read_b64_tr_b16 v[82:83], v34 offset:11648
    s_waitcnt lgkmcnt(0)
    v_mfma_f32_16x16x32_bf16 v[8:11], v[64:67], v[152:155], v[8:11]
    ds_read_b64_tr_b16 v[84:85], v34 offset:15360
    ds_read_b64_tr_b16 v[86:87], v34 offset:16640
    v_mfma_f32_16x16x32_bf16 v[12:15], v[68:71], v[152:155], v[12:15]
    ds_read_b64_tr_b16 v[88:89], v34 offset:15392
    ds_read_b64_tr_b16 v[90:91], v34 offset:16672
    v_mfma_f32_16x16x32_bf16 v[16:19], v[72:75], v[152:155], v[16:19]
    ds_read_b64_tr_b16 v[92:93], v34 offset:15424
    ds_read_b64_tr_b16 v[94:95], v34 offset:16704
    v_mfma_f32_16x16x32_bf16 v[20:23], v[76:79], v[152:155], v[20:23]
    ds_read_b64_tr_b16 v[96:97], v34 offset:15456
    ds_read_b64_tr_b16 v[98:99], v34 offset:16736
    v_mfma_f32_16x16x32_bf16 v[24:27], v[80:83], v[152:155], v[24:27]
    ds_read_b64_tr_b16 v[100:101], v34 offset:15488
    ds_read_b64_tr_b16 v[102:103], v34 offset:16768
    s_waitcnt lgkmcnt(0)
    v_mfma_f32_16x16x32_bf16 v[8:11], v[84:87], v[156:159], v[8:11]
    s_add_u32 s71, s80, 16384
    v_mfma_f32_16x16x32_bf16 v[12:15], v[88:91], v[156:159], v[12:15]
    buffer_load_dwordx4 v[144:147], v2, s[8:11], s71 offen offset:0 sc1
    v_mfma_f32_16x16x32_bf16 v[16:19], v[92:95], v[156:159], v[16:19]
    buffer_load_dwordx4 v[148:151], v2, s[8:11], s71 offen offset:1024 sc1
    v_mfma_f32_16x16x32_bf16 v[20:23], v[96:99], v[156:159], v[20:23]
    buffer_load_dwordx4 v[152:155], v2, s[8:11], s71 offen offset:2048 sc1
    v_mfma_f32_16x16x32_bf16 v[24:27], v[100:103], v[156:159], v[24:27]
    buffer_load_dwordx4 v[156:159], v2, s[8:11], s71 offen offset:3072 sc1
    s_waitcnt vmcnt(13)
    s_barrier
    v_add_u32 v34, 20480, v33
    ds_read_b64_tr_b16 v[64:65], v34 offset:0
    ds_read_b64_tr_b16 v[66:67], v34 offset:1280
    ds_read_b64_tr_b16 v[68:69], v34 offset:32
    ds_read_b64_tr_b16 v[70:71], v34 offset:1312
    ds_read_b64_tr_b16 v[72:73], v34 offset:64
    ds_read_b64_tr_b16 v[74:75], v34 offset:1344
    ds_read_b64_tr_b16 v[76:77], v34 offset:96
    ds_read_b64_tr_b16 v[78:79], v34 offset:1376
    ds_read_b64_tr_b16 v[80:81], v34 offset:128
    ds_read_b64_tr_b16 v[82:83], v34 offset:1408
    s_waitcnt lgkmcnt(0)
    v_mfma_f32_16x16x32_bf16 v[8:11], v[64:67], v[160:163], v[8:11]
    ds_read_b64_tr_b16 v[84:85], v34 offset:5120
    ds_read_b64_tr_b16 v[86:87], v34 offset:6400
    ds_read_b64_tr_b16 v[88:89], v34 offset:5152
    v_mfma_f32_16x16x32_bf16 v[12:15], v[68:71], v[160:163], v[12:15]
    ds_read_b64_tr_b16 v[90:91], v34 offset:6432
    ds_read_b64_tr_b16 v[92:93], v34 offset:5184
    ds_read_b64_tr_b16 v[94:95], v34 offset:6464
    ds_read_b64_tr_b16 v[96:97], v34 offset:5216
    v_mfma_f32_16x16x32_bf16 v[16:19], v[72:75], v[160:163], v[16:19]
    ds_read_b64_tr_b16 v[98:99], v34 offset:6496
    ds_read_b64_tr_b16 v[100:101], v34 offset:5248
    ds_read_b64_tr_b16 v[102:103], v34 offset:6528
    s_add_u32 s73, s76, 81920
    v_mfma_f32_16x16x32_bf16 v[20:23], v[76:79], v[160:163], v[20:23]
    s_add_u32 m0, s77, 110592
    s_nop 0
    buffer_load_dwordx4 v2, s[8:11], s73 offen offset:0 sc1 lds
    buffer_load_dwordx4 v2, s[8:11], s73 offen offset:1024 sc1 lds
    buffer_load_dwordx4 v2, s[8:11], s73 offen offset:2048 sc1 lds
    v_mfma_f32_16x16x32_bf16 v[24:27], v[80:83], v[160:163], v[24:27]
    buffer_load_dwordx4 v2, s[8:11], s73 offen offset:3072 sc1 lds
    s_add_u32 s73, s73, 4096
    s_add_u32 m0, s77, 114688
    s_nop 0
    buffer_load_dwordx4 v2, s[8:11], s73 offen sc1 lds
    s_waitcnt lgkmcnt(0)
    v_mfma_f32_16x16x32_bf16 v[8:11], v[84:87], v[164:167], v[8:11]
    ds_read_b64_tr_b16 v[64:65], v34 offset:10240
    ds_read_b64_tr_b16 v[66:67], v34 offset:11520
    v_mfma_f32_16x16x32_bf16 v[12:15], v[88:91], v[164:167], v[12:15]
    ds_read_b64_tr_b16 v[68:69], v34 offset:10272
    ds_read_b64_tr_b16 v[70:71], v34 offset:11552
    v_mfma_f32_16x16x32_bf16 v[16:19], v[92:95], v[164:167], v[16:19]
    ds_read_b64_tr_b16 v[72:73], v34 offset:10304
    ds_read_b64_tr_b16 v[74:75], v34 offset:11584
    v_mfma_f32_16x16x32_bf16 v[20:23], v[96:99], v[164:167], v[20:23]
    ds_read_b64_tr_b16 v[76:77], v34 offset:10336
    ds_read_b64_tr_b16 v[78:79], v34 offset:11616
    v_mfma_f32_16x16x32_bf16 v[24:27], v[100:103], v[164:167], v[24:27]
    ds_read_b64_tr_b16 v[80:81], v34 offset:10368
    ds_read_b64_tr_b16 v[82:83], v34 offset:11648
    s_waitcnt lgkmcnt(0)
    v_mfma_f32_16x16x32_bf16 v[8:11], v[64:67], v[168:171], v[8:11]
    ds_read_b64_tr_b16 v[84:85], v34 offset:15360
    ds_read_b64_tr_b16 v[86:87], v34 offset:16640
    v_mfma_f32_16x16x32_bf16 v[12:15], v[68:71], v[168:171], v[12:15]
    ds_read_b64_tr_b16 v[88:89], v34 offset:15392
    ds_read_b64_tr_b16 v[90:91], v34 offset:16672
    v_mfma_f32_16x16x32_bf16 v[16:19], v[72:75], v[168:171], v[16:19]
    ds_read_b64_tr_b16 v[92:93], v34 offset:15424
    ds_read_b64_tr_b16 v[94:95], v34 offset:16704
    v_mfma_f32_16x16x32_bf16 v[20:23], v[76:79], v[168:171], v[20:23]
    ds_read_b64_tr_b16 v[96:97], v34 offset:15456
    ds_read_b64_tr_b16 v[98:99], v34 offset:16736
    v_mfma_f32_16x16x32_bf16 v[24:27], v[80:83], v[168:171], v[24:27]
    ds_read_b64_tr_b16 v[100:101], v34 offset:15488
    ds_read_b64_tr_b16 v[102:103], v34 offset:16768
    s_waitcnt lgkmcnt(0)
    v_mfma_f32_16x16x32_bf16 v[8:11], v[84:87], v[172:175], v[8:11]
    s_add_u32 s71, s80, 20480
    v_mfma_f32_16x16x32_bf16 v[12:15], v[88:91], v[172:175], v[12:15]
    buffer_load_dwordx4 v[160:163], v2, s[8:11], s71 offen offset:0 sc1
    v_mfma_f32_16x16x32_bf16 v[16:19], v[92:95], v[172:175], v[16:19]
    buffer_load_dwordx4 v[164:167], v2, s[8:11], s71 offen offset:1024 sc1
    v_mfma_f32_16x16x32_bf16 v[20:23], v[96:99], v[172:175], v[20:23]
    buffer_load_dwordx4 v[168:171], v2, s[8:11], s71 offen offset:2048 sc1
    v_mfma_f32_16x16x32_bf16 v[24:27], v[100:103], v[172:175], v[24:27]
    buffer_load_dwordx4 v[172:175], v2, s[8:11], s71 offen offset:3072 sc1
    s_waitcnt vmcnt(13)
    s_barrier
    v_add_u32 v34, 65536, v33
    ds_read_b64_tr_b16 v[64:65], v34 offset:0
    ds_read_b64_tr_b16 v[66:67], v34 offset:1280
    ds_read_b64_tr_b16 v[68:69], v34 offset:32
    ds_read_b64_tr_b16 v[70:71], v34 offset:1312
    ds_read_b64_tr_b16 v[72:73], v34 offset:64
    ds_read_b64_tr_b16 v[74:75], v34 offset:1344
    ds_read_b64_tr_b16 v[76:77], v34 offset:96
    ds_read_b64_tr_b16 v[78:79], v34 offset:1376
    ds_read_b64_tr_b16 v[80:81], v34 offset:128
    ds_read_b64_tr_b16 v[82:83], v34 offset:1408
    s_waitcnt lgkmcnt(0)
    v_mfma_f32_16x16x32_bf16 v[8:11], v[64:67], v[128:131], v[8:11]
    ds_read_b64_tr_b16 v[84:85], v34 offset:5120
    ds_read_b64_tr_b16 v[86:87], v34 offset:6400
    ds_read_b64_tr_b16 v[88:89], v34 offset:5152
    v_mfma_f32_16x16x32_bf16 v[12:15], v[68:71], v[128:131], v[12:15]
    ds_read_b64_tr_b16 v[90:91], v34 offset:6432
    ds_read_b64_tr_b16 v[92:93], v34 offset:5184
    ds_read_b64_tr_b16 v[94:95], v34 offset:6464
    ds_read_b64_tr_b16 v[96:97], v34 offset:5216
    v_mfma_f32_16x16x32_bf16 v[16:19], v[72:75], v[128:131], v[16:19]
    ds_read_b64_tr_b16 v[98:99], v34 offset:6496
    ds_read_b64_tr_b16 v[100:101], v34 offset:5248
    ds_read_b64_tr_b16 v[102:103], v34 offset:6528
    s_add_u32 s73, s76, 102400
    v_mfma_f32_16x16x32_bf16 v[20:23], v[76:79], v[128:131], v[20:23]
    s_add_u32 m0, s77, 20480
    s_nop 0
    buffer_load_dwordx4 v2, s[8:11], s73 offen offset:0 sc1 lds
    buffer_load_dwordx4 v2, s[8:11], s73 offen offset:1024 sc1 lds
    buffer_load_dwordx4 v2, s[8:11], s73 offen offset:2048 sc1 lds
    v_mfma_f32_16x16x32_bf16 v[24:27], v[80:83], v[128:131], v[24:27]
    buffer_load_dwordx4 v2, s[8:11], s73 offen offset:3072 sc1 lds
    s_add_u32 s73, s73, 4096
    s_add_u32 m0, s77, 24576
    s_nop 0
    buffer_load_dwordx4 v2, s[8:11], s73 offen sc1 lds
    s_waitcnt lgkmcnt(0)
    v_mfma_f32_16x16x32_bf16 v[8:11], v[84:87], v[132:135], v[8:11]
    ds_read_b64_tr_b16 v[64:65], v34 offset:10240
    ds_read_b64_tr_b16 v[66:67], v34 offset:11520
    v_mfma_f32_16x16x32_bf16 v[12:15], v[88:91], v[132:135], v[12:15]
    ds_read_b64_tr_b16 v[68:69], v34 offset:10272
    ds_read_b64_tr_b16 v[70:71], v34 offset:11552
    v_mfma_f32_16x16x32_bf16 v[16:19], v[92:95], v[132:135], v[16:19]
    ds_read_b64_tr_b16 v[72:73], v34 offset:10304
    ds_read_b64_tr_b16 v[74:75], v34 offset:11584
    v_mfma_f32_16x16x32_bf16 v[20:23], v[96:99], v[132:135], v[20:23]
    ds_read_b64_tr_b16 v[76:77], v34 offset:10336
    ds_read_b64_tr_b16 v[78:79], v34 offset:11616
    v_mfma_f32_16x16x32_bf16 v[24:27], v[100:103], v[132:135], v[24:27]
    ds_read_b64_tr_b16 v[80:81], v34 offset:10368
    ds_read_b64_tr_b16 v[82:83], v34 offset:11648
    s_waitcnt lgkmcnt(0)
    v_mfma_f32_16x16x32_bf16 v[8:11], v[64:67], v[136:139], v[8:11]
    ds_read_b64_tr_b16 v[84:85], v34 offset:15360
    ds_read_b64_tr_b16 v[86:87], v34 offset:16640
    v_mfma_f32_16x16x32_bf16 v[12:15], v[68:71], v[136:139], v[12:15]
    ds_read_b64_tr_b16 v[88:89], v34 offset:15392
    ds_read_b64_tr_b16 v[90:91], v34 offset:16672
    v_mfma_f32_16x16x32_bf16 v[16:19], v[72:75], v[136:139], v[16:19]
    ds_read_b64_tr_b16 v[92:93], v34 offset:15424
    ds_read_b64_tr_b16 v[94:95], v34 offset:16704
    v_mfma_f32_16x16x32_bf16 v[20:23], v[76:79], v[136:139], v[20:23]
    ds_read_b64_tr_b16 v[96:97], v34 offset:15456
    ds_read_b64_tr_b16 v[98:99], v34 offset:16736
    v_mfma_f32_16x16x32_bf16 v[24:27], v[80:83], v[136:139], v[24:27]
    ds_read_b64_tr_b16 v[100:101], v34 offset:15488
    ds_read_b64_tr_b16 v[102:103], v34 offset:16768
    s_waitcnt lgkmcnt(0)
    v_mfma_f32_16x16x32_bf16 v[8:11], v[84:87], v[140:143], v[8:11]
    v_mfma_f32_16x16x32_bf16 v[12:15], v[88:91], v[140:143], v[12:15]
    s_add_u32 s71, s80, 24576
    v_mfma_f32_16x16x32_bf16 v[16:19], v[92:95], v[140:143], v[16:19]
    buffer_load_dwordx4 v[128:131], v2, s[8:11], s71 offen offset:0 sc1
    v_mfma_f32_16x16x32_bf16 v[20:23], v[96:99], v[140:143], v[20:23]
    buffer_load_dwordx4 v[132:135], v2, s[8:11], s71 offen offset:1024 sc1
    v_mfma_f32_16x16x32_bf16 v[24:27], v[100:103], v[140:143], v[24:27]
    buffer_load_dwordx4 v[136:139], v2, s[8:11], s71 offen offset:2048 sc1
    s_waitcnt vmcnt(12)
    s_barrier
    v_add_u32 v34, 110592, v33
    ds_read_b64_tr_b16 v[64:65], v34 offset:0
    ds_read_b64_tr_b16 v[66:67], v34 offset:1280
    ds_read_b64_tr_b16 v[68:69], v34 offset:32
    ds_read_b64_tr_b16 v[70:71], v34 offset:1312
    ds_read_b64_tr_b16 v[72:73], v34 offset:64
    ds_read_b64_tr_b16 v[74:75], v34 offset:1344
    ds_read_b64_tr_b16 v[76:77], v34 offset:96
    ds_read_b64_tr_b16 v[78:79], v34 offset:1376
    ds_read_b64_tr_b16 v[80:81], v34 offset:128
    ds_read_b64_tr_b16 v[82:83], v34 offset:1408
    s_waitcnt lgkmcnt(0)
    v_mfma_f32_16x16x32_bf16 v[8:11], v[64:67], v[144:147], v[8:11]
    ds_read_b64_tr_b16 v[84:85], v34 offset:5120
    ds_read_b64_tr_b16 v[86:87], v34 offset:6400
    ds_read_b64_tr_b16 v[88:89], v34 offset:5152
    v_mfma_f32_16x16x32_bf16 v[12:15], v[68:71], v[144:147], v[12:15]
    ds_read_b64_tr_b16 v[90:91], v34 offset:6432
    ds_read_b64_tr_b16 v[92:93], v34 offset:5184
    ds_read_b64_tr_b16 v[94:95], v34 offset:6464
    ds_read_b64_tr_b16 v[96:97], v34 offset:5216
    v_mfma_f32_16x16x32_bf16 v[16:19], v[72:75], v[144:147], v[16:19]
    ds_read_b64_tr_b16 v[98:99], v34 offset:6496
    ds_read_b64_tr_b16 v[100:101], v34 offset:5248
    ds_read_b64_tr_b16 v[102:103], v34 offset:6528
    s_add_u32 s73, s76, 122880
    v_mfma_f32_16x16x32_bf16 v[20:23], v[76:79], v[144:147], v[20:23]
    s_add_u32 m0, s77, 65536
    s_nop 0
    buffer_load_dwordx4 v2, s[8:11], s73 offen offset:0 sc1 lds
    buffer_load_dwordx4 v2, s[8:11], s73 offen offset:1024 sc1 lds
    buffer_load_dwordx4 v2, s[8:11], s73 offen offset:2048 sc1 lds
    v_mfma_f32_16x16x32_bf16 v[24:27], v[80:83], v[144:147], v[24:27]
    buffer_load_dwordx4 v2, s[8:11], s73 offen offset:3072 sc1 lds
    s_add_u32 s73, s73, 4096
    s_add_u32 m0, s77, 69632
    s_nop 0
    buffer_load_dwordx4 v2, s[8:11], s73 offen sc1 lds
    s_waitcnt lgkmcnt(0)
    v_mfma_f32_16x16x32_bf16 v[8:11], v[84:87], v[148:151], v[8:11]
    ds_read_b64_tr_b16 v[64:65], v34 offset:10240
    ds_read_b64_tr_b16 v[66:67], v34 offset:11520
    v_mfma_f32_16x16x32_bf16 v[12:15], v[88:91], v[148:151], v[12:15]
    ds_read_b64_tr_b16 v[68:69], v34 offset:10272
    ds_read_b64_tr_b16 v[70:71], v34 offset:11552
    v_mfma_f32_16x16x32_bf16 v[16:19], v[92:95], v[148:151], v[16:19]
    ds_read_b64_tr_b16 v[72:73], v34 offset:10304
    ds_read_b64_tr_b16 v[74:75], v34 offset:11584
    v_mfma_f32_16x16x32_bf16 v[20:23], v[96:99], v[148:151], v[20:23]
    ds_read_b64_tr_b16 v[76:77], v34 offset:10336
    ds_read_b64_tr_b16 v[78:79], v34 offset:11616
    v_mfma_f32_16x16x32_bf16 v[24:27], v[100:103], v[148:151], v[24:27]
    ds_read_b64_tr_b16 v[80:81], v34 offset:10368
    ds_read_b64_tr_b16 v[82:83], v34 offset:11648
    s_waitcnt lgkmcnt(0)
    v_mfma_f32_16x16x32_bf16 v[8:11], v[64:67], v[152:155], v[8:11]
    ds_read_b64_tr_b16 v[84:85], v34 offset:15360
    ds_read_b64_tr_b16 v[86:87], v34 offset:16640
    v_mfma_f32_16x16x32_bf16 v[12:15], v[68:71], v[152:155], v[12:15]
    ds_read_b64_tr_b16 v[88:89], v34 offset:15392
    ds_read_b64_tr_b16 v[90:91], v34 offset:16672
    v_mfma_f32_16x16x32_bf16 v[16:19], v[72:75], v[152:155], v[16:19]
    ds_read_b64_tr_b16 v[92:93], v34 offset:15424
    ds_read_b64_tr_b16 v[94:95], v34 offset:16704
    v_mfma_f32_16x16x32_bf16 v[20:23], v[76:79], v[152:155], v[20:23]
    ds_read_b64_tr_b16 v[96:97], v34 offset:15456
    ds_read_b64_tr_b16 v[98:99], v34 offset:16736
    v_mfma_f32_16x16x32_bf16 v[24:27], v[80:83], v[152:155], v[24:27]
    ds_read_b64_tr_b16 v[100:101], v34 offset:15488
    ds_read_b64_tr_b16 v[102:103], v34 offset:16768
    s_waitcnt lgkmcnt(0)
    v_mfma_f32_16x16x32_bf16 v[8:11], v[84:87], v[156:159], v[8:11]
    v_mfma_f32_16x16x32_bf16 v[12:15], v[88:91], v[156:159], v[12:15]
    v_mfma_f32_16x16x32_bf16 v[16:19], v[92:95], v[156:159], v[16:19]
    v_mfma_f32_16x16x32_bf16 v[20:23], v[96:99], v[156:159], v[20:23]
    v_mfma_f32_16x16x32_bf16 v[24:27], v[100:103], v[156:159], v[24:27]
    s_waitcnt vmcnt(8)
    s_barrier
    v_add_u32 v34, 20480, v33
    ds_read_b64_tr_b16 v[64:65], v34 offset:0
    ds_read_b64_tr_b16 v[66:67], v34 offset:1280
    ds_read_b64_tr_b16 v[68:69], v34 offset:32
    ds_read_b64_tr_b16 v[70:71], v34 offset:1312
    ds_read_b64_tr_b16 v[72:73], v34 offset:64
    ds_read_b64_tr_b16 v[74:75], v34 offset:1344
    ds_read_b64_tr_b16 v[76:77], v34 offset:96
    ds_read_b64_tr_b16 v[78:79], v34 offset:1376
    ds_read_b64_tr_b16 v[80:81], v34 offset:128
    ds_read_b64_tr_b16 v[82:83], v34 offset:1408
    s_waitcnt lgkmcnt(0)
    v_mfma_f32_16x16x32_bf16 v[8:11], v[64:67], v[160:163], v[8:11]
    ds_read_b64_tr_b16 v[84:85], v34 offset:5120
    ds_read_b64_tr_b16 v[86:87], v34 offset:6400
    v_mfma_f32_16x16x32_bf16 v[12:15], v[68:71], v[160:163], v[12:15]
    ds_read_b64_tr_b16 v[88:89], v34 offset:5152
    ds_read_b64_tr_b16 v[90:91], v34 offset:6432
    v_mfma_f32_16x16x32_bf16 v[16:19], v[72:75], v[160:163], v[16:19]
    ds_read_b64_tr_b16 v[92:93], v34 offset:5184
    ds_read_b64_tr_b16 v[94:95], v34 offset:6464
    v_mfma_f32_16x16x32_bf16 v[20:23], v[76:79], v[160:163], v[20:23]
    ds_read_b64_tr_b16 v[96:97], v34 offset:5216
    ds_read_b64_tr_b16 v[98:99], v34 offset:6496
    v_mfma_f32_16x16x32_bf16 v[24:27], v[80:83], v[160:163], v[24:27]
    ds_read_b64_tr_b16 v[100:101], v34 offset:5248
    ds_read_b64_tr_b16 v[102:103], v34 offset:6528
    s_waitcnt lgkmcnt(0)
    v_mfma_f32_16x16x32_bf16 v[8:11], v[84:87], v[164:167], v[8:11]
    ds_read_b64_tr_b16 v[64:65], v34 offset:10240
    ds_read_b64_tr_b16 v[66:67], v34 offset:11520
    v_mfma_f32_16x16x32_bf16 v[12:15], v[88:91], v[164:167], v[12:15]
    ds_read_b64_tr_b16 v[68:69], v34 offset:10272
    ds_read_b64_tr_b16 v[70:71], v34 offset:11552
    v_mfma_f32_16x16x32_bf16 v[16:19], v[92:95], v[164:167], v[16:19]
    ds_read_b64_tr_b16 v[72:73], v34 offset:10304
    ds_read_b64_tr_b16 v[74:75], v34 offset:11584
    v_mfma_f32_16x16x32_bf16 v[20:23], v[96:99], v[164:167], v[20:23]
    ds_read_b64_tr_b16 v[76:77], v34 offset:10336
    ds_read_b64_tr_b16 v[78:79], v34 offset:11616
    v_mfma_f32_16x16x32_bf16 v[24:27], v[100:103], v[164:167], v[24:27]
    ds_read_b64_tr_b16 v[80:81], v34 offset:10368
    ds_read_b64_tr_b16 v[82:83], v34 offset:11648
    s_waitcnt lgkmcnt(0)
    v_mfma_f32_16x16x32_bf16 v[8:11], v[64:67], v[168:171], v[8:11]
    ds_read_b64_tr_b16 v[84:85], v34 offset:15360
    ds_read_b64_tr_b16 v[86:87], v34 offset:16640
    v_mfma_f32_16x16x32_bf16 v[12:15], v[68:71], v[168:171], v[12:15]
    ds_read_b64_tr_b16 v[88:89], v34 offset:15392
    ds_read_b64_tr_b16 v[90:91], v34 offset:16672
    v_mfma_f32_16x16x32_bf16 v[16:19], v[72:75], v[168:171], v[16:19]
    ds_read_b64_tr_b16 v[92:93], v34 offset:15424
    ds_read_b64_tr_b16 v[94:95], v34 offset:16704
    v_mfma_f32_16x16x32_bf16 v[20:23], v[76:79], v[168:171], v[20:23]
    ds_read_b64_tr_b16 v[96:97], v34 offset:15456
    ds_read_b64_tr_b16 v[98:99], v34 offset:16736
    v_mfma_f32_16x16x32_bf16 v[24:27], v[80:83], v[168:171], v[24:27]
    ds_read_b64_tr_b16 v[100:101], v34 offset:15488
    ds_read_b64_tr_b16 v[102:103], v34 offset:16768
    s_waitcnt lgkmcnt(0)
    v_mfma_f32_16x16x32_bf16 v[8:11], v[84:87], v[172:175], v[8:11]
    v_mfma_f32_16x16x32_bf16 v[12:15], v[88:91], v[172:175], v[12:15]
    v_mfma_f32_16x16x32_bf16 v[16:19], v[92:95], v[172:175], v[16:19]
    v_mfma_f32_16x16x32_bf16 v[20:23], v[96:99], v[172:175], v[20:23]
    v_mfma_f32_16x16x32_bf16 v[24:27], v[100:103], v[172:175], v[24:27]
    s_waitcnt vmcnt(0)
    s_barrier
    v_add_u32 v34, 65536, v33
    ds_read_b64_tr_b16 v[64:65], v34 offset:0
    ds_read_b64_tr_b16 v[66:67], v34 offset:1280
    ds_read_b64_tr_b16 v[68:69], v34 offset:32
    ds_read_b64_tr_b16 v[70:71], v34 offset:1312
    ds_read_b64_tr_b16 v[72:73], v34 offset:64
    ds_read_b64_tr_b16 v[74:75], v34 offset:1344
    ds_read_b64_tr_b16 v[76:77], v34 offset:96
    ds_read_b64_tr_b16 v[78:79], v34 offset:1376
    ds_read_b64_tr_b16 v[80:81], v34 offset:128
    ds_read_b64_tr_b16 v[82:83], v34 offset:1408
    s_waitcnt lgkmcnt(0)
    v_mfma_f32_16x16x32_bf16 v[8:11], v[64:67], v[128:131], v[8:11]
    ds_read_b64_tr_b16 v[84:85], v34 offset:5120
    ds_read_b64_tr_b16 v[86:87], v34 offset:6400
    v_mfma_f32_16x16x32_bf16 v[12:15], v[68:71], v[128:131], v[12:15]
    ds_read_b64_tr_b16 v[88:89], v34 offset:5152
    ds_read_b64_tr_b16 v[90:91], v34 offset:6432
    v_mfma_f32_16x16x32_bf16 v[16:19], v[72:75], v[128:131], v[16:19]
    ds_read_b64_tr_b16 v[92:93], v34 offset:5184
    ds_read_b64_tr_b16 v[94:95], v34 offset:6464
    v_mfma_f32_16x16x32_bf16 v[20:23], v[76:79], v[128:131], v[20:23]
    ds_read_b64_tr_b16 v[96:97], v34 offset:5216
    ds_read_b64_tr_b16 v[98:99], v34 offset:6496
    v_mfma_f32_16x16x32_bf16 v[24:27], v[80:83], v[128:131], v[24:27]
    ds_read_b64_tr_b16 v[100:101], v34 offset:5248
    ds_read_b64_tr_b16 v[102:103], v34 offset:6528
    s_waitcnt lgkmcnt(0)
    v_mfma_f32_16x16x32_bf16 v[8:11], v[84:87], v[132:135], v[8:11]
    ds_read_b64_tr_b16 v[64:65], v34 offset:10240
    ds_read_b64_tr_b16 v[66:67], v34 offset:11520
    v_mfma_f32_16x16x32_bf16 v[12:15], v[88:91], v[132:135], v[12:15]
    ds_read_b64_tr_b16 v[68:69], v34 offset:10272
    ds_read_b64_tr_b16 v[70:71], v34 offset:11552
    v_mfma_f32_16x16x32_bf16 v[16:19], v[92:95], v[132:135], v[16:19]
    ds_read_b64_tr_b16 v[72:73], v34 offset:10304
    ds_read_b64_tr_b16 v[74:75], v34 offset:11584
    v_mfma_f32_16x16x32_bf16 v[20:23], v[96:99], v[132:135], v[20:23]
    ds_read_b64_tr_b16 v[76:77], v34 offset:10336
    ds_read_b64_tr_b16 v[78:79], v34 offset:11616
    v_mfma_f32_16x16x32_bf16 v[24:27], v[100:103], v[132:135], v[24:27]
    ds_read_b64_tr_b16 v[80:81], v34 offset:10368
    ds_read_b64_tr_b16 v[82:83], v34 offset:11648
    s_waitcnt lgkmcnt(0)
    v_mfma_f32_16x16x32_bf16 v[8:11], v[64:67], v[136:139], v[8:11]
    v_mfma_f32_16x16x32_bf16 v[12:15], v[68:71], v[136:139], v[12:15]
    v_mfma_f32_16x16x32_bf16 v[16:19], v[72:75], v[136:139], v[16:19]
    v_mfma_f32_16x16x32_bf16 v[20:23], v[76:79], v[136:139], v[20:23]
    v_mfma_f32_16x16x32_bf16 v[24:27], v[80:83], v[136:139], v[24:27]
    s_mul_i32 s70, s69, 5120
    s_add_u32 s70, s70, 0
    v_add_u32 v40, s70, v2
    s_cmp_lg_u32 s97, 0
    s_cbranch_scc1 Lex_177
    s_nop 1
    ds_write_b128 v40, v[20:23] offset:3072
    ds_write_b128 v40, v[24:27] offset:4096
    s_waitcnt lgkmcnt(0)
    s_barrier
    ds_read_b128 v[44:47], v40 offset:0
    ds_read_b128 v[48:51], v40 offset:1024
    ds_read_b128 v[52:55], v40 offset:2048
    s_waitcnt lgkmcnt(0)
    v_add_f32 v8, v8, v44
    v_add_f32 v9, v9, v45
    v_add_f32 v10, v10, v46
    v_add_f32 v11, v11, v47
    v_add_f32 v12, v12, v48
    v_add_f32 v13, v13, v49
    v_add_f32 v14, v14, v50
    v_add_f32 v15, v15, v51
    v_add_f32 v16, v16, v52
    v_add_f32 v17, v17, v53
    v_add_f32 v18, v18, v54
    v_add_f32 v19, v19, v55
    s_branch Lex_178
Lex_177:
    ds_write_b128 v40, v[8:11] offset:0
    ds_write_b128 v40, v[12:15] offset:1024
    ds_write_b128 v40, v[16:19] offset:2048
    s_waitcnt lgkmcnt(0)
    s_barrier
    ds_read_b128 v[56:59], v40 offset:3072
    ds_read_b128 v[60:63], v40 offset:4096
    s_waitcnt lgkmcnt(0)
    v_add_f32 v20, v20, v56
    v_add_f32 v21, v21, v57
    v_add_f32 v22, v22, v58
    v_add_f32 v23, v23, v59
    v_add_f32 v24, v24, v60
    v_add_f32 v25, v25, v61
    v_add_f32 v26, v26, v62
    v_add_f32 v27, v27, v63
Lex_178:
    s_cmp_lg_u32 s97, 0
    s_cbranch_scc1 Lp5e_179
    v_fma_f32 v40, v228, v8, v240
    v_fma_f32 v41, v229, v9, v241
    v_fma_f32 v42, v230, v10, v242
    v_fma_f32 v43, v231, v11, v243
    v_cvt_pk_bf16_f32 v44, v40, v41
    v_cvt_pk_bf16_f32 v45, v42, v43
    buffer_store_dwordx2 v[44:45], v253, s[24:27], s30 offen offset:0
    v_fma_f32 v40, v232, v12, v244
    v_fma_f32 v41, v233, v13, v245
    v_fma_f32 v42, v234, v14, v246
    v_fma_f32 v43, v235, v15, v247
    v_cvt_pk_bf16_f32 v46, v40, v41
    v_cvt_pk_bf16_f32 v47, v42, v43
    buffer_store_dwordx2 v[46:47], v253, s[24:27], s30 offen offset:32
    v_fma_f32 v40, v236, v16, v248
    v_fma_f32 v41, v237, v17, v249
    v_fma_f32 v42, v238, v18, v250
    v_fma_f32 v43, v239, v19, v251
    v_cvt_pk_bf16_f32 v48, v40, v41
    v_cvt_pk_bf16_f32 v49, v42, v43
    buffer_store_dwordx2 v[48:49], v253, s[24:27], s30 offen offset:64
    s_branch Lp5e_180
Lp5e_179:
    v_fma_f32 v40, v228, v20, v240
    v_fma_f32 v41, v229, v21, v241
    v_fma_f32 v42, v230, v22, v242
    v_fma_f32 v43, v231, v23, v243
    v_cvt_pk_bf16_f32 v44, v40, v41
    v_cvt_pk_bf16_f32 v45, v42, v43
    buffer_store_dwordx2 v[44:45], v253, s[24:27], s30 offen offset:0
    v_fma_f32 v40, v232, v24, v244
    v_fma_f32 v41, v233, v25, v245
    v_fma_f32 v42, v234, v26, v246
    v_fma_f32 v43, v235, v27, v247
    v_cvt_pk_bf16_f32 v46, v40, v41
    v_cvt_pk_bf16_f32 v47, v42, v43
    buffer_store_dwordx2 v[46:47], v253, s[24:27], s30 offen offset:32
Lp5e_180:
    s_waitcnt vmcnt(0) lgkmcnt(0)
L_END:
    s_endpgm
.section .rodata,"a"
.p2align 6
.amdhsa_kernel adaLN_cond__grouped_kv_mqa__glu_gated_swiglu__prompt_kernel
  .amdhsa_next_free_vgpr 256
  .amdhsa_next_free_sgpr 102
  .amdhsa_accum_offset 256
  .amdhsa_group_segment_fixed_size 0
  .amdhsa_kernarg_size 112
  .amdhsa_user_sgpr_count 2
  .amdhsa_user_sgpr_kernarg_segment_ptr 1
  .amdhsa_system_sgpr_workgroup_id_x 1
  .amdhsa_float_denorm_mode_32 3
.end_amdhsa_kernel
```
